```python
import torch

def _softmax(x, axis=-1):
    return torch.softmax(x, dim=axis)
def _gelu(x):
    return torch.nn.functional.gelu(x, approximate="tanh")
def _silu(x):
    return torch.nn.functional.silu(x)
def _sigmoid(x):
    return torch.sigmoid(x)
def _layernorm(x, axis=-1, eps=1e-5):
    m = x.mean(dim=axis, keepdim=True)
    v = x.var(dim=axis, keepdim=True, unbiased=False)
    return (x - m) / torch.sqrt(v + eps)
def _scatter_add(tgt, idx, src, axis=0):
    return tgt.clone().index_add_(axis, idx, src)
def _segment_sum(src, seg, n):
    out = torch.zeros((n,) + src.shape[1:], dtype=src.dtype)
    return out.index_add_(0, seg, src)
def _pad(x, pw):
    flat = tuple(v for pair in reversed(pw) for v in pair)
    return torch.nn.functional.pad(x, flat)

kernel_name = 'gated_mix__ssm_conv_s5__dense_activation_gelu__prompt'

def setup_inputs():

    _w = (lambda a: (lambda t: t.to(torch.bfloat16) if t.is_floating_point() else t)(torch.as_tensor(a)))
    def _A_setup():
        B, S, D = 1, 2048, 1024
        P = D
        Lambda_re = -0.5 * (lambda _x: torch.exp(torch.as_tensor(_x)))((lambda *s: torch.randn(*s, dtype=torch.bfloat16) * 0.2)(P))
        Lambda_im = (lambda *s: torch.randn(*s, dtype=torch.bfloat16) * 0.8)(P) * 1.0
        B_re = (lambda *s: torch.randn(*s, dtype=torch.bfloat16) * 0.2)(P, D) * (D ** -0.5)
        B_im = (lambda *s: torch.randn(*s, dtype=torch.bfloat16) * 0.2)(P, D) * (D ** -0.5)
        C_re = (lambda *s: torch.randn(*s, dtype=torch.bfloat16) * 0.2)(D, P) * (P ** -0.5)
        C_im = (lambda *s: torch.randn(*s, dtype=torch.bfloat16) * 0.2)(D, P) * (P ** -0.5)
        log_dt = (lambda *s: torch.randn(*s, dtype=torch.bfloat16) * 0.2)(P) * 0.3 - 2.0
        Dskip = (lambda *s: torch.randn(*s, dtype=torch.bfloat16) * 0.05)(D)
        return {
            "x": _w((lambda *s: torch.randn(*s, dtype=torch.bfloat16) * 0.05)(B, S, D)),
            "Lambda_re": _w(Lambda_re),
            "Lambda_im": _w(Lambda_im),
            "B_re": _w(B_re),
            "B_im": _w(B_im),
            "C_re": _w(C_re),
            "C_im": _w(C_im),
            "log_dt": _w(log_dt),
            "Dskip": _w(Dskip),
        }
    _A_in = _A_setup()

    def _B_setup():
        B, S, D, F = 1, 2048, 1024, 3584
        return {
            "x": _w((lambda *s: torch.randn(*s, dtype=torch.bfloat16) * 0.05)(B, S, D)),
            "w1": _w((lambda *s: torch.randn(*s, dtype=torch.bfloat16) * 3.2)(D, F) * (D ** -0.5)),
            "b1": _w((lambda *s: torch.randn(*s, dtype=torch.bfloat16) * 3.2)(F) * 0.01),
            "w2": _w((lambda *s: torch.randn(*s, dtype=torch.bfloat16) * 0.1)(F, D) * (F ** -0.5)),
            "b2": _w((lambda *s: torch.randn(*s, dtype=torch.bfloat16) * 0.2)(D) * 0.01),
        }
    _B_in = _B_setup()

    return {
        "A_x": _A_in["x"],
        "A_Lambda_re": _A_in["Lambda_re"],
        "A_Lambda_im": _A_in["Lambda_im"],
        "A_B_re": _A_in["B_re"],
        "A_B_im": _A_in["B_im"],
        "A_C_re": _A_in["C_re"],
        "A_C_im": _A_in["C_im"],
        "A_log_dt": _A_in["log_dt"],
        "A_Dskip": _A_in["Dskip"],
        "B_x": _B_in["x"],
        "B_w1": _B_in["w1"],
        "B_b1": _B_in["b1"],
        "B_w2": _B_in["w2"],
        "B_b2": _B_in["b2"],
        "gate_w": _w((lambda *s: torch.randn(*s, dtype=torch.bfloat16) * 0.05)(1024) * 16.0),
    }

def reference(A_x, A_Lambda_re, A_Lambda_im, A_B_re, A_B_im, A_C_re, A_C_im, A_log_dt, A_Dskip, B_x, B_w1, B_b1, B_w2, B_b2, gate_w):
    def _A_ref(x, Lambda_re, Lambda_im, B_re, B_im, C_re, C_im, log_dt, Dskip):
        Bsz, L, H = x.shape
        Lam = Lambda_re + 1j * Lambda_im
        Bmat = B_re + 1j * B_im
        Cmat = C_re + 1j * C_im
        dt = torch.exp(log_dt)
        Lam_bar = torch.exp(dt * Lam)
        B_bar = ((Lam_bar - 1.0) / Lam)[:, None] * Bmat
        Bu = torch.einsum("bld,pd->blp", x + 0j, B_bar)
        h = torch.zeros_like(Bu[:, 0, :])
        hs = []
        for t in range(L):
            h = Lam_bar[None, :] * h + Bu[:, t, :]
            hs.append(h)
        hseq = torch.stack(hs, 1)
        y = 2.0 * torch.einsum("blp,dp->bld", hseq, Cmat).real + x * Dskip[None, None, :]
        return y

    def _B_ref(x, w1, b1, w2, b2):
        h = torch.einsum("bsd,df->bsf", x, w1) + b1
        h = _gelu(h)
        return torch.einsum("bsf,fd->bsd", h, w2) + b2

    x = A_x
    g = _sigmoid((x * gate_w).sum(-1, keepdims=True))
    a = _A_ref(x, A_Lambda_re, A_Lambda_im, A_B_re, A_B_im, A_C_re, A_C_im, A_log_dt, A_Dskip)
    b = _B_ref(x, B_w1, B_b1, B_w2, B_b2)
    return g * a + (1 - g) * b
```

```asm
; @launch grid=(256,1,1) block=(256,1,1) lds=163840
.amdgcn_target "amdgcn-amd-amdhsa--gfx950"
.text
.globl gated_mix__ssm_conv_s5__dense_activation_gelu__prompt_kernel
.p2align 8
.type gated_mix__ssm_conv_s5__dense_activation_gelu__prompt_kernel,@function
gated_mix__ssm_conv_s5__dense_activation_gelu__prompt_kernel:
    s_cmp_ge_u32 s2, 256
    s_cbranch_scc1 L_end
    s_load_dwordx16 s[64:79], s[0:1], 0
    s_load_dwordx16 s[80:95], s[0:1], 64
    s_load_dwordx4 s[96:99], s[0:1], 128
    s_getpc_b64 s[62:63]
    s_lshr_b32 s18, s2, 3
    s_lshl_b32 s18, s18, 11
    v_and_b32 v30, 15, v0
    v_lshl_add_u32 v1, v30, 7, s18
    global_load_dword a96, v1, s[62:63]
    v_lshrrev_b32 v1, 6, v0
    v_and_b32 v0, 63, v0
    v_readfirstlane_b32 s16, v1
    s_and_b32 s12, s2, 4
    s_lshr_b32 s18, s2, 6
    s_add_u32 s12, s12, s18
    s_and_b32 s15, s2, 3
    s_bfe_u32 s14, s2, 0x30003
    s_lshl3_add_u32 s13, s15, s14
    s_mov_b32 s22, 0x400000
    s_mov_b32 s23, 0x20000
    v_bfrev_b32 v34, 1
    v_lshlrev_b32 v32, 7, v0
    v_cmp_gt_u32 vcc, 14, v0
    v_lshrrev_b32 v36, 2, v0
    v_and_b32 v35, 0x180, v32
    v_cndmask_b32 v22, v34, v32, vcc
    v_cmp_gt_u32 vcc, 8, v0
    v_lshl_add_u32 v36, v36, 11, v35
    s_lshl3_add_u32 s18, s12, s14
    v_cndmask_b32 v23, v34, v36, vcc
    s_lshl2_add_u32 s19, s18, s16
    s_lshl2_add_u32 s19, s19, s15
    s_mul_i32 s63, s19, 1792
    s_and_b32 s19, s16, 1
    s_lshl1_add_u32 s18, s18, s19
    s_lshl_b32 s19, s15, 7
    s_add_u32 s18, s18, s19
    s_lshl_b32 s59, s18, 12
    s_lshl_b32 s18, s12, 5
    s_add_u32 s18, s18, s13
    s_lshl2_add_u32 s18, s18, s16
    s_lshl_b32 s60, s18, 12
    v_and_b32 v77, 31, v0
    v_lshrrev_b32 v35, 5, v0
    v_lshlrev_b32 v77, 4, v77
    v_lshl_add_u32 v77, v35, 11, v77
    s_mov_b32 s26, 0x200000
    s_mov_b32 s27, 0x20000
    s_mov_b32 s30, 0x700000
    s_mov_b32 s31, 0x20000
    s_waitcnt lgkmcnt(0)
    s_mov_b64 s[20:21], s[64:65]
    s_cmp_lt_u32 s16, 2
    s_cselect_b64 s[24:25], s[70:71], s[72:73]
    s_mov_b64 s[28:29], s[84:85]
    buffer_load_dword a96, v22, s[28:31], s63 offen
    buffer_load_dword a96, v23, s[24:27], s59 offen
    buffer_load_dword a96, v23, s[20:23], s60 offen offset:0
    v_lshrrev_b32 v31, 4, v0
    v_lshrrev_b32 v32, 5, v0
    v_bfe_u32 v33, v0, 3, 2
    v_lshl_add_u32 v32, v32, 4, v33
    v_and_b32 v33, 7, v0
    v_xor_b32 v33, v33, v31
    v_lshlrev_b32 v33, 4, v33
    v_lshl_add_u32 v7, v32, 11, v33
    s_lshl2_add_u32 s3, s12, s16
    s_lshl_b32 s18, s3, 17
    v_add_u32 v8, s18, v7
    v_xor_b32 v1, 64, v8
    v_add_u32 v9, 64512, v1
    v_add_u32 v10, 6144, v8
    v_add_u32 v11, 70656, v1
    v_add_u32 v12, 16384, v8
    v_add_u32 v13, 80896, v1
    v_add_u32 v14, 22528, v8
    v_add_u32 v15, 87040, v1
    s_mov_b32 s61, 0
    s_lshl_b32 s56, s16, 13
    s_sub_u32 s56, s56, 0x100000
    s_add_u32 m0, s56, 0x100000
    s_nop 0
    buffer_load_dwordx4 v8, s[20:23], s61 offen offset:0  lds
    buffer_load_dwordx4 v9, s[20:23], s61 offen offset:1024  lds
    buffer_load_dwordx4 v10, s[20:23], s61 offen offset:2048  lds
    buffer_load_dwordx4 v11, s[20:23], s61 offen offset:3072  lds
    s_add_u32 m0, s56, 0x101000
    s_nop 0
    buffer_load_dwordx4 v12, s[20:23], s61 offen offset:0  lds
    buffer_load_dwordx4 v13, s[20:23], s61 offen offset:1024  lds
    buffer_load_dwordx4 v14, s[20:23], s61 offen offset:2048  lds
    buffer_load_dwordx4 v15, s[20:23], s61 offen offset:3072  lds
    v_lshrrev_b32 v32, 3, v0
    v_lshl_add_u32 v35, v32, 11, v33
    s_and_b32 s18, s16, 1
    s_lshl1_add_u32 s18, s13, s18
    s_lshl_b32 s18, s18, 15
    v_add_u32 v16, s18, v35
    v_xor_b32 v17, 64, v16
    v_add_u32 v17, 15360, v17
    s_lshl_b32 s57, s16, 11
    s_add_u32 s57, s57, 0xfff10000
    s_add_u32 m0, s57, 0x100000
    s_nop 0
    buffer_load_dwordx4 v16, s[24:27], s61 offen offset:0  lds
    buffer_load_dwordx4 v17, s[24:27], s61 offen offset:1024  lds
    s_and_b32 s17, s14, 1
    s_mul_i32 s18, s16, 114688
    s_mul_i32 s19, s13, 224
    s_add_u32 s18, s18, s19
    s_lshl_b32 s19, s17, 1
    v_bfrev_b32 v34, 1
    v_subrev_u32 v32, 0, v0
    v_cmp_gt_u32 vcc, 56, v32
    v_mul_u32_u24 v33, 4682, v32
    v_lshrrev_b32 v33, 16, v33
    v_mul_u32_u24 v1, 14, v33
    v_sub_u32 v32, v32, v1
    v_add_u32 v32, s19, v32
    v_subrev_u32 v1, 14, v32
    v_min_u32 v32, v32, v1
    v_mul_u32_u24 v33, 7168, v33
    v_lshl_add_u32 v32, v32, 4, v33
    v_add_u32 v32, s18, v32
    v_add_u32 v33, 0, v32
    v_cndmask_b32 v18, v34, v33, vcc
    v_add_u32 v33, 27648, v32
    v_cndmask_b32 v19, v34, v33, vcc
    v_subrev_u32 v32, 8, v0
    v_cmp_gt_u32 vcc, 56, v32
    v_mul_u32_u24 v33, 4682, v32
    v_lshrrev_b32 v33, 16, v33
    v_mul_u32_u24 v1, 14, v33
    v_sub_u32 v32, v32, v1
    v_add_u32 v32, s19, v32
    v_subrev_u32 v1, 14, v32
    v_min_u32 v32, v32, v1
    v_mul_u32_u24 v33, 7168, v33
    v_lshl_add_u32 v32, v32, 4, v33
    v_add_u32 v32, s18, v32
    v_add_u32 v33, 55296, v32
    v_cndmask_b32 v20, v34, v33, vcc
    v_add_u32 v33, 82944, v32
    v_cndmask_b32 v21, v34, v33, vcc
    s_lshl_b32 s58, s16, 12
    s_add_u32 s58, s58, 0xfff16000
    s_mov_b32 s62, 0
    s_add_u32 m0, s58, 0x100000
    s_nop 0
    buffer_load_dwordx4 v18, s[28:31], s62 offen offset:0  lds
    buffer_load_dwordx4 v19, s[28:31], s62 offen offset:1024  lds
    buffer_load_dwordx4 v20, s[28:31], s62 offen offset:2048  lds
    buffer_load_dwordx4 v21, s[28:31], s62 offen offset:3072  lds
    v_lshlrev_b32 v1, 4, v0
    s_mov_b32 s11, 0x20000
    s_mov_b64 s[8:9], s[78:79]
    s_cmp_eq_u32 s16, 2
    s_cselect_b64 s[8:9], s[68:69], s[8:9]
    s_cmp_eq_u32 s16, 1
    s_cselect_b64 s[8:9], s[66:67], s[8:9]
    s_cmp_eq_u32 s16, 0
    s_cselect_b64 s[8:9], s[86:87], s[8:9]
    s_cselect_b32 s19, 224, 64
    s_mul_i32 s18, s13, s19
    s_add_u32 s10, s18, s19
    s_lshl_b32 s19, s16, 10
    s_add_u32 m0, s19, 139264
    s_nop 0
    buffer_load_dwordx4 v1, s[8:11], s18 offen lds
    s_add_u32 m0, s19, 143360
    s_mov_b64 s[8:9], s[92:93]
    s_cmp_eq_u32 s16, 1
    s_cselect_b64 s[8:9], s[90:91], s[8:9]
    s_cmp_eq_u32 s16, 0
    s_cselect_b64 s[8:9], s[80:81], s[8:9]
    s_lshl2_add_u32 s18, s14, s15
    s_lshl_b32 s18, s18, 6
    s_and_b32 s19, s19, 1024
    s_cmp_lt_u32 s16, 2
    s_cselect_b32 s18, s18, s19
    s_cselect_b32 s19, 64, 1024
    s_add_u32 s10, s18, s19
    buffer_load_dwordx4 v1, s[8:11], s18 offen lds
    v_lshrrev_b32 v32, 1, v30
    v_xor_b32 v32, v32, v31
    v_lshlrev_b32 v32, 4, v32
    v_lshl_add_u32 v32, v30, 7, v32
    s_lshl_b32 s18, s16, 13
    v_add_u32 v2, s18, v32
    v_xor_b32 v3, 64, v2
    v_add_u32 v4, 65536, v32
    v_xor_b32 v5, 64, v4
    v_bfe_u32 v32, v0, 2, 2
    v_mul_u32_u24 v32, 224, v32
    v_and_b32 v33, 3, v0
    v_lshl_add_u32 v32, v33, 3, v32
    v_lshl_add_u32 v32, v31, 11, v32
    v_and_b32 v33, 1, v31
    v_lshl_add_u32 v32, v33, 7, v32
    v_add_u32 v6, 90112, v32
    s_mov_b32 s18, 139264
    v_lshl_add_u32 v72, v31, 3, s18
    v_lshl_add_u32 v75, v30, 1, s18
    s_lshl_b32 s19, s17, 5
    v_add_u32 v73, s19, v72
    s_mul_i32 s19, s17, 224
    v_subrev_u32 v74, s19, v73
    v_and_b32 v78, 31, v0
    v_lshlrev_b32 v78, 4, v78
    v_add_u32 v76, s18, v78
    s_mov_b64 s[48:49], s[96:97]
    s_addk_i32 s61, 128
    s_bitset0_b32 s61, 11
    s_mul_i32 s62, s61, 3584
    s_add_u32 m0, s58, 0x104000
    s_nop 0
    buffer_load_dwordx4 v18, s[28:31], s62 offen offset:0  lds
    buffer_load_dwordx4 v19, s[28:31], s62 offen offset:1024  lds
    buffer_load_dwordx4 v20, s[28:31], s62 offen offset:2048  lds
    buffer_load_dwordx4 v21, s[28:31], s62 offen offset:3072  lds
    s_add_u32 m0, s57, 0x102000
    s_nop 0
    buffer_load_dwordx4 v16, s[24:27], s61 offen offset:0  lds
    buffer_load_dwordx4 v17, s[24:27], s61 offen offset:1024  lds
    s_add_u32 m0, s56, 0x108000
    s_nop 0
    buffer_load_dwordx4 v8, s[20:23], s61 offen offset:0  lds
    buffer_load_dwordx4 v9, s[20:23], s61 offen offset:1024  lds
    s_mov_b64 s[4:5], s[98:99]
    s_mov_b32 s6, 0x3200000
    s_mov_b32 s7, 0x20000
    s_mov_b64 s[32:33], s[88:89]
    s_mov_b32 s34, 0x700000
    s_mov_b32 s35, 0x20000
    s_mov_b64 s[36:37], s[74:75]
    s_mov_b32 s38, 0x200000
    s_mov_b32 s39, 0x20000
    s_mov_b64 s[40:41], s[76:77]
    s_mov_b32 s42, 0x200000
    s_mov_b32 s43, 0x20000
    s_mov_b64 s[44:45], s[94:95]
    s_mov_b32 s46, 0x800000
    s_mov_b32 s47, 0x20000
    s_mov_b32 s54, 0x4000
    s_mov_b32 s55, 0x20000
    s_mov_b32 s50, 0x100
    s_mov_b32 s51, 0x20000
    s_lshl_b32 s8, s13, 14
    s_add_u32 s8, s8, 0x3000000
    s_add_u32 s52, s4, s8
    s_addc_u32 s53, s5, 0
    s_sub_u32 s19, 31, s3
    s_lshl_b32 s19, s19, 9
    s_add_u32 s92, s8, s19
    v_lshlrev_b32 v78, 3, v0
    v_mov_b32 v64, -1
    v_mov_b32 v65, -1
    s_lshl2_add_u32 s8, s12, s15
    s_lshl2_add_u32 s8, s8, s16
    s_mul_i32 s8, s8, 180224
    s_sub_u32 s84, s8, 0x100000
    s_mul_i32 s8, s15, 1835008
    s_sub_u32 s85, s8, 0x100000
    s_cmp_le_u32 s14, 0
    s_cselect_b32 s8, 4, 0
    s_cselect_b32 s9, 4, 0
    s_lshl_b32 s8, s8, 12
    s_add_u32 s64, s84, s8
    s_lshl_b32 s9, s9, 16
    s_add_u32 s71, s85, s9
    s_cmp_le_u32 s14, 1
    s_cselect_b32 s8, 11, 4
    s_cselect_b32 s9, 7, 4
    s_lshl_b32 s8, s8, 12
    s_add_u32 s65, s84, s8
    s_lshl_b32 s9, s9, 16
    s_add_u32 s72, s85, s9
    s_cmp_le_u32 s14, 2
    s_cselect_b32 s8, 15, 11
    s_cselect_b32 s9, 11, 7
    s_lshl_b32 s8, s8, 12
    s_add_u32 s66, s84, s8
    s_lshl_b32 s9, s9, 16
    s_add_u32 s73, s85, s9
    s_cmp_le_u32 s14, 3
    s_cselect_b32 s8, 22, 15
    s_cselect_b32 s9, 14, 11
    s_lshl_b32 s8, s8, 12
    s_add_u32 s67, s84, s8
    s_lshl_b32 s9, s9, 16
    s_add_u32 s74, s85, s9
    s_cmp_le_u32 s14, 4
    s_cselect_b32 s8, 26, 22
    s_cselect_b32 s9, 18, 14
    s_lshl_b32 s8, s8, 12
    s_add_u32 s68, s84, s8
    s_lshl_b32 s9, s9, 16
    s_add_u32 s75, s85, s9
    s_cmp_le_u32 s14, 5
    s_cselect_b32 s8, 33, 26
    s_cselect_b32 s9, 21, 18
    s_lshl_b32 s8, s8, 12
    s_add_u32 s69, s84, s8
    s_lshl_b32 s9, s9, 16
    s_add_u32 s76, s85, s9
    s_cmp_le_u32 s14, 6
    s_cselect_b32 s8, 37, 33
    s_cselect_b32 s9, 25, 21
    s_lshl_b32 s8, s8, 12
    s_add_u32 s70, s84, s8
    s_lshl_b32 s9, s9, 16
    s_add_u32 s77, s85, s9
    s_lshr_b32 s19, s14, 1
    s_lshl_b32 s10, s15, 9
    s_cmp_le_u32 s19, 0
    s_cselect_b32 s8, 1, 0
    s_mul_i32 s9, s8, 45056
    s_add_u32 s78, s84, s9
    s_lshl_b32 s8, s8, 7
    s_add_u32 s81, s10, s8
    s_cmp_le_u32 s19, 1
    s_cselect_b32 s8, 2, 1
    s_mul_i32 s9, s8, 45056
    s_add_u32 s79, s84, s9
    s_lshl_b32 s8, s8, 7
    s_add_u32 s82, s10, s8
    s_cmp_le_u32 s19, 2
    s_cselect_b32 s8, 3, 2
    s_mul_i32 s9, s8, 45056
    s_add_u32 s80, s84, s9
    s_lshl_b32 s8, s8, 7
    s_add_u32 s83, s10, s8
    s_lshl_b32 s8, s19, 7
    s_add_u32 s90, s10, s8
    s_mul_i32 s8, s19, 45056
    s_add_u32 s91, s84, s8
    s_lshl_b32 s8, s17, 14
    s_add_u32 s86, s91, s8
    s_lshl_b32 s8, s17, 12
    s_add_u32 s9, s91, 28672
    s_add_u32 s87, s9, s8
    s_sub_u32 s9, s9, s8
    s_add_u32 s88, s9, 4096
    s_mul_i32 s8, s19, 458752
    s_lshl_b32 s9, s17, 18
    s_add_u32 s8, s8, s9
    s_add_u32 s89, s85, s8
    s_mov_b32 s94, 0xbdd2d3e8
    s_mov_b32 s95, 0xc0135761
    s_mov_b32 s93, 1048576
    s_lshl2_add_u32 s8, s13, s16
    s_mul_i32 s8, s8, 12288
    s_lshl_b32 s9, s12, 21
    s_add_u32 s8, s8, s9
    s_add_u32 s0, s8, 0x2000000
    buffer_store_dwordx2 v[64:65], v78, s[4:7], s92 offen sc1
    s_branch L_body
    .p2align 12
L_body:
    s_waitcnt vmcnt(9)
    s_barrier
    ds_read_b128 a[0:3], v2 offset:0
    ds_read_b128 a[16:19], v3 offset:0
    ds_read_b128 a[4:7], v2 offset:2048
    ds_read_b128 a[20:23], v3 offset:2048
    ds_read_b128 a[8:11], v2 offset:4096
    ds_read_b128 a[24:27], v3 offset:4096
    ds_read_b128 a[12:15], v2 offset:6144
    ds_read_b128 a[28:31], v3 offset:6144
    ds_read_b128 a[64:67], v4 offset:0
    ds_read_b128 a[68:71], v5 offset:0
    ds_read_b128 a[72:75], v4 offset:2048
    ds_read_b128 a[76:79], v5 offset:2048
    ds_read_b128 a[80:83], v4 offset:4096
    ds_read_b128 a[84:87], v5 offset:4096
    .p2align 3
    s_waitcnt lgkmcnt(4)
    v_mfma_f32_16x16x32_bf16 v[80:83], a[0:3], a[64:67], 0
    ds_read_b128 a[88:91], v4 offset:6144
    ds_read_b64 v[158:159], v73 offset:0
    v_mfma_f32_16x16x32_bf16 v[80:83], a[16:19], a[68:71], v[80:83]
    buffer_load_dwordx4 v10, s[20:23], s61 offen offset:2048  lds
    ds_read_b64 v[162:163], v73 offset:32
    v_mfma_f32_16x16x32_bf16 v[84:87], a[20:23], a[68:71], 0
    buffer_load_dwordx4 v11, s[20:23], s61 offen offset:3072  lds
    ds_read_b64 v[190:191], v73 offset:64
    v_mfma_f32_16x16x32_bf16 v[84:87], a[4:7], a[64:67], v[84:87]
    ds_read_b128 a[92:95], v5 offset:6144
    v_mfma_f32_16x16x32_bf16 v[88:91], a[8:11], a[64:67], 0
    ds_read_b64 v[194:195], v73 offset:96
    v_mfma_f32_16x16x32_bf16 v[88:91], a[24:27], a[68:71], v[88:91]
    s_add_u32 m0, s56, 0x109000
    ds_read_b64 v[222:223], v73 offset:128
    v_mfma_f32_16x16x32_bf16 v[92:95], a[28:31], a[68:71], 0
    ds_read_b64 v[226:227], v73 offset:160
    v_mfma_f32_16x16x32_bf16 v[92:95], a[12:15], a[64:67], v[92:95]
    ds_read_b64 v[254:255], v74 offset:192
    s_waitcnt lgkmcnt(11)
    v_mfma_f32_16x16x32_bf16 v[108:111], a[12:15], a[72:75], 0
    ds_read_b64_tr_b16 a[64:65], v6 offset:0
    v_mfma_f32_16x16x32_bf16 v[108:111], a[28:31], a[76:79], v[108:111]
    ds_read_b64_tr_b16 a[66:67], v6 offset:1024
    v_mfma_f32_16x16x32_bf16 v[104:107], a[24:27], a[76:79], 0
    buffer_load_dwordx4 v12, s[20:23], s61 offen offset:0  lds
    v_mfma_f32_16x16x32_bf16 v[104:107], a[8:11], a[72:75], v[104:107]
    ds_read_b64_tr_b16 a[68:69], v6 offset:8192
    v_mfma_f32_16x16x32_bf16 v[100:103], a[4:7], a[72:75], 0
    buffer_load_dwordx4 v13, s[20:23], s61 offen offset:1024  lds
    v_mfma_f32_16x16x32_bf16 v[100:103], a[20:23], a[76:79], v[100:103]
    ds_read_b64_tr_b16 a[70:71], v6 offset:9216
    v_mfma_f32_16x16x32_bf16 v[96:99], a[16:19], a[76:79], 0
    buffer_load_dwordx4 v14, s[20:23], s61 offen offset:2048  lds
    v_mfma_f32_16x16x32_bf16 v[96:99], a[0:3], a[72:75], v[96:99]
    buffer_load_dwordx4 v15, s[20:23], s61 offen offset:3072  lds
    s_waitcnt lgkmcnt(13)
    v_mfma_f32_16x16x32_bf16 v[112:115], a[0:3], a[80:83], 0
    ds_read_b64_tr_b16 a[72:73], v6 offset:32
    s_waitcnt lgkmcnt(5)
    v_mfma_f32_16x16x32_bf16 v[112:115], a[16:19], a[84:87], v[112:115]
    ds_read_b64_tr_b16 a[74:75], v6 offset:1056
    v_lshlrev_b32 v156, 16, v158
    v_mfma_f32_16x16x32_bf16 v[116:119], a[20:23], a[84:87], 0
    s_addk_i32 s61, 128
    s_bitset0_b32 s61, 11
    v_and_b32 v157, 0xffff0000, v158
    v_mfma_f32_16x16x32_bf16 v[116:119], a[4:7], a[80:83], v[116:119]
    ds_read_b64_tr_b16 a[76:77], v6 offset:8224
    v_lshlrev_b32 v158, 16, v159
    v_mfma_f32_16x16x32_bf16 v[120:123], a[8:11], a[80:83], 0
    v_and_b32 v56, 15, v0
    v_and_b32 v159, 0xffff0000, v159
    v_mfma_f32_16x16x32_bf16 v[120:123], a[24:27], a[84:87], v[120:123]
    ds_read_b64_tr_b16 a[78:79], v6 offset:9248
    v_lshlrev_b32 v160, 16, v162
    v_mfma_f32_16x16x32_bf16 v[124:127], a[28:31], a[84:87], 0
    s_mul_i32 s62, s61, 3584
    v_lshrrev_b32 v57, 4, v0
    v_mfma_f32_16x16x32_bf16 v[124:127], a[12:15], a[80:83], v[124:127]
    v_and_b32 v161, 0xffff0000, v162
    v_lshlrev_b32 v162, 16, v163
    v_mfma_f32_16x16x32_bf16 v[140:143], a[12:15], a[88:91], 0
    ds_read_b64_tr_b16 a[80:81], v6 offset:64
    v_cmp_gt_u32 vcc, 14, v56
    v_mfma_f32_16x16x32_bf16 v[140:143], a[28:31], a[92:95], v[140:143]
    ds_read_b64_tr_b16 a[82:83], v6 offset:1088
    v_and_b32 v163, 0xffff0000, v163
    v_lshlrev_b32 v188, 16, v190
    v_mfma_f32_16x16x32_bf16 v[136:139], a[24:27], a[92:95], 0
    s_add_u32 m0, s58, 0x108000
    v_cmp_gt_u32 s[8:9], 32, v0
    v_mfma_f32_16x16x32_bf16 v[136:139], a[8:11], a[88:91], v[136:139]
    ds_read_b64_tr_b16 a[84:85], v6 offset:8256
    v_and_b32 v189, 0xffff0000, v190
    v_lshlrev_b32 v190, 16, v191
    v_mfma_f32_16x16x32_bf16 v[132:135], a[4:7], a[88:91], 0
    buffer_load_dwordx4 v18, s[28:31], s62 offen offset:0  lds
    v_mul_u32_u24 v57, 7168, v57
    v_and_b32 v191, 0xffff0000, v191
    v_mfma_f32_16x16x32_bf16 v[132:135], a[20:23], a[92:95], v[132:135]
    ds_read_b64_tr_b16 a[86:87], v6 offset:9280
    v_lshlrev_b32 v192, 16, v194
    v_mfma_f32_16x16x32_bf16 v[128:131], a[16:19], a[92:95], 0
    buffer_load_dwordx4 v19, s[28:31], s62 offen offset:1024  lds
    s_and_b64 vcc, vcc, s[8:9]
    v_mfma_f32_16x16x32_bf16 v[128:131], a[0:3], a[88:91], v[128:131]
    v_and_b32 v193, 0xffff0000, v194
    s_waitcnt lgkmcnt(8)
    v_mfma_f32_16x16x32_bf16 v[144:147], a[64:67], a[0:3], v[156:159]
    ds_read_b64_tr_b16 a[88:89], v6 offset:96
    v_lshlrev_b32 v194, 16, v195
    v_mfma_f32_16x16x32_bf16 v[144:147], a[68:71], a[16:19], v[144:147]
    ds_read_b64_tr_b16 a[90:91], v6 offset:1120
    v_lshl_add_u32 v56, v56, 7, v57
    v_mfma_f32_16x16x32_bf16 v[148:151], a[68:71], a[20:23], v[156:159]
    buffer_load_dwordx4 v20, s[28:31], s62 offen offset:2048  lds
    v_and_b32 v195, 0xffff0000, v195
    v_mfma_f32_16x16x32_bf16 v[148:151], a[64:67], a[4:7], v[148:151]
    ds_read_b64_tr_b16 a[92:93], v6 offset:8288
    v_lshlrev_b32 v220, 16, v222
    v_mfma_f32_16x16x32_bf16 v[152:155], a[64:67], a[8:11], v[156:159]
    v_bfrev_b32 v57, 1
    v_and_b32 v221, 0xffff0000, v222
    v_mfma_f32_16x16x32_bf16 v[152:155], a[68:71], a[24:27], v[152:155]
    ds_read_b64_tr_b16 a[94:95], v6 offset:9312
    v_cndmask_b32 v22, v57, v56, vcc
    v_mfma_f32_16x16x32_bf16 v[156:159], a[68:71], a[28:31], v[156:159]
    buffer_load_dwordx4 v21, s[28:31], s62 offen offset:3072  lds
    v_lshlrev_b32 v222, 16, v223
    v_mfma_f32_16x16x32_bf16 v[156:159], a[64:67], a[12:15], v[156:159]
    v_cmp_gt_u32 vcc, 16, v0
    s_waitcnt lgkmcnt(8)
    v_mfma_f32_16x16x32_bf16 v[172:175], a[72:75], a[12:15], v[160:163]
    ds_read_b64_tr_b16 a[64:65], v6 offset:128
    v_and_b32 v223, 0xffff0000, v223
    v_mfma_f32_16x16x32_bf16 v[172:175], a[76:79], a[28:31], v[172:175]
    ds_read_b64_tr_b16 a[66:67], v6 offset:1152
    v_lshrrev_b32 v56, 2, v0
    v_lshlrev_b32 v224, 16, v226
    v_mfma_f32_16x16x32_bf16 v[168:171], a[76:79], a[24:27], v[160:163]
    s_add_u32 m0, s57, 0x104000
    v_and_b32 v225, 0xffff0000, v226
    v_mfma_f32_16x16x32_bf16 v[168:171], a[72:75], a[8:11], v[168:171]
    ds_read_b64_tr_b16 a[68:69], v6 offset:8320
    v_and_b32 v58, 3, v0
    v_mfma_f32_16x16x32_bf16 v[164:167], a[72:75], a[4:7], v[160:163]
    buffer_load_dwordx4 v16, s[24:27], s61 offen offset:0  lds
    v_lshlrev_b32 v226, 16, v227
    v_mfma_f32_16x16x32_bf16 v[164:167], a[76:79], a[20:23], v[164:167]
    ds_read_b64_tr_b16 a[70:71], v6 offset:9344
    v_and_b32 v227, 0xffff0000, v227
    v_mfma_f32_16x16x32_bf16 v[160:163], a[76:79], a[16:19], v[160:163]
    buffer_load_dwordx4 v17, s[24:27], s61 offen offset:1024  lds
    v_lshlrev_b32 v58, 7, v58
    v_mfma_f32_16x16x32_bf16 v[160:163], a[72:75], a[0:3], v[160:163]
    v_lshlrev_b32 v252, 16, v254
    s_waitcnt lgkmcnt(8)
    v_mfma_f32_16x16x32_bf16 v[176:179], a[80:83], a[0:3], v[188:191]
    ds_read_b64_tr_b16 a[72:73], v6 offset:160
    v_lshl_add_u32 v56, v56, 11, v58
    v_mfma_f32_16x16x32_bf16 v[176:179], a[84:87], a[16:19], v[176:179]
    ds_read_b64_tr_b16 a[74:75], v6 offset:1184
    v_and_b32 v253, 0xffff0000, v254
    v_mfma_f32_16x16x32_bf16 v[180:183], a[84:87], a[20:23], v[188:191]
    s_add_u32 m0, s56, 0x100000
    v_cndmask_b32 v23, v57, v56, vcc
    v_lshlrev_b32 v254, 16, v255
    v_mfma_f32_16x16x32_bf16 v[180:183], a[80:83], a[4:7], v[180:183]
    ds_read_b64_tr_b16 a[76:77], v6 offset:8352
    v_and_b32 v255, 0xffff0000, v255
    v_mfma_f32_16x16x32_bf16 v[184:187], a[80:83], a[8:11], v[188:191]
    buffer_load_dwordx4 v8, s[20:23], s61 offen offset:0  lds
    ds_read_b128 v[40:43], v76 offset:6144
    v_mfma_f32_16x16x32_bf16 v[184:187], a[84:87], a[24:27], v[184:187]
    ds_read_b64_tr_b16 a[78:79], v6 offset:9376
    ds_read_b128 v[44:47], v76 offset:6656
    v_mfma_f32_16x16x32_bf16 v[188:191], a[84:87], a[28:31], v[188:191]
    s_lshr_b32 s8, s14, 1
    s_lshl2_add_u32 s8, s12, s8
    ds_read_b128 v[48:51], v76 offset:7168
    v_mfma_f32_16x16x32_bf16 v[188:191], a[80:83], a[12:15], v[188:191]
    s_lshl2_add_u32 s9, s8, s16
    s_lshl3_add_u32 s9, s9, s15
    s_waitcnt lgkmcnt(11)
    v_mfma_f32_16x16x32_bf16 v[204:207], a[88:91], a[12:15], v[192:195]
    ds_read_b64_tr_b16 a[80:81], v6 offset:192
    s_mul_i32 s9, s9, 1792
    v_mfma_f32_16x16x32_bf16 v[204:207], a[92:95], a[28:31], v[204:207]
    ds_read_b64_tr_b16 a[82:83], v6 offset:1216
    ds_read_b128 v[52:55], v76 offset:7680
    v_mfma_f32_16x16x32_bf16 v[200:203], a[92:95], a[24:27], v[192:195]
    buffer_load_dwordx4 v9, s[20:23], s61 offen offset:1024  lds
    ds_read_u16 v66, v75 offset:1024
    v_mfma_f32_16x16x32_bf16 v[200:203], a[88:91], a[8:11], v[200:203]
    ds_read_b64_tr_b16 a[84:85], v6 offset:8384
    s_and_b32 s10, s16, 1
    s_lshl1_add_u32 s8, s8, s10
    ds_read_u16 v67, v75 offset:1056
    v_mfma_f32_16x16x32_bf16 v[196:199], a[88:91], a[4:7], v[192:195]
    buffer_load_dwordx4 v10, s[20:23], s61 offen offset:2048  lds
    ds_read_u16 v68, v75 offset:2048
    v_mfma_f32_16x16x32_bf16 v[196:199], a[92:95], a[20:23], v[196:199]
    ds_read_b64_tr_b16 a[86:87], v6 offset:9408
    s_lshl_b32 s10, s15, 6
    s_add_u32 s8, s8, s10
    v_mfma_f32_16x16x32_bf16 v[192:195], a[92:95], a[16:19], v[192:195]
    buffer_load_dwordx4 v11, s[20:23], s61 offen offset:3072  lds
    ds_read_u16 v69, v75 offset:2080
    v_mfma_f32_16x16x32_bf16 v[192:195], a[88:91], a[0:3], v[192:195]
    ds_read_u16 v70, v75 offset:3072
    s_waitcnt lgkmcnt(14)
    v_mfma_f32_16x16x32_bf16 v[208:211], a[64:67], a[0:3], v[220:223]
    s_lshl_b32 s8, s8, 13
    s_add_u32 s10, s14, 1
    ds_read_u16 v71, v75 offset:3104
    v_mfma_f32_16x16x32_bf16 v[208:211], a[68:71], a[16:19], v[208:211]
    s_add_u32 m0, s56, 0x101000
    ds_read_b64 a[128:129], v72 offset:4096
    v_mfma_f32_16x16x32_bf16 v[212:215], a[68:71], a[20:23], v[220:223]
    s_add_u32 s9, s9, 0
    s_add_u32 s8, s8, 0
    ds_read_b64 a[130:131], v72 offset:4128
    v_mfma_f32_16x16x32_bf16 v[212:215], a[64:67], a[4:7], v[212:215]
    s_bitcmp1_b32 s10, 1
    s_cselect_b32 s63, 0x40000000, s9
    s_cselect_b32 s59, 0x40000000, s8
    ds_read_b64 a[132:133], v72 offset:5120
    v_mfma_f32_16x16x32_bf16 v[216:219], a[64:67], a[8:11], v[220:223]
    buffer_load_dwordx4 v12, s[20:23], s61 offen offset:0  lds
    v_mfma_f32_16x16x32_bf16 v[216:219], a[68:71], a[24:27], v[216:219]
    ds_read_b64 a[134:135], v72 offset:5152
    v_mfma_f32_16x16x32_bf16 v[220:223], a[68:71], a[28:31], v[220:223]
    v_mfma_f32_16x16x32_bf16 v[220:223], a[64:67], a[12:15], v[220:223]
    s_waitcnt vmcnt(11) lgkmcnt(0)
    s_barrier
    v_mfma_f32_16x16x32_bf16 v[236:239], a[72:75], a[12:15], v[224:227]
    ds_read_b128 a[88:91], v4 offset:8192
    v_mfma_f32_16x16x32_bf16 v[236:239], a[76:79], a[28:31], v[236:239]
    ds_read_b128 a[92:95], v5 offset:8192
    s_add_u32 s63, s63, 1835008
    s_add_u32 s59, s59, 512
    v_mfma_f32_16x16x32_bf16 v[232:235], a[76:79], a[24:27], v[224:227]
    ds_read_b128 a[32:35], v2 offset:32768
    v_mfma_f32_16x16x32_bf16 v[232:235], a[72:75], a[8:11], v[232:235]
    ds_read_b128 a[48:51], v3 offset:32768
    v_mfma_f32_16x16x32_bf16 v[228:231], a[72:75], a[4:7], v[224:227]
    buffer_load_dword a96, v22, s[28:31], s63 offen
    v_mfma_f32_16x16x32_bf16 v[228:231], a[76:79], a[20:23], v[228:231]
    ds_read_b128 a[36:39], v2 offset:34816
    buffer_load_dword a96, v23, s[24:27], s59 offen
    v_mfma_f32_16x16x32_bf16 v[224:227], a[76:79], a[16:19], v[224:227]
    ds_read_b128 a[52:55], v3 offset:34816
    buffer_load_dwordx4 v[24:27], v77, s[20:23], s60 offen offset:0
    v_mfma_f32_16x16x32_bf16 v[224:227], a[72:75], a[0:3], v[224:227]
    buffer_load_dwordx4 v[28:31], v77, s[20:23], s60 offen offset:512
    v_mfma_f32_16x16x32_bf16 v[240:243], a[80:83], a[0:3], v[252:255]
    ds_read_b128 a[64:67], v4 offset:10240
    buffer_load_dwordx4 v[32:35], v77, s[20:23], s60 offen offset:1024
    v_mfma_f32_16x16x32_bf16 v[240:243], a[84:87], a[16:19], v[240:243]
    ds_read_b128 a[68:71], v5 offset:10240
    v_mfma_f32_16x16x32_bf16 v[244:247], a[84:87], a[20:23], v[252:255]
    ds_read_b128 a[40:43], v2 offset:36864
    buffer_load_dwordx4 v[36:39], v77, s[20:23], s60 offen offset:1536
    v_mfma_f32_16x16x32_bf16 v[244:247], a[80:83], a[4:7], v[244:247]
    ds_read_b128 a[56:59], v3 offset:36864
    v_mfma_f32_16x16x32_bf16 v[248:251], a[80:83], a[8:11], v[252:255]
    ds_read_b128 a[44:47], v2 offset:38912
    v_mfma_f32_16x16x32_bf16 v[248:251], a[84:87], a[24:27], v[248:251]
    ds_read_b128 a[60:63], v3 offset:38912
    v_mfma_f32_16x16x32_bf16 v[252:255], a[84:87], a[28:31], v[252:255]
    v_mfma_f32_16x16x32_bf16 v[252:255], a[80:83], a[12:15], v[252:255]
    s_waitcnt lgkmcnt(6)
    v_mfma_f32_16x16x32_bf16 v[80:83], a[32:35], a[88:91], v[80:83]
    ds_read_b128 a[72:75], v4 offset:12288
    buffer_load_dwordx4 v13, s[20:23], s61 offen offset:1024  lds
    v_mfma_f32_16x16x32_bf16 v[80:83], a[48:51], a[92:95], v[80:83]
    ds_read_b128 a[80:83], v4 offset:14336
    v_mfma_f32_16x16x32_bf16 v[84:87], a[52:55], a[92:95], v[84:87]
    ds_read_b128 a[76:79], v5 offset:12288
    v_mfma_f32_16x16x32_bf16 v[84:87], a[36:39], a[88:91], v[84:87]
    ds_read_b128 a[84:87], v5 offset:14336
    s_waitcnt lgkmcnt(4)
    v_mfma_f32_16x16x32_bf16 v[88:91], a[40:43], a[88:91], v[88:91]
    buffer_load_dwordx4 v14, s[20:23], s61 offen offset:2048  lds
    v_mfma_f32_16x16x32_bf16 v[88:91], a[56:59], a[92:95], v[88:91]
    v_mfma_f32_16x16x32_bf16 v[92:95], a[60:63], a[92:95], v[92:95]
    buffer_load_dwordx4 v15, s[20:23], s61 offen offset:3072  lds
    v_mfma_f32_16x16x32_bf16 v[92:95], a[44:47], a[88:91], v[92:95]
    s_mov_b64 exec, 0
    s_cmp_eq_u32 s16, 0
    s_cbranch_scc1 L_hop_0
    s_cmp_eq_u32 s16, 1
    s_cbranch_scc1 L_hop_1
    s_cmp_eq_u32 s16, 2
    s_cbranch_scc1 L_hop_2
    s_branch L_hop_3
L_hop_done:
    s_mov_b64 exec, -1
    s_nop 0
    v_and_b32 v56, 15, v0
    v_lshrrev_b32 v57, 4, v0
    v_bfrev_b32 v58, 1
    v_bfe_u32 v59, v0, 2, 2
    v_and_b32 v60, 3, v0
    v_cmp_gt_u32 vcc, 16, v0
    v_lshlrev_b32 v61, 4, v56
    s_sub_u32 s18, 32, s3
    s_lshl_b32 s18, s18, 9
    v_cndmask_b32 v62, v58, v61, vcc
    v_accvgpr_write_b32 a136, v62
    v_lshl_add_u32 v62, v57, 12, v61
    v_add_u32 v62, s18, v62
    v_accvgpr_write_b32 a137, v62
    v_and_b32 v63, 1, v57
    v_lshrrev_b32 v62, 5, v0
    v_lshl_add_u32 v62, v63, 2, v62
    v_lshl_add_u32 v62, v62, 8, v61
    v_accvgpr_write_b32 a138, v62
    v_lshl_or_b32 v62, v63, 2, v59
    v_lshlrev_b32 v62, 5, v62
    v_lshl_add_u32 v62, v59, 8, v62
    v_lshl_add_u32 v62, v57, 10, v62
    v_lshl_add_u32 v62, v60, 3, v62
    v_add_u32 v62, 98304, v62
    v_accvgpr_write_b32 a143, v62
    v_subrev_u32 v62, 65536, v4
    v_accvgpr_write_b32 a144, v62
    s_lshl_b32 s18, s16, 13
    s_add_u32 s18, s18, 32768
    v_bfe_u32 v62, v0, 1, 2
    v_and_b32 v63, 1, v0
    v_lshl_or_b32 v62, v63, 2, v62
    v_lshlrev_b32 v63, 1, v57
    v_xor_b32 v62, v62, v63
    v_lshl_add_u32 v63, v56, 7, s18
    v_lshl_add_u32 v62, v62, 4, v63
    v_accvgpr_write_b32 a139, v62
    v_bfe_u32 v62, v0, 3, 1
    v_and_b32 v63, 4, v0
    v_or_b32 v62, v62, v63
    v_lshlrev_b32 v63, 1, v60
    v_xor_b32 v62, v62, v63
    v_lshl_add_u32 v63, v59, 7, s18
    v_lshl_add_u32 v62, v62, 4, v63
    v_lshl_add_u32 v62, v57, 10, v62
    v_accvgpr_write_b32 a140, v62
    v_cmp_eq_u32 vcc, s14, v0
    v_lshlrev_b32 v63, 2, v0
    s_lshl2_add_u32 s18, s14, s15
    s_lshl_b32 s18, s18, 6
    v_cndmask_b32 v62, v58, v63, vcc
    v_accvgpr_write_b32 a141, v62
    s_lshl_b32 s19, s3, 17
    s_add_u32 s18, s18, s19
    v_lshl_add_u32 v62, v59, 4, v60
    v_lshl_add_u32 v63, v57, 3, s18
    v_lshl_add_u32 v62, v62, 11, v63
    v_accvgpr_write_b32 a142, v62
    v_lshl_add_u32 v62, v57, 4, v59
    v_xor_b32 v63, v60, v57
    v_lshl_add_u32 v63, v63, 4, s18
    v_lshl_add_u32 v62, v62, 11, v63
    v_accvgpr_write_b32 a145, v62
    s_lshl_b32 s18, s16, 12
    s_add_u32 s18, s18, 73728
    v_lshrrev_b32 v62, 1, v57
    v_xor_b32 v62, v62, v59
    v_lshl_add_u32 v63, v56, 6, s18
    v_lshl_add_u32 v62, v62, 4, v63
    v_and_b32 v63, 1, v57
    v_lshl_add_u32 v62, v63, 3, v62
    v_accvgpr_write_b32 a146, v62
    s_lshl_b32 s18, s17, 9
    s_add_u32 s91, s91, s18
    .p2align 3
    v_mfma_f32_16x16x32_bf16 v[108:111], a[44:47], a[64:67], v[108:111]
    ds_read_b64_tr_b16 a[88:89], v6 offset:16384
    v_mfma_f32_16x16x32_bf16 v[108:111], a[60:63], a[68:71], v[108:111]
    ds_read_b64_tr_b16 a[90:91], v6 offset:17408
    v_mfma_f32_16x16x32_bf16 v[104:107], a[56:59], a[68:71], v[104:107]
    s_addk_i32 s61, 128
    s_bitset0_b32 s61, 11
    v_mfma_f32_16x16x32_bf16 v[104:107], a[40:43], a[64:67], v[104:107]
    ds_read_b64_tr_b16 a[92:93], v6 offset:24576
    v_mfma_f32_16x16x32_bf16 v[100:103], a[36:39], a[64:67], v[100:103]
    s_mul_i32 s62, s61, 3584
    v_mfma_f32_16x16x32_bf16 v[100:103], a[52:55], a[68:71], v[100:103]
    ds_read_b64_tr_b16 a[94:95], v6 offset:25600
    v_mfma_f32_16x16x32_bf16 v[96:99], a[48:51], a[68:71], v[96:99]
    v_bfrev_b32 v74, 1
    v_mfma_f32_16x16x32_bf16 v[96:99], a[32:35], a[64:67], v[96:99]
    v_lshrrev_b32 v73, 2, v0
    s_waitcnt lgkmcnt(5)
    v_mfma_f32_16x16x32_bf16 v[112:115], a[32:35], a[72:75], v[112:115]
    ds_read_b64_tr_b16 a[64:65], v6 offset:16416
    v_mfma_f32_16x16x32_bf16 v[112:115], a[48:51], a[76:79], v[112:115]
    ds_read_b64_tr_b16 a[66:67], v6 offset:17440
    v_mfma_f32_16x16x32_bf16 v[116:119], a[52:55], a[76:79], v[116:119]
    s_add_u32 m0, s58, 0x100000
    v_mfma_f32_16x16x32_bf16 v[116:119], a[36:39], a[72:75], v[116:119]
    ds_read_b64_tr_b16 a[68:69], v6 offset:24608
    v_and_b32 v72, 3, v0
    v_mfma_f32_16x16x32_bf16 v[120:123], a[40:43], a[72:75], v[120:123]
    buffer_load_dwordx4 v18, s[28:31], s62 offen offset:0  lds
    v_mfma_f32_16x16x32_bf16 v[120:123], a[56:59], a[76:79], v[120:123]
    ds_read_b64_tr_b16 a[70:71], v6 offset:25632
    v_mfma_f32_16x16x32_bf16 v[124:127], a[60:63], a[76:79], v[124:127]
    buffer_load_dwordx4 v19, s[28:31], s62 offen offset:1024  lds
    v_mfma_f32_16x16x32_bf16 v[124:127], a[44:47], a[72:75], v[124:127]
    v_lshlrev_b32 v72, 7, v72
    s_waitcnt lgkmcnt(8)
    v_mfma_f32_16x16x32_bf16 v[140:143], a[44:47], a[80:83], v[140:143]
    ds_read_b64_tr_b16 a[72:73], v6 offset:16448
    v_mfma_f32_16x16x32_bf16 v[140:143], a[60:63], a[84:87], v[140:143]
    ds_read_b64_tr_b16 a[74:75], v6 offset:17472
    v_mfma_f32_16x16x32_bf16 v[136:139], a[56:59], a[84:87], v[136:139]
    buffer_load_dwordx4 v20, s[28:31], s62 offen offset:2048  lds
    v_mfma_f32_16x16x32_bf16 v[136:139], a[40:43], a[80:83], v[136:139]
    ds_read_b64_tr_b16 a[76:77], v6 offset:24640
    v_mfma_f32_16x16x32_bf16 v[132:135], a[36:39], a[80:83], v[132:135]
    buffer_load_dwordx4 v21, s[28:31], s62 offen offset:3072  lds
    v_mfma_f32_16x16x32_bf16 v[132:135], a[52:55], a[84:87], v[132:135]
    ds_read_b64_tr_b16 a[78:79], v6 offset:25664
    v_mfma_f32_16x16x32_bf16 v[128:131], a[48:51], a[84:87], v[128:131]
    v_lshl_add_u32 v73, v73, 11, v72
    v_mfma_f32_16x16x32_bf16 v[128:131], a[32:35], a[80:83], v[128:131]
    v_cmp_gt_u32 vcc, 16, v0
    s_waitcnt lgkmcnt(8)
    v_mfma_f32_16x16x32_bf16 v[144:147], a[88:91], a[32:35], v[144:147]
    ds_read_b64_tr_b16 a[80:81], v6 offset:16480
    v_mfma_f32_16x16x32_bf16 v[144:147], a[92:95], a[48:51], v[144:147]
    ds_read_b64_tr_b16 a[82:83], v6 offset:17504
    v_mfma_f32_16x16x32_bf16 v[148:151], a[92:95], a[52:55], v[148:151]
    s_add_u32 m0, s57, 0x100000
    s_lshl_b32 s10, s14, 5
    s_add_u32 s10, s10, s3
    v_mfma_f32_16x16x32_bf16 v[148:151], a[88:91], a[36:39], v[148:151]
    ds_read_b64_tr_b16 a[84:85], v6 offset:24672
    v_mfma_f32_16x16x32_bf16 v[152:155], a[88:91], a[40:43], v[152:155]
    buffer_load_dwordx4 v16, s[24:27], s61 offen offset:0  lds
    v_mfma_f32_16x16x32_bf16 v[152:155], a[92:95], a[56:59], v[152:155]
    ds_read_b64_tr_b16 a[86:87], v6 offset:25696
    s_lshl_b32 s10, s10, 4
    v_mfma_f32_16x16x32_bf16 v[156:159], a[92:95], a[60:63], v[156:159]
    buffer_load_dwordx4 v17, s[24:27], s61 offen offset:1024  lds
    v_mfma_f32_16x16x32_bf16 v[156:159], a[88:91], a[44:47], v[156:159]
    s_waitcnt lgkmcnt(8)
    v_mfma_f32_16x16x32_bf16 v[172:175], a[64:67], a[44:47], v[172:175]
    ds_read_b64_tr_b16 a[88:89], v6 offset:16512
    v_mfma_f32_16x16x32_bf16 v[172:175], a[68:71], a[60:63], v[172:175]
    ds_read_b64_tr_b16 a[90:91], v6 offset:17536
    s_add_u32 s10, s10, s15
    s_lshl_b32 s10, s10, 9
    v_mfma_f32_16x16x32_bf16 v[168:171], a[68:71], a[56:59], v[168:171]
    s_add_u32 m0, s56, 0x108000
    v_mfma_f32_16x16x32_bf16 v[168:171], a[64:67], a[40:43], v[168:171]
    ds_read_b64_tr_b16 a[92:93], v6 offset:24704
    v_mfma_f32_16x16x32_bf16 v[164:167], a[64:67], a[36:39], v[164:167]
    buffer_load_dwordx4 v8, s[20:23], s61 offen offset:0  lds
    v_mfma_f32_16x16x32_bf16 v[164:167], a[68:71], a[52:55], v[164:167]
    ds_read_b64_tr_b16 a[94:95], v6 offset:25728
    v_cndmask_b32 v79, v74, v73, vcc
    v_mfma_f32_16x16x32_bf16 v[160:163], a[68:71], a[48:51], v[160:163]
    buffer_load_dwordx4 v9, s[20:23], s61 offen offset:1024  lds
    v_mfma_f32_16x16x32_bf16 v[160:163], a[64:67], a[32:35], v[160:163]
    s_waitcnt lgkmcnt(8)
    v_mfma_f32_16x16x32_bf16 v[176:179], a[72:75], a[32:35], v[176:179]
    ds_read_b64_tr_b16 a[64:65], v6 offset:16544
    v_mfma_f32_16x16x32_bf16 v[176:179], a[76:79], a[48:51], v[176:179]
    ds_read_b64_tr_b16 a[66:67], v6 offset:17568
    v_mfma_f32_16x16x32_bf16 v[180:183], a[76:79], a[52:55], v[180:183]
    buffer_load_dwordx4 v10, s[20:23], s61 offen offset:2048  lds
    v_mfma_f32_16x16x32_bf16 v[180:183], a[72:75], a[36:39], v[180:183]
    ds_read_b64_tr_b16 a[68:69], v6 offset:24736
    v_mfma_f32_16x16x32_bf16 v[184:187], a[72:75], a[40:43], v[184:187]
    v_lshrrev_b32 v73, 1, v0
    v_mfma_f32_16x16x32_bf16 v[184:187], a[76:79], a[56:59], v[184:187]
    ds_read_b64_tr_b16 a[70:71], v6 offset:25760
    v_and_b32 v72, 1, v0
    v_mfma_f32_16x16x32_bf16 v[188:191], a[76:79], a[60:63], v[188:191]
    buffer_load_dwordx4 v11, s[20:23], s61 offen offset:3072  lds
    v_mfma_f32_16x16x32_bf16 v[188:191], a[72:75], a[44:47], v[188:191]
    s_waitcnt lgkmcnt(8)
    v_mfma_f32_16x16x32_bf16 v[204:207], a[80:83], a[44:47], v[204:207]
    ds_read_b64_tr_b16 a[72:73], v6 offset:16576
    v_lshlrev_b32 v72, 7, v72
    v_mfma_f32_16x16x32_bf16 v[204:207], a[84:87], a[60:63], v[204:207]
    ds_read_b64_tr_b16 a[74:75], v6 offset:17600
    v_mfma_f32_16x16x32_bf16 v[200:203], a[84:87], a[56:59], v[200:203]
    s_add_u32 m0, s56, 0x109000
    v_mfma_f32_16x16x32_bf16 v[200:203], a[80:83], a[40:43], v[200:203]
    ds_read_b64_tr_b16 a[76:77], v6 offset:24768
    v_lshl_add_u32 v73, v73, 11, v72
    v_mfma_f32_16x16x32_bf16 v[196:199], a[80:83], a[36:39], v[196:199]
    buffer_load_dwordx4 v12, s[20:23], s61 offen offset:0  lds
    v_mfma_f32_16x16x32_bf16 v[196:199], a[84:87], a[52:55], v[196:199]
    ds_read_b64_tr_b16 a[78:79], v6 offset:25792
    v_mfma_f32_16x16x32_bf16 v[192:195], a[84:87], a[48:51], v[192:195]
    buffer_load_dwordx4 v13, s[20:23], s61 offen offset:1024  lds
    v_mfma_f32_16x16x32_bf16 v[192:195], a[80:83], a[32:35], v[192:195]
    s_waitcnt lgkmcnt(8)
    v_mfma_f32_16x16x32_bf16 v[208:211], a[88:91], a[32:35], v[208:211]
    v_cmp_gt_u32 vcc, 28, v0
    v_mfma_f32_16x16x32_bf16 v[208:211], a[92:95], a[48:51], v[208:211]
    buffer_load_dwordx4 v14, s[20:23], s61 offen offset:2048  lds
    v_mfma_f32_16x16x32_bf16 v[212:215], a[92:95], a[52:55], v[212:215]
    v_mfma_f32_16x16x32_bf16 v[212:215], a[88:91], a[36:39], v[212:215]
    s_mul_i32 s8, s3, 57344
    s_lshl_b32 s9, s14, 8
    v_mfma_f32_16x16x32_bf16 v[216:219], a[88:91], a[40:43], v[216:219]
    buffer_load_dwordx4 v15, s[20:23], s61 offen offset:3072  lds
    v_mfma_f32_16x16x32_bf16 v[216:219], a[92:95], a[56:59], v[216:219]
    v_mfma_f32_16x16x32_bf16 v[220:223], a[92:95], a[60:63], v[220:223]
    s_add_u32 s8, s8, s9
    s_add_u32 s8, s8, s85
    v_mfma_f32_16x16x32_bf16 v[220:223], a[88:91], a[44:47], v[220:223]
    s_waitcnt vmcnt(14) lgkmcnt(0)
    s_barrier
    v_mfma_f32_16x16x32_bf16 v[236:239], a[64:67], a[44:47], v[236:239]
    ds_read_b128 a[80:83], v4 offset:16384
    v_mfma_f32_16x16x32_bf16 v[236:239], a[68:71], a[60:63], v[236:239]
    ds_read_b128 a[84:87], v5 offset:16384
    v_mfma_f32_16x16x32_bf16 v[232:235], a[68:71], a[56:59], v[232:235]
    ds_read_b128 a[0:3], v2 offset:0
    v_mfma_f32_16x16x32_bf16 v[232:235], a[64:67], a[40:43], v[232:235]
    ds_read_b128 a[16:19], v3 offset:0
    v_mfma_f32_16x16x32_bf16 v[228:231], a[64:67], a[36:39], v[228:231]
    s_add_u32 s8, s8, 0x100000
    s_add_u32 s9, s8, 28672
    v_mfma_f32_16x16x32_bf16 v[228:231], a[68:71], a[52:55], v[228:231]
    ds_read_b128 a[4:7], v2 offset:2048
    v_mfma_f32_16x16x32_bf16 v[224:227], a[68:71], a[48:51], v[224:227]
    ds_read_b128 a[20:23], v3 offset:2048
    v_cndmask_b32 v78, v74, v73, vcc
    v_mfma_f32_16x16x32_bf16 v[224:227], a[64:67], a[32:35], v[224:227]
    v_mfma_f32_16x16x32_bf16 v[240:243], a[72:75], a[32:35], v[240:243]
    ds_read_b128 a[88:91], v4 offset:18432
    v_mfma_f32_16x16x32_bf16 v[240:243], a[76:79], a[48:51], v[240:243]
    ds_read_b128 a[92:95], v5 offset:18432
    v_mfma_f32_16x16x32_bf16 v[244:247], a[76:79], a[52:55], v[244:247]
    ds_read_b128 a[8:11], v2 offset:4096
    v_mfma_f32_16x16x32_bf16 v[244:247], a[72:75], a[36:39], v[244:247]
    ds_read_b128 a[24:27], v3 offset:4096
    v_mfma_f32_16x16x32_bf16 v[248:251], a[72:75], a[40:43], v[248:251]
    ds_read_b128 a[12:15], v2 offset:6144
    v_mfma_f32_16x16x32_bf16 v[248:251], a[76:79], a[56:59], v[248:251]
    ds_read_b128 a[28:31], v3 offset:6144
    v_mfma_f32_16x16x32_bf16 v[252:255], a[76:79], a[60:63], v[252:255]
    v_mfma_f32_16x16x32_bf16 v[252:255], a[72:75], a[44:47], v[252:255]
    s_waitcnt lgkmcnt(6)
    v_mfma_f32_16x16x32_bf16 v[80:83], a[0:3], a[80:83], v[80:83]
    ds_read_b128 a[64:67], v4 offset:20480
    v_mfma_f32_16x16x32_bf16 v[80:83], a[16:19], a[84:87], v[80:83]
    ds_read_b128 a[72:75], v4 offset:22528
    v_mfma_f32_16x16x32_bf16 v[84:87], a[20:23], a[84:87], v[84:87]
    ds_read_b128 a[68:71], v5 offset:20480
    v_mfma_f32_16x16x32_bf16 v[84:87], a[4:7], a[80:83], v[84:87]
    ds_read_b128 a[76:79], v5 offset:22528
    s_waitcnt lgkmcnt(4)
    v_mfma_f32_16x16x32_bf16 v[88:91], a[8:11], a[80:83], v[88:91]
    v_mfma_f32_16x16x32_bf16 v[88:91], a[24:27], a[84:87], v[88:91]
    v_mov_b32 v64, 0
    v_mfma_f32_16x16x32_bf16 v[92:95], a[28:31], a[84:87], v[92:95]
    v_mov_b32 v65, 0x3f803f80
    v_mfma_f32_16x16x32_bf16 v[92:95], a[12:15], a[80:83], v[92:95]
    v_mfma_f32_16x16x32_bf16 v[108:111], a[12:15], a[88:91], v[108:111]
    ds_read_b64_tr_b16 a[80:81], v6 offset:32768
    v_lshlrev_b32 v56, 16, v24
    v_mfma_f32_16x16x32_bf16 v[108:111], a[28:31], a[92:95], v[108:111]
    ds_read_b64_tr_b16 a[82:83], v6 offset:33792
    v_mfma_f32_16x16x32_bf16 v[104:107], a[24:27], a[92:95], v[104:107]
    s_addk_i32 s61, 128
    s_bitset0_b32 s61, 11
    v_and_b32 v57, 0xffff0000, v24
    v_mfma_f32_16x16x32_bf16 v[104:107], a[8:11], a[88:91], v[104:107]
    ds_read_b64_tr_b16 a[84:85], v6 offset:40960
    v_mfma_f32_16x16x32_bf16 v[100:103], a[4:7], a[88:91], v[100:103]
    s_mul_i32 s62, s61, 3584
    v_lshlrev_b32 v58, 16, v40
    v_mfma_f32_16x16x32_bf16 v[100:103], a[20:23], a[92:95], v[100:103]
    ds_read_b64_tr_b16 a[86:87], v6 offset:41984
    v_mfma_f32_16x16x32_bf16 v[96:99], a[16:19], a[92:95], v[96:99]
    s_add_u32 m0, s58, 0x104000
    v_and_b32 v59, 0xffff0000, v40
    v_mfma_f32_16x16x32_bf16 v[96:99], a[0:3], a[88:91], v[96:99]
L_hop_0:
    s_cbranch_execz L_hop_4
    s_nop 0
    s_waitcnt lgkmcnt(5)
    v_mfma_f32_16x16x32_bf16 v[112:115], a[0:3], a[64:67], v[112:115]
    ds_read_b64_tr_b16 a[88:89], v6 offset:32800
    v_mul_f32 v56, v56, v58
    v_mfma_f32_16x16x32_bf16 v[112:115], a[16:19], a[68:71], v[112:115]
    ds_read_b64_tr_b16 a[90:91], v6 offset:33824
    v_mfma_f32_16x16x32_bf16 v[116:119], a[20:23], a[68:71], v[116:119]
    buffer_load_dwordx4 v18, s[28:31], s62 offen offset:0  lds
    v_mul_f32 v57, v57, v59
    v_mfma_f32_16x16x32_bf16 v[116:119], a[4:7], a[64:67], v[116:119]
    ds_read_b64_tr_b16 a[92:93], v6 offset:40992
    v_mfma_f32_16x16x32_bf16 v[120:123], a[8:11], a[64:67], v[120:123]
    buffer_load_dwordx4 v19, s[28:31], s62 offen offset:1024  lds
    v_mfma_f32_16x16x32_bf16 v[120:123], a[24:27], a[68:71], v[120:123]
    ds_read_b64_tr_b16 a[94:95], v6 offset:42016
    v_mfma_f32_16x16x32_bf16 v[124:127], a[28:31], a[68:71], v[124:127]
    v_cvt_pk_bf16_f32 v56, v56, v57
    v_mfma_f32_16x16x32_bf16 v[124:127], a[12:15], a[64:67], v[124:127]
    v_dot2c_f32_bf16 v64, v56, v65
    s_waitcnt lgkmcnt(8)
    v_mfma_f32_16x16x32_bf16 v[140:143], a[12:15], a[72:75], v[140:143]
    ds_read_b64_tr_b16 a[64:65], v6 offset:32832
    v_lshlrev_b32 v60, 16, v25
    v_mfma_f32_16x16x32_bf16 v[140:143], a[28:31], a[76:79], v[140:143]
    ds_read_b64_tr_b16 a[66:67], v6 offset:33856
    v_mfma_f32_16x16x32_bf16 v[136:139], a[24:27], a[76:79], v[136:139]
    buffer_load_dwordx4 v20, s[28:31], s62 offen offset:2048  lds
    v_and_b32 v61, 0xffff0000, v25
    v_mfma_f32_16x16x32_bf16 v[136:139], a[8:11], a[72:75], v[136:139]
    ds_read_b64_tr_b16 a[68:69], v6 offset:41024
    v_mfma_f32_16x16x32_bf16 v[132:135], a[4:7], a[72:75], v[132:135]
    buffer_load_dwordx4 v21, s[28:31], s62 offen offset:3072  lds
    v_lshlrev_b32 v62, 16, v41
    v_mfma_f32_16x16x32_bf16 v[132:135], a[20:23], a[76:79], v[132:135]
    ds_read_b64_tr_b16 a[70:71], v6 offset:42048
    v_mfma_f32_16x16x32_bf16 v[128:131], a[16:19], a[76:79], v[128:131]
    s_add_u32 m0, s57, 0x102000
    v_and_b32 v63, 0xffff0000, v41
    v_mfma_f32_16x16x32_bf16 v[128:131], a[0:3], a[72:75], v[128:131]
    s_waitcnt lgkmcnt(8)
    v_mfma_f32_16x16x32_bf16 v[144:147], a[80:83], a[0:3], v[144:147]
    ds_read_b64_tr_b16 a[72:73], v6 offset:32864
    v_mul_f32 v60, v60, v62
    v_mfma_f32_16x16x32_bf16 v[144:147], a[84:87], a[16:19], v[144:147]
    ds_read_b64_tr_b16 a[74:75], v6 offset:33888
    v_mfma_f32_16x16x32_bf16 v[148:151], a[84:87], a[20:23], v[148:151]
    buffer_load_dwordx4 v16, s[24:27], s61 offen offset:0  lds
    v_mul_f32 v61, v61, v63
    v_mfma_f32_16x16x32_bf16 v[148:151], a[80:83], a[4:7], v[148:151]
    ds_read_b64_tr_b16 a[76:77], v6 offset:41056
    v_mfma_f32_16x16x32_bf16 v[152:155], a[80:83], a[8:11], v[152:155]
    buffer_load_dwordx4 v17, s[24:27], s61 offen offset:1024  lds
    v_mfma_f32_16x16x32_bf16 v[152:155], a[84:87], a[24:27], v[152:155]
    ds_read_b64_tr_b16 a[78:79], v6 offset:42080
    v_mfma_f32_16x16x32_bf16 v[156:159], a[84:87], a[28:31], v[156:159]
    v_cvt_pk_bf16_f32 v60, v60, v61
    v_mfma_f32_16x16x32_bf16 v[156:159], a[80:83], a[12:15], v[156:159]
    v_dot2c_f32_bf16 v64, v60, v65
    s_waitcnt lgkmcnt(8)
    v_mfma_f32_16x16x32_bf16 v[172:175], a[88:91], a[12:15], v[172:175]
    ds_read_b64_tr_b16 a[80:81], v6 offset:32896
    v_lshlrev_b32 v56, 16, v26
    v_mfma_f32_16x16x32_bf16 v[172:175], a[92:95], a[28:31], v[172:175]
    ds_read_b64_tr_b16 a[82:83], v6 offset:33920
    v_mfma_f32_16x16x32_bf16 v[168:171], a[92:95], a[24:27], v[168:171]
    s_add_u32 m0, s56, 0x100000
    v_and_b32 v57, 0xffff0000, v26
    v_mfma_f32_16x16x32_bf16 v[168:171], a[88:91], a[8:11], v[168:171]
    ds_read_b64_tr_b16 a[84:85], v6 offset:41088
    v_mfma_f32_16x16x32_bf16 v[164:167], a[88:91], a[4:7], v[164:167]
    buffer_load_dwordx4 v8, s[20:23], s61 offen offset:0  lds
    v_lshlrev_b32 v58, 16, v42
    v_mfma_f32_16x16x32_bf16 v[164:167], a[92:95], a[20:23], v[164:167]
    ds_read_b64_tr_b16 a[86:87], v6 offset:42112
    v_mfma_f32_16x16x32_bf16 v[160:163], a[92:95], a[16:19], v[160:163]
    buffer_load_dwordx4 v9, s[20:23], s61 offen offset:1024  lds
    v_and_b32 v59, 0xffff0000, v42
    v_mfma_f32_16x16x32_bf16 v[160:163], a[88:91], a[0:3], v[160:163]
    s_waitcnt lgkmcnt(8)
    v_mfma_f32_16x16x32_bf16 v[176:179], a[64:67], a[0:3], v[176:179]
    ds_read_b64_tr_b16 a[88:89], v6 offset:32928
    v_mul_f32 v56, v56, v58
    v_mfma_f32_16x16x32_bf16 v[176:179], a[68:71], a[16:19], v[176:179]
    ds_read_b64_tr_b16 a[90:91], v6 offset:33952
    v_mfma_f32_16x16x32_bf16 v[180:183], a[68:71], a[20:23], v[180:183]
    buffer_load_dwordx4 v10, s[20:23], s61 offen offset:2048  lds
    v_mul_f32 v57, v57, v59
    v_mfma_f32_16x16x32_bf16 v[180:183], a[64:67], a[4:7], v[180:183]
    ds_read_b64_tr_b16 a[92:93], v6 offset:41120
    v_mfma_f32_16x16x32_bf16 v[184:187], a[64:67], a[8:11], v[184:187]
    buffer_load_dwordx4 v11, s[20:23], s61 offen offset:3072  lds
    v_mfma_f32_16x16x32_bf16 v[184:187], a[68:71], a[24:27], v[184:187]
    ds_read_b64_tr_b16 a[94:95], v6 offset:42144
    v_mfma_f32_16x16x32_bf16 v[188:191], a[68:71], a[28:31], v[188:191]
    v_cvt_pk_bf16_f32 v56, v56, v57
    v_mfma_f32_16x16x32_bf16 v[188:191], a[64:67], a[12:15], v[188:191]
    v_dot2c_f32_bf16 v64, v56, v65
    s_waitcnt lgkmcnt(8)
    v_mfma_f32_16x16x32_bf16 v[204:207], a[72:75], a[12:15], v[204:207]
    ds_read_b64_tr_b16 a[64:65], v6 offset:32960
    v_lshlrev_b32 v60, 16, v27
    v_mfma_f32_16x16x32_bf16 v[204:207], a[76:79], a[28:31], v[204:207]
    ds_read_b64_tr_b16 a[66:67], v6 offset:33984
    v_mfma_f32_16x16x32_bf16 v[200:203], a[76:79], a[24:27], v[200:203]
    s_add_u32 m0, s56, 0x101000
    v_and_b32 v61, 0xffff0000, v27
    v_mfma_f32_16x16x32_bf16 v[200:203], a[72:75], a[8:11], v[200:203]
    ds_read_b64_tr_b16 a[68:69], v6 offset:41152
    v_mfma_f32_16x16x32_bf16 v[196:199], a[72:75], a[4:7], v[196:199]
    buffer_load_dwordx4 v12, s[20:23], s61 offen offset:0  lds
    v_lshlrev_b32 v62, 16, v43
    v_mfma_f32_16x16x32_bf16 v[196:199], a[76:79], a[20:23], v[196:199]
    ds_read_b64_tr_b16 a[70:71], v6 offset:42176
    v_mfma_f32_16x16x32_bf16 v[192:195], a[76:79], a[16:19], v[192:195]
    buffer_load_dwordx4 v13, s[20:23], s61 offen offset:1024  lds
    v_mfma_f32_16x16x32_bf16 v[192:195], a[72:75], a[0:3], v[192:195]
    s_waitcnt lgkmcnt(8)
    v_mfma_f32_16x16x32_bf16 v[208:211], a[80:83], a[0:3], v[208:211]
    v_and_b32 v63, 0xffff0000, v43
    v_mfma_f32_16x16x32_bf16 v[208:211], a[84:87], a[16:19], v[208:211]
    buffer_load_dwordx4 v14, s[20:23], s61 offen offset:2048  lds
    v_mfma_f32_16x16x32_bf16 v[212:215], a[84:87], a[20:23], v[212:215]
    v_mul_f32 v60, v60, v62
    v_mfma_f32_16x16x32_bf16 v[212:215], a[80:83], a[4:7], v[212:215]
    v_mul_f32 v61, v61, v63
    v_mfma_f32_16x16x32_bf16 v[216:219], a[80:83], a[8:11], v[216:219]
    buffer_load_dwordx4 v15, s[20:23], s61 offen offset:3072  lds
    v_mfma_f32_16x16x32_bf16 v[216:219], a[84:87], a[24:27], v[216:219]
    v_cvt_pk_bf16_f32 v60, v60, v61
    v_mfma_f32_16x16x32_bf16 v[220:223], a[84:87], a[28:31], v[220:223]
    v_dot2c_f32_bf16 v64, v60, v65
    v_mfma_f32_16x16x32_bf16 v[220:223], a[80:83], a[12:15], v[220:223]
    s_waitcnt vmcnt(14) lgkmcnt(0)
    s_barrier
    v_mfma_f32_16x16x32_bf16 v[236:239], a[88:91], a[12:15], v[236:239]
    ds_read_b128 a[72:75], v4 offset:0
    v_mfma_f32_16x16x32_bf16 v[236:239], a[92:95], a[28:31], v[236:239]
    ds_read_b128 a[76:79], v5 offset:0
    v_mfma_f32_16x16x32_bf16 v[232:235], a[92:95], a[24:27], v[232:235]
    ds_read_b128 a[32:35], v2 offset:32768
    v_mfma_f32_16x16x32_bf16 v[232:235], a[88:91], a[8:11], v[232:235]
    ds_read_b128 a[48:51], v3 offset:32768
    v_mfma_f32_16x16x32_bf16 v[228:231], a[88:91], a[4:7], v[228:231]
    v_lshlrev_b32 v56, 16, v28
    v_mfma_f32_16x16x32_bf16 v[228:231], a[92:95], a[20:23], v[228:231]
    ds_read_b128 a[36:39], v2 offset:34816
    v_and_b32 v57, 0xffff0000, v28
    v_mfma_f32_16x16x32_bf16 v[224:227], a[92:95], a[16:19], v[224:227]
    ds_read_b128 a[52:55], v3 offset:34816
    v_mfma_f32_16x16x32_bf16 v[224:227], a[88:91], a[0:3], v[224:227]
    v_lshlrev_b32 v58, 16, v44
    v_mfma_f32_16x16x32_bf16 v[240:243], a[64:67], a[0:3], v[240:243]
    ds_read_b128 a[80:83], v4 offset:2048
    v_mfma_f32_16x16x32_bf16 v[240:243], a[68:71], a[16:19], v[240:243]
    ds_read_b128 a[84:87], v5 offset:2048
    v_and_b32 v59, 0xffff0000, v44
    v_mfma_f32_16x16x32_bf16 v[244:247], a[68:71], a[20:23], v[244:247]
    ds_read_b128 a[40:43], v2 offset:36864
    v_mfma_f32_16x16x32_bf16 v[244:247], a[64:67], a[4:7], v[244:247]
    ds_read_b128 a[56:59], v3 offset:36864
    v_mfma_f32_16x16x32_bf16 v[248:251], a[64:67], a[8:11], v[248:251]
    ds_read_b128 a[44:47], v2 offset:38912
    v_mfma_f32_16x16x32_bf16 v[248:251], a[68:71], a[24:27], v[248:251]
    ds_read_b128 a[60:63], v3 offset:38912
    v_mfma_f32_16x16x32_bf16 v[252:255], a[68:71], a[28:31], v[252:255]
    v_mul_f32 v56, v56, v58
    v_mfma_f32_16x16x32_bf16 v[252:255], a[64:67], a[12:15], v[252:255]
    v_mul_f32 v57, v57, v59
    s_waitcnt lgkmcnt(6)
    v_mfma_f32_16x16x32_bf16 v[80:83], a[32:35], a[72:75], v[80:83]
    ds_read_b128 a[88:91], v4 offset:4096
    v_cvt_pk_bf16_f32 v56, v56, v57
    v_mfma_f32_16x16x32_bf16 v[80:83], a[48:51], a[76:79], v[80:83]
    ds_read_b128 a[64:67], v4 offset:6144
    v_mfma_f32_16x16x32_bf16 v[84:87], a[52:55], a[76:79], v[84:87]
    ds_read_b128 a[92:95], v5 offset:4096
    v_mfma_f32_16x16x32_bf16 v[84:87], a[36:39], a[72:75], v[84:87]
    ds_read_b128 a[68:71], v5 offset:6144
    s_waitcnt lgkmcnt(4)
    v_mfma_f32_16x16x32_bf16 v[88:91], a[40:43], a[72:75], v[88:91]
    v_dot2c_f32_bf16 v64, v56, v65
    v_mfma_f32_16x16x32_bf16 v[88:91], a[56:59], a[76:79], v[88:91]
    v_lshlrev_b32 v60, 16, v29
    v_mfma_f32_16x16x32_bf16 v[92:95], a[60:63], a[76:79], v[92:95]
    v_mfma_f32_16x16x32_bf16 v[92:95], a[44:47], a[72:75], v[92:95]
    v_and_b32 v61, 0xffff0000, v29
    v_mfma_f32_16x16x32_bf16 v[108:111], a[44:47], a[80:83], v[108:111]
    ds_read_b64_tr_b16 a[72:73], v6 offset:0
    v_mfma_f32_16x16x32_bf16 v[108:111], a[60:63], a[84:87], v[108:111]
    ds_read_b64_tr_b16 a[74:75], v6 offset:1024
    v_lshlrev_b32 v62, 16, v45
    v_mfma_f32_16x16x32_bf16 v[104:107], a[56:59], a[84:87], v[104:107]
    s_addk_i32 s61, 128
    s_bitset0_b32 s61, 11
    v_mfma_f32_16x16x32_bf16 v[104:107], a[40:43], a[80:83], v[104:107]
    ds_read_b64_tr_b16 a[76:77], v6 offset:8192
    v_and_b32 v63, 0xffff0000, v45
    v_mfma_f32_16x16x32_bf16 v[100:103], a[36:39], a[80:83], v[100:103]
    s_mul_i32 s62, s61, 3584
    v_mfma_f32_16x16x32_bf16 v[100:103], a[52:55], a[84:87], v[100:103]
    ds_read_b64_tr_b16 a[78:79], v6 offset:9216
    v_mul_f32 v60, v60, v62
    v_mfma_f32_16x16x32_bf16 v[96:99], a[48:51], a[84:87], v[96:99]
    s_add_u32 m0, s58, 0x108000
    v_mfma_f32_16x16x32_bf16 v[96:99], a[32:35], a[80:83], v[96:99]
    v_mul_f32 v61, v61, v63
    s_waitcnt lgkmcnt(5)
    v_mfma_f32_16x16x32_bf16 v[112:115], a[32:35], a[88:91], v[112:115]
    ds_read_b64_tr_b16 a[80:81], v6 offset:32
    v_mfma_f32_16x16x32_bf16 v[112:115], a[48:51], a[92:95], v[112:115]
    ds_read_b64_tr_b16 a[82:83], v6 offset:1056
    v_mfma_f32_16x16x32_bf16 v[116:119], a[52:55], a[92:95], v[116:119]
    buffer_load_dwordx4 v18, s[28:31], s62 offen offset:0  lds
    v_cvt_pk_bf16_f32 v60, v60, v61
    v_mfma_f32_16x16x32_bf16 v[116:119], a[36:39], a[88:91], v[116:119]
    ds_read_b64_tr_b16 a[84:85], v6 offset:8224
    v_mfma_f32_16x16x32_bf16 v[120:123], a[40:43], a[88:91], v[120:123]
    buffer_load_dwordx4 v19, s[28:31], s62 offen offset:1024  lds
    v_mfma_f32_16x16x32_bf16 v[120:123], a[56:59], a[92:95], v[120:123]
    ds_read_b64_tr_b16 a[86:87], v6 offset:9248
    v_mfma_f32_16x16x32_bf16 v[124:127], a[60:63], a[92:95], v[124:127]
    v_dot2c_f32_bf16 v64, v60, v65
    v_mfma_f32_16x16x32_bf16 v[124:127], a[44:47], a[88:91], v[124:127]
    v_lshlrev_b32 v56, 16, v30
    s_waitcnt lgkmcnt(8)
    v_mfma_f32_16x16x32_bf16 v[140:143], a[44:47], a[64:67], v[140:143]
    ds_read_b64_tr_b16 a[88:89], v6 offset:64
    v_and_b32 v57, 0xffff0000, v30
    v_mfma_f32_16x16x32_bf16 v[140:143], a[60:63], a[68:71], v[140:143]
    ds_read_b64_tr_b16 a[90:91], v6 offset:1088
    v_mfma_f32_16x16x32_bf16 v[136:139], a[56:59], a[68:71], v[136:139]
    buffer_load_dwordx4 v20, s[28:31], s62 offen offset:2048  lds
    v_mfma_f32_16x16x32_bf16 v[136:139], a[40:43], a[64:67], v[136:139]
    ds_read_b64_tr_b16 a[92:93], v6 offset:8256
    v_lshlrev_b32 v58, 16, v46
    v_mfma_f32_16x16x32_bf16 v[132:135], a[36:39], a[64:67], v[132:135]
    buffer_load_dwordx4 v21, s[28:31], s62 offen offset:3072  lds
    v_mfma_f32_16x16x32_bf16 v[132:135], a[52:55], a[68:71], v[132:135]
    ds_read_b64_tr_b16 a[94:95], v6 offset:9280
    v_and_b32 v59, 0xffff0000, v46
    v_mfma_f32_16x16x32_bf16 v[128:131], a[48:51], a[68:71], v[128:131]
    s_add_u32 m0, s57, 0x104000
    v_mfma_f32_16x16x32_bf16 v[128:131], a[32:35], a[64:67], v[128:131]
    v_mul_f32 v56, v56, v58
    s_waitcnt lgkmcnt(8)
    v_mfma_f32_16x16x32_bf16 v[144:147], a[72:75], a[32:35], v[144:147]
    ds_read_b64_tr_b16 a[64:65], v6 offset:96
    v_mfma_f32_16x16x32_bf16 v[144:147], a[76:79], a[48:51], v[144:147]
    ds_read_b64_tr_b16 a[66:67], v6 offset:1120
    v_mul_f32 v57, v57, v59
    v_mfma_f32_16x16x32_bf16 v[148:151], a[76:79], a[52:55], v[148:151]
    buffer_load_dwordx4 v16, s[24:27], s61 offen offset:0  lds
    v_mfma_f32_16x16x32_bf16 v[148:151], a[72:75], a[36:39], v[148:151]
    ds_read_b64_tr_b16 a[68:69], v6 offset:8288
    v_mfma_f32_16x16x32_bf16 v[152:155], a[72:75], a[40:43], v[152:155]
    buffer_load_dwordx4 v17, s[24:27], s61 offen offset:1024  lds
    v_mfma_f32_16x16x32_bf16 v[152:155], a[76:79], a[56:59], v[152:155]
    ds_read_b64_tr_b16 a[70:71], v6 offset:9312
    v_mfma_f32_16x16x32_bf16 v[156:159], a[76:79], a[60:63], v[156:159]
    v_cvt_pk_bf16_f32 v56, v56, v57
    v_mfma_f32_16x16x32_bf16 v[156:159], a[72:75], a[44:47], v[156:159]
    v_dot2c_f32_bf16 v64, v56, v65
    s_waitcnt lgkmcnt(8)
    v_mfma_f32_16x16x32_bf16 v[172:175], a[80:83], a[44:47], v[172:175]
    ds_read_b64_tr_b16 a[72:73], v6 offset:128
    v_lshlrev_b32 v60, 16, v31
    v_mfma_f32_16x16x32_bf16 v[172:175], a[84:87], a[60:63], v[172:175]
    ds_read_b64_tr_b16 a[74:75], v6 offset:1152
    v_mfma_f32_16x16x32_bf16 v[168:171], a[84:87], a[56:59], v[168:171]
    s_add_u32 m0, s56, 0x108000
    v_and_b32 v61, 0xffff0000, v31
    v_mfma_f32_16x16x32_bf16 v[168:171], a[80:83], a[40:43], v[168:171]
    ds_read_b64_tr_b16 a[76:77], v6 offset:8320
    v_mfma_f32_16x16x32_bf16 v[164:167], a[80:83], a[36:39], v[164:167]
    buffer_load_dwordx4 v8, s[20:23], s61 offen offset:0  lds
    v_lshlrev_b32 v62, 16, v47
    v_mfma_f32_16x16x32_bf16 v[164:167], a[84:87], a[52:55], v[164:167]
    ds_read_b64_tr_b16 a[78:79], v6 offset:9344
    v_mfma_f32_16x16x32_bf16 v[160:163], a[84:87], a[48:51], v[160:163]
    buffer_load_dwordx4 v9, s[20:23], s61 offen offset:1024  lds
    v_and_b32 v63, 0xffff0000, v47
    v_mfma_f32_16x16x32_bf16 v[160:163], a[80:83], a[32:35], v[160:163]
    s_waitcnt lgkmcnt(8)
    v_mfma_f32_16x16x32_bf16 v[176:179], a[88:91], a[32:35], v[176:179]
    ds_read_b64_tr_b16 a[80:81], v6 offset:160
    v_mfma_f32_16x16x32_bf16 v[176:179], a[92:95], a[48:51], v[176:179]
    ds_read_b64_tr_b16 a[82:83], v6 offset:1184
    v_mul_f32 v60, v60, v62
    v_mfma_f32_16x16x32_bf16 v[180:183], a[92:95], a[52:55], v[180:183]
    buffer_load_dwordx4 v10, s[20:23], s61 offen offset:2048  lds
    v_mfma_f32_16x16x32_bf16 v[180:183], a[88:91], a[36:39], v[180:183]
    ds_read_b64_tr_b16 a[84:85], v6 offset:8352
    v_mul_f32 v61, v61, v63
    v_mfma_f32_16x16x32_bf16 v[184:187], a[88:91], a[40:43], v[184:187]
    buffer_load_dwordx4 v11, s[20:23], s61 offen offset:3072  lds
    v_mfma_f32_16x16x32_bf16 v[184:187], a[92:95], a[56:59], v[184:187]
    ds_read_b64_tr_b16 a[86:87], v6 offset:9376
    v_mfma_f32_16x16x32_bf16 v[188:191], a[92:95], a[60:63], v[188:191]
    v_cvt_pk_bf16_f32 v60, v60, v61
    v_mfma_f32_16x16x32_bf16 v[188:191], a[88:91], a[44:47], v[188:191]
    v_dot2c_f32_bf16 v64, v60, v65
    s_waitcnt lgkmcnt(8)
    v_mfma_f32_16x16x32_bf16 v[204:207], a[64:67], a[44:47], v[204:207]
    ds_read_b64_tr_b16 a[88:89], v6 offset:192
    v_mfma_f32_16x16x32_bf16 v[204:207], a[68:71], a[60:63], v[204:207]
    ds_read_b64_tr_b16 a[90:91], v6 offset:1216
    v_mfma_f32_16x16x32_bf16 v[200:203], a[68:71], a[56:59], v[200:203]
    s_add_u32 m0, s56, 0x109000
    v_mfma_f32_16x16x32_bf16 v[200:203], a[64:67], a[40:43], v[200:203]
    ds_read_b64_tr_b16 a[92:93], v6 offset:8384
    v_mfma_f32_16x16x32_bf16 v[196:199], a[64:67], a[36:39], v[196:199]
    buffer_load_dwordx4 v12, s[20:23], s61 offen offset:0  lds
    v_lshlrev_b32 v56, 16, v32
    v_mfma_f32_16x16x32_bf16 v[196:199], a[68:71], a[52:55], v[196:199]
    ds_read_b64_tr_b16 a[94:95], v6 offset:9408
    v_mfma_f32_16x16x32_bf16 v[192:195], a[68:71], a[48:51], v[192:195]
    buffer_load_dwordx4 v13, s[20:23], s61 offen offset:1024  lds
    v_mfma_f32_16x16x32_bf16 v[192:195], a[64:67], a[32:35], v[192:195]
    s_waitcnt lgkmcnt(8)
    v_mfma_f32_16x16x32_bf16 v[208:211], a[72:75], a[32:35], v[208:211]
    v_and_b32 v57, 0xffff0000, v32
    v_mfma_f32_16x16x32_bf16 v[208:211], a[76:79], a[48:51], v[208:211]
    buffer_load_dwordx4 v14, s[20:23], s61 offen offset:2048  lds
    v_mfma_f32_16x16x32_bf16 v[212:215], a[76:79], a[52:55], v[212:215]
    v_lshlrev_b32 v58, 16, v48
    v_mfma_f32_16x16x32_bf16 v[212:215], a[72:75], a[36:39], v[212:215]
    v_and_b32 v59, 0xffff0000, v48
    v_mfma_f32_16x16x32_bf16 v[216:219], a[72:75], a[40:43], v[216:219]
    buffer_load_dwordx4 v15, s[20:23], s61 offen offset:3072  lds
    v_mfma_f32_16x16x32_bf16 v[216:219], a[76:79], a[56:59], v[216:219]
    v_mul_f32 v56, v56, v58
    v_mfma_f32_16x16x32_bf16 v[220:223], a[76:79], a[60:63], v[220:223]
    v_mfma_f32_16x16x32_bf16 v[220:223], a[72:75], a[44:47], v[220:223]
    v_mul_f32 v57, v57, v59
    s_waitcnt vmcnt(14) lgkmcnt(0)
    s_barrier
    v_mfma_f32_16x16x32_bf16 v[236:239], a[80:83], a[44:47], v[236:239]
    ds_read_b128 a[64:67], v4 offset:8192
    v_mfma_f32_16x16x32_bf16 v[236:239], a[84:87], a[60:63], v[236:239]
    ds_read_b128 a[68:71], v5 offset:8192
    v_cvt_pk_bf16_f32 v56, v56, v57
    v_mfma_f32_16x16x32_bf16 v[232:235], a[84:87], a[56:59], v[232:235]
    ds_read_b128 a[0:3], v2 offset:0
    v_mfma_f32_16x16x32_bf16 v[232:235], a[80:83], a[40:43], v[232:235]
    ds_read_b128 a[16:19], v3 offset:0
    v_mfma_f32_16x16x32_bf16 v[228:231], a[80:83], a[36:39], v[228:231]
    v_dot2c_f32_bf16 v64, v56, v65
    v_mfma_f32_16x16x32_bf16 v[228:231], a[84:87], a[52:55], v[228:231]
    ds_read_b128 a[4:7], v2 offset:2048
    v_lshlrev_b32 v60, 16, v33
    v_mfma_f32_16x16x32_bf16 v[224:227], a[84:87], a[48:51], v[224:227]
    ds_read_b128 a[20:23], v3 offset:2048
    v_mfma_f32_16x16x32_bf16 v[224:227], a[80:83], a[32:35], v[224:227]
    v_mfma_f32_16x16x32_bf16 v[240:243], a[88:91], a[32:35], v[240:243]
    ds_read_b128 a[72:75], v4 offset:10240
    v_and_b32 v61, 0xffff0000, v33
    v_mfma_f32_16x16x32_bf16 v[240:243], a[92:95], a[48:51], v[240:243]
    ds_read_b128 a[76:79], v5 offset:10240
    v_mfma_f32_16x16x32_bf16 v[244:247], a[92:95], a[52:55], v[244:247]
    ds_read_b128 a[8:11], v2 offset:4096
    v_lshlrev_b32 v62, 16, v49
    v_mfma_f32_16x16x32_bf16 v[244:247], a[88:91], a[36:39], v[244:247]
    ds_read_b128 a[24:27], v3 offset:4096
    v_mfma_f32_16x16x32_bf16 v[248:251], a[88:91], a[40:43], v[248:251]
    ds_read_b128 a[12:15], v2 offset:6144
    v_mfma_f32_16x16x32_bf16 v[248:251], a[92:95], a[56:59], v[248:251]
    ds_read_b128 a[28:31], v3 offset:6144
    v_mfma_f32_16x16x32_bf16 v[252:255], a[92:95], a[60:63], v[252:255]
    v_and_b32 v63, 0xffff0000, v49
    v_mfma_f32_16x16x32_bf16 v[252:255], a[88:91], a[44:47], v[252:255]
    v_mul_f32 v60, v60, v62
    s_waitcnt lgkmcnt(6)
    v_mfma_f32_16x16x32_bf16 v[80:83], a[0:3], a[64:67], v[80:83]
    ds_read_b128 a[80:83], v4 offset:12288
    v_mul_f32 v61, v61, v63
    v_mfma_f32_16x16x32_bf16 v[80:83], a[16:19], a[68:71], v[80:83]
    ds_read_b128 a[88:91], v4 offset:14336
    v_mfma_f32_16x16x32_bf16 v[84:87], a[20:23], a[68:71], v[84:87]
    ds_read_b128 a[84:87], v5 offset:12288
    v_mfma_f32_16x16x32_bf16 v[84:87], a[4:7], a[64:67], v[84:87]
    ds_read_b128 a[92:95], v5 offset:14336
    s_waitcnt lgkmcnt(4)
    v_mfma_f32_16x16x32_bf16 v[88:91], a[8:11], a[64:67], v[88:91]
    v_cvt_pk_bf16_f32 v60, v60, v61
    v_mfma_f32_16x16x32_bf16 v[88:91], a[24:27], a[68:71], v[88:91]
    v_dot2c_f32_bf16 v64, v60, v65
    v_mfma_f32_16x16x32_bf16 v[92:95], a[28:31], a[68:71], v[92:95]
    v_mfma_f32_16x16x32_bf16 v[92:95], a[12:15], a[64:67], v[92:95]
    v_lshlrev_b32 v56, 16, v34
    v_mfma_f32_16x16x32_bf16 v[108:111], a[12:15], a[72:75], v[108:111]
    ds_read_b64_tr_b16 a[64:65], v6 offset:16384
    v_mfma_f32_16x16x32_bf16 v[108:111], a[28:31], a[76:79], v[108:111]
    ds_read_b64_tr_b16 a[66:67], v6 offset:17408
    v_and_b32 v57, 0xffff0000, v34
    v_mfma_f32_16x16x32_bf16 v[104:107], a[24:27], a[76:79], v[104:107]
    s_addk_i32 s61, 128
    s_bitset0_b32 s61, 11
    v_mfma_f32_16x16x32_bf16 v[104:107], a[8:11], a[72:75], v[104:107]
    ds_read_b64_tr_b16 a[68:69], v6 offset:24576
    v_mfma_f32_16x16x32_bf16 v[100:103], a[4:7], a[72:75], v[100:103]
    s_mul_i32 s62, s61, 3584
    v_lshlrev_b32 v58, 16, v50
    v_mfma_f32_16x16x32_bf16 v[100:103], a[20:23], a[76:79], v[100:103]
    ds_read_b64_tr_b16 a[70:71], v6 offset:25600
    v_mfma_f32_16x16x32_bf16 v[96:99], a[16:19], a[76:79], v[96:99]
    s_add_u32 m0, s58, 0x100000
    v_and_b32 v59, 0xffff0000, v50
    v_mfma_f32_16x16x32_bf16 v[96:99], a[0:3], a[72:75], v[96:99]
    s_waitcnt lgkmcnt(5)
    v_mfma_f32_16x16x32_bf16 v[112:115], a[0:3], a[80:83], v[112:115]
    ds_read_b64_tr_b16 a[72:73], v6 offset:16416
    v_mul_f32 v56, v56, v58
    v_mfma_f32_16x16x32_bf16 v[112:115], a[16:19], a[84:87], v[112:115]
    ds_read_b64_tr_b16 a[74:75], v6 offset:17440
    v_mfma_f32_16x16x32_bf16 v[116:119], a[20:23], a[84:87], v[116:119]
    buffer_load_dwordx4 v18, s[28:31], s62 offen offset:0  lds
    v_mul_f32 v57, v57, v59
    v_mfma_f32_16x16x32_bf16 v[116:119], a[4:7], a[80:83], v[116:119]
    ds_read_b64_tr_b16 a[76:77], v6 offset:24608
    v_mfma_f32_16x16x32_bf16 v[120:123], a[8:11], a[80:83], v[120:123]
    buffer_load_dwordx4 v19, s[28:31], s62 offen offset:1024  lds
    v_mfma_f32_16x16x32_bf16 v[120:123], a[24:27], a[84:87], v[120:123]
    ds_read_b64_tr_b16 a[78:79], v6 offset:25632
    v_mfma_f32_16x16x32_bf16 v[124:127], a[28:31], a[84:87], v[124:127]
    v_cvt_pk_bf16_f32 v56, v56, v57
    v_mfma_f32_16x16x32_bf16 v[124:127], a[12:15], a[80:83], v[124:127]
    v_dot2c_f32_bf16 v64, v56, v65
    s_waitcnt lgkmcnt(8)
    v_mfma_f32_16x16x32_bf16 v[140:143], a[12:15], a[88:91], v[140:143]
    ds_read_b64_tr_b16 a[80:81], v6 offset:16448
    v_mfma_f32_16x16x32_bf16 v[140:143], a[28:31], a[92:95], v[140:143]
    ds_read_b64_tr_b16 a[82:83], v6 offset:17472
    v_lshlrev_b32 v60, 16, v35
    v_mfma_f32_16x16x32_bf16 v[136:139], a[24:27], a[92:95], v[136:139]
    buffer_load_dwordx4 v20, s[28:31], s62 offen offset:2048  lds
    v_mfma_f32_16x16x32_bf16 v[136:139], a[8:11], a[88:91], v[136:139]
    ds_read_b64_tr_b16 a[84:85], v6 offset:24640
    v_and_b32 v61, 0xffff0000, v35
    v_mfma_f32_16x16x32_bf16 v[132:135], a[4:7], a[88:91], v[132:135]
    buffer_load_dwordx4 v21, s[28:31], s62 offen offset:3072  lds
    v_mfma_f32_16x16x32_bf16 v[132:135], a[20:23], a[92:95], v[132:135]
    ds_read_b64_tr_b16 a[86:87], v6 offset:25664
    v_lshlrev_b32 v62, 16, v51
    v_mfma_f32_16x16x32_bf16 v[128:131], a[16:19], a[92:95], v[128:131]
    s_add_u32 m0, s57, 0x100000
    v_mfma_f32_16x16x32_bf16 v[128:131], a[0:3], a[88:91], v[128:131]
    v_and_b32 v63, 0xffff0000, v51
    s_waitcnt lgkmcnt(8)
    v_mfma_f32_16x16x32_bf16 v[144:147], a[64:67], a[0:3], v[144:147]
    ds_read_b64_tr_b16 a[88:89], v6 offset:16480
    v_mfma_f32_16x16x32_bf16 v[144:147], a[68:71], a[16:19], v[144:147]
    ds_read_b64_tr_b16 a[90:91], v6 offset:17504
    v_mfma_f32_16x16x32_bf16 v[148:151], a[68:71], a[20:23], v[148:151]
    buffer_load_dwordx4 v16, s[24:27], s61 offen offset:0  lds
    v_mul_f32 v60, v60, v62
    v_mfma_f32_16x16x32_bf16 v[148:151], a[64:67], a[4:7], v[148:151]
    ds_read_b64_tr_b16 a[92:93], v6 offset:24672
    v_mfma_f32_16x16x32_bf16 v[152:155], a[64:67], a[8:11], v[152:155]
    buffer_load_dwordx4 v17, s[24:27], s61 offen offset:1024  lds
    v_mfma_f32_16x16x32_bf16 v[152:155], a[68:71], a[24:27], v[152:155]
    ds_read_b64_tr_b16 a[94:95], v6 offset:25696
    v_mfma_f32_16x16x32_bf16 v[156:159], a[68:71], a[28:31], v[156:159]
    v_mul_f32 v61, v61, v63
    v_mfma_f32_16x16x32_bf16 v[156:159], a[64:67], a[12:15], v[156:159]
    v_cvt_pk_bf16_f32 v60, v60, v61
    s_waitcnt lgkmcnt(8)
    v_mfma_f32_16x16x32_bf16 v[172:175], a[72:75], a[12:15], v[172:175]
    ds_read_b64_tr_b16 a[64:65], v6 offset:16512
    v_dot2c_f32_bf16 v64, v60, v65
    v_mfma_f32_16x16x32_bf16 v[172:175], a[76:79], a[28:31], v[172:175]
    ds_read_b64_tr_b16 a[66:67], v6 offset:17536
    v_mfma_f32_16x16x32_bf16 v[168:171], a[76:79], a[24:27], v[168:171]
    s_add_u32 m0, s56, 0x100000
    v_mfma_f32_16x16x32_bf16 v[168:171], a[72:75], a[8:11], v[168:171]
    ds_read_b64_tr_b16 a[68:69], v6 offset:24704
    v_mfma_f32_16x16x32_bf16 v[164:167], a[72:75], a[4:7], v[164:167]
    buffer_load_dwordx4 v8, s[20:23], s61 offen offset:0  lds
    v_mfma_f32_16x16x32_bf16 v[164:167], a[76:79], a[20:23], v[164:167]
    ds_read_b64_tr_b16 a[70:71], v6 offset:25728
    v_lshlrev_b32 v56, 16, v36
    v_mfma_f32_16x16x32_bf16 v[160:163], a[76:79], a[16:19], v[160:163]
    buffer_load_dwordx4 v9, s[20:23], s61 offen offset:1024  lds
    v_mfma_f32_16x16x32_bf16 v[160:163], a[72:75], a[0:3], v[160:163]
    v_and_b32 v57, 0xffff0000, v36
    s_waitcnt lgkmcnt(8)
    v_mfma_f32_16x16x32_bf16 v[176:179], a[80:83], a[0:3], v[176:179]
    ds_read_b64_tr_b16 a[72:73], v6 offset:16544
    v_mfma_f32_16x16x32_bf16 v[176:179], a[84:87], a[16:19], v[176:179]
    ds_read_b64_tr_b16 a[74:75], v6 offset:17568
    v_lshlrev_b32 v58, 16, v52
    v_mfma_f32_16x16x32_bf16 v[180:183], a[84:87], a[20:23], v[180:183]
    buffer_load_dwordx4 v10, s[20:23], s61 offen offset:2048  lds
    v_mfma_f32_16x16x32_bf16 v[180:183], a[80:83], a[4:7], v[180:183]
    ds_read_b64_tr_b16 a[76:77], v6 offset:24736
    v_and_b32 v59, 0xffff0000, v52
    v_mfma_f32_16x16x32_bf16 v[184:187], a[80:83], a[8:11], v[184:187]
    buffer_load_dwordx4 v11, s[20:23], s61 offen offset:3072  lds
    v_mfma_f32_16x16x32_bf16 v[184:187], a[84:87], a[24:27], v[184:187]
    ds_read_b64_tr_b16 a[78:79], v6 offset:25760
    v_mfma_f32_16x16x32_bf16 v[188:191], a[84:87], a[28:31], v[188:191]
    v_mul_f32 v56, v56, v58
    v_mfma_f32_16x16x32_bf16 v[188:191], a[80:83], a[12:15], v[188:191]
    v_mul_f32 v57, v57, v59
    s_waitcnt lgkmcnt(8)
    v_mfma_f32_16x16x32_bf16 v[204:207], a[88:91], a[12:15], v[204:207]
    ds_read_b64_tr_b16 a[80:81], v6 offset:16576
    v_mfma_f32_16x16x32_bf16 v[204:207], a[92:95], a[28:31], v[204:207]
    ds_read_b64_tr_b16 a[82:83], v6 offset:17600
    v_cvt_pk_bf16_f32 v56, v56, v57
    v_mfma_f32_16x16x32_bf16 v[200:203], a[92:95], a[24:27], v[200:203]
    s_add_u32 m0, s56, 0x101000
    v_mfma_f32_16x16x32_bf16 v[200:203], a[88:91], a[8:11], v[200:203]
    ds_read_b64_tr_b16 a[84:85], v6 offset:24768
    v_dot2c_f32_bf16 v64, v56, v65
    v_mfma_f32_16x16x32_bf16 v[196:199], a[88:91], a[4:7], v[196:199]
    buffer_load_dwordx4 v12, s[20:23], s61 offen offset:0  lds
    v_mfma_f32_16x16x32_bf16 v[196:199], a[92:95], a[20:23], v[196:199]
    ds_read_b64_tr_b16 a[86:87], v6 offset:25792
    v_lshlrev_b32 v60, 16, v37
    v_mfma_f32_16x16x32_bf16 v[192:195], a[92:95], a[16:19], v[192:195]
    buffer_load_dwordx4 v13, s[20:23], s61 offen offset:1024  lds
    v_mfma_f32_16x16x32_bf16 v[192:195], a[88:91], a[0:3], v[192:195]
    s_waitcnt lgkmcnt(8)
    v_mfma_f32_16x16x32_bf16 v[208:211], a[64:67], a[0:3], v[208:211]
    v_and_b32 v61, 0xffff0000, v37
    v_mfma_f32_16x16x32_bf16 v[208:211], a[68:71], a[16:19], v[208:211]
    buffer_load_dwordx4 v14, s[20:23], s61 offen offset:2048  lds
    v_mfma_f32_16x16x32_bf16 v[212:215], a[68:71], a[20:23], v[212:215]
    v_lshlrev_b32 v62, 16, v53
    v_mfma_f32_16x16x32_bf16 v[212:215], a[64:67], a[4:7], v[212:215]
    v_and_b32 v63, 0xffff0000, v53
    v_mfma_f32_16x16x32_bf16 v[216:219], a[64:67], a[8:11], v[216:219]
    buffer_load_dwordx4 v15, s[20:23], s61 offen offset:3072  lds
    v_mfma_f32_16x16x32_bf16 v[216:219], a[68:71], a[24:27], v[216:219]
    v_mul_f32 v60, v60, v62
    v_mfma_f32_16x16x32_bf16 v[220:223], a[68:71], a[28:31], v[220:223]
    v_mfma_f32_16x16x32_bf16 v[220:223], a[64:67], a[12:15], v[220:223]
    v_mul_f32 v61, v61, v63
    s_waitcnt vmcnt(14) lgkmcnt(0)
    s_barrier
    v_mfma_f32_16x16x32_bf16 v[236:239], a[72:75], a[12:15], v[236:239]
    ds_read_b128 a[88:91], v4 offset:16384
    v_mfma_f32_16x16x32_bf16 v[236:239], a[76:79], a[28:31], v[236:239]
    ds_read_b128 a[92:95], v5 offset:16384
    v_cvt_pk_bf16_f32 v60, v60, v61
    v_mfma_f32_16x16x32_bf16 v[232:235], a[76:79], a[24:27], v[232:235]
    ds_read_b128 a[32:35], v2 offset:32768
    v_mfma_f32_16x16x32_bf16 v[232:235], a[72:75], a[8:11], v[232:235]
    ds_read_b128 a[48:51], v3 offset:32768
    v_dot2c_f32_bf16 v64, v60, v65
    v_mfma_f32_16x16x32_bf16 v[228:231], a[72:75], a[4:7], v[228:231]
    s_add_u32 s63, s63, 1835008
    s_add_u32 s59, s59, 512
    v_mfma_f32_16x16x32_bf16 v[228:231], a[76:79], a[20:23], v[228:231]
    ds_read_b128 a[36:39], v2 offset:34816
    buffer_load_dword a96, v22, s[28:31], s63 offen
    v_mfma_f32_16x16x32_bf16 v[224:227], a[76:79], a[16:19], v[224:227]
    ds_read_b128 a[52:55], v3 offset:34816
    v_lshlrev_b32 v56, 16, v38
    v_mfma_f32_16x16x32_bf16 v[224:227], a[72:75], a[0:3], v[224:227]
    v_and_b32 v57, 0xffff0000, v38
    v_mfma_f32_16x16x32_bf16 v[240:243], a[80:83], a[0:3], v[240:243]
    ds_read_b128 a[64:67], v4 offset:18432
L_hop_1:
    s_cbranch_execz L_hop_5
    s_nop 0
    buffer_load_dword a96, v23, s[24:27], s59 offen
    v_mfma_f32_16x16x32_bf16 v[240:243], a[84:87], a[16:19], v[240:243]
    ds_read_b128 a[68:71], v5 offset:18432
    v_mfma_f32_16x16x32_bf16 v[244:247], a[84:87], a[20:23], v[244:247]
    ds_read_b128 a[40:43], v2 offset:36864
    v_lshlrev_b32 v58, 16, v54
    v_mfma_f32_16x16x32_bf16 v[244:247], a[80:83], a[4:7], v[244:247]
    ds_read_b128 a[56:59], v3 offset:36864
    v_mfma_f32_16x16x32_bf16 v[248:251], a[80:83], a[8:11], v[248:251]
    ds_read_b128 a[44:47], v2 offset:38912
    v_mfma_f32_16x16x32_bf16 v[248:251], a[84:87], a[24:27], v[248:251]
    ds_read_b128 a[60:63], v3 offset:38912
    v_mfma_f32_16x16x32_bf16 v[252:255], a[84:87], a[28:31], v[252:255]
    v_and_b32 v59, 0xffff0000, v54
    v_mfma_f32_16x16x32_bf16 v[252:255], a[80:83], a[12:15], v[252:255]
    v_mul_f32 v56, v56, v58
    s_waitcnt lgkmcnt(6)
    v_mfma_f32_16x16x32_bf16 v[80:83], a[32:35], a[88:91], v[80:83]
    ds_read_b128 a[72:75], v4 offset:20480
    v_mul_f32 v57, v57, v59
    v_mfma_f32_16x16x32_bf16 v[80:83], a[48:51], a[92:95], v[80:83]
    ds_read_b128 a[80:83], v4 offset:22528
    v_mfma_f32_16x16x32_bf16 v[84:87], a[52:55], a[92:95], v[84:87]
    ds_read_b128 a[76:79], v5 offset:20480
    v_mfma_f32_16x16x32_bf16 v[84:87], a[36:39], a[88:91], v[84:87]
    ds_read_b128 a[84:87], v5 offset:22528
    s_waitcnt lgkmcnt(4)
    v_mfma_f32_16x16x32_bf16 v[88:91], a[40:43], a[88:91], v[88:91]
    v_cvt_pk_bf16_f32 v56, v56, v57
    v_mfma_f32_16x16x32_bf16 v[88:91], a[56:59], a[92:95], v[88:91]
    v_dot2c_f32_bf16 v64, v56, v65
    v_mfma_f32_16x16x32_bf16 v[92:95], a[60:63], a[92:95], v[92:95]
    v_lshlrev_b32 v60, 16, v39
    v_mfma_f32_16x16x32_bf16 v[92:95], a[44:47], a[88:91], v[92:95]
    v_mfma_f32_16x16x32_bf16 v[108:111], a[44:47], a[64:67], v[108:111]
    ds_read_b64_tr_b16 a[88:89], v6 offset:32768
    v_mfma_f32_16x16x32_bf16 v[108:111], a[60:63], a[68:71], v[108:111]
    ds_read_b64_tr_b16 a[90:91], v6 offset:33792
    v_mfma_f32_16x16x32_bf16 v[104:107], a[56:59], a[68:71], v[104:107]
    v_and_b32 v61, 0xffff0000, v39
    v_mfma_f32_16x16x32_bf16 v[104:107], a[40:43], a[64:67], v[104:107]
    ds_read_b64_tr_b16 a[92:93], v6 offset:40960
    v_mfma_f32_16x16x32_bf16 v[100:103], a[36:39], a[64:67], v[100:103]
    v_lshlrev_b32 v62, 16, v55
    v_mfma_f32_16x16x32_bf16 v[100:103], a[52:55], a[68:71], v[100:103]
    ds_read_b64_tr_b16 a[94:95], v6 offset:41984
    v_mfma_f32_16x16x32_bf16 v[96:99], a[48:51], a[68:71], v[96:99]
    v_and_b32 v63, 0xffff0000, v55
    v_mfma_f32_16x16x32_bf16 v[96:99], a[32:35], a[64:67], v[96:99]
    v_mul_f32 v60, v60, v62
    s_waitcnt lgkmcnt(5)
    v_mfma_f32_16x16x32_bf16 v[112:115], a[32:35], a[72:75], v[112:115]
    ds_read_b64_tr_b16 a[64:65], v6 offset:32800
    v_mfma_f32_16x16x32_bf16 v[112:115], a[48:51], a[76:79], v[112:115]
    ds_read_b64_tr_b16 a[66:67], v6 offset:33824
    v_mfma_f32_16x16x32_bf16 v[116:119], a[52:55], a[76:79], v[116:119]
    v_mul_f32 v61, v61, v63
    v_mfma_f32_16x16x32_bf16 v[116:119], a[36:39], a[72:75], v[116:119]
    ds_read_b64_tr_b16 a[68:69], v6 offset:40992
    v_mfma_f32_16x16x32_bf16 v[120:123], a[40:43], a[72:75], v[120:123]
    v_cvt_pk_bf16_f32 v60, v60, v61
    v_mfma_f32_16x16x32_bf16 v[120:123], a[56:59], a[76:79], v[120:123]
    ds_read_b64_tr_b16 a[70:71], v6 offset:42016
    v_dot2c_f32_bf16 v64, v60, v65
    v_mfma_f32_16x16x32_bf16 v[124:127], a[60:63], a[76:79], v[124:127]
    s_addk_i32 s61, 128
    s_bitset0_b32 s61, 11
    s_nop 2
    v_add_f32_dpp v64, v64, v64 quad_perm:[1,0,3,2] row_mask:0xf bank_mask:0xf
    v_mfma_f32_16x16x32_bf16 v[124:127], a[44:47], a[72:75], v[124:127]
    s_waitcnt lgkmcnt(8)
    v_mfma_f32_16x16x32_bf16 v[140:143], a[44:47], a[80:83], v[140:143]
    ds_read_b64_tr_b16 a[72:73], v6 offset:32832
    s_nop 2
    v_add_f32_dpp v64, v64, v64 quad_perm:[2,3,0,1] row_mask:0xf bank_mask:0xf
    v_mfma_f32_16x16x32_bf16 v[140:143], a[60:63], a[84:87], v[140:143]
    ds_read_b64_tr_b16 a[74:75], v6 offset:33856
    v_mfma_f32_16x16x32_bf16 v[136:139], a[56:59], a[84:87], v[136:139]
    s_mul_i32 s62, s61, 3584
    s_nop 2
    v_add_f32_dpp v64, v64, v64 row_half_mirror row_mask:0xf bank_mask:0xf
    v_mfma_f32_16x16x32_bf16 v[136:139], a[40:43], a[80:83], v[136:139]
    ds_read_b64_tr_b16 a[76:77], v6 offset:41024
    v_mfma_f32_16x16x32_bf16 v[132:135], a[36:39], a[80:83], v[132:135]
    s_add_u32 m0, s58, 0x104000
    v_mfma_f32_16x16x32_bf16 v[132:135], a[52:55], a[84:87], v[132:135]
    ds_read_b64_tr_b16 a[78:79], v6 offset:42048
    v_mfma_f32_16x16x32_bf16 v[128:131], a[48:51], a[84:87], v[128:131]
    s_nop 2
    v_add_f32_dpp v64, v64, v64 row_mirror row_mask:0xf bank_mask:0xf
    v_mfma_f32_16x16x32_bf16 v[128:131], a[32:35], a[80:83], v[128:131]
    v_mov_b32 v65, v64
    s_waitcnt lgkmcnt(8)
    v_mfma_f32_16x16x32_bf16 v[144:147], a[88:91], a[32:35], v[144:147]
    ds_read_b64_tr_b16 a[80:81], v6 offset:32864
    v_mfma_f32_16x16x32_bf16 v[144:147], a[92:95], a[48:51], v[144:147]
    ds_read_b64_tr_b16 a[82:83], v6 offset:33888
    s_nop 1
    v_permlane16_swap_b32 v64, v65
    v_mfma_f32_16x16x32_bf16 v[148:151], a[92:95], a[52:55], v[148:151]
    buffer_load_dwordx4 v18, s[28:31], s62 offen offset:0  lds
    v_mfma_f32_16x16x32_bf16 v[148:151], a[88:91], a[36:39], v[148:151]
    ds_read_b64_tr_b16 a[84:85], v6 offset:41056
    s_nop 1
    v_add_f32 v64, v64, v65
    v_mfma_f32_16x16x32_bf16 v[152:155], a[88:91], a[40:43], v[152:155]
    buffer_load_dwordx4 v19, s[28:31], s62 offen offset:1024  lds
    v_mfma_f32_16x16x32_bf16 v[152:155], a[92:95], a[56:59], v[152:155]
    ds_read_b64_tr_b16 a[86:87], v6 offset:42080
    v_cvt_pk_bf16_f32 v64, v64, v64
    v_mfma_f32_16x16x32_bf16 v[156:159], a[92:95], a[60:63], v[156:159]
    buffer_load_dwordx4 v20, s[28:31], s62 offen offset:2048  lds
    v_mfma_f32_16x16x32_bf16 v[156:159], a[88:91], a[44:47], v[156:159]
    v_lshlrev_b32 v64, 16, v64
    s_waitcnt lgkmcnt(8)
    v_mfma_f32_16x16x32_bf16 v[172:175], a[64:67], a[44:47], v[172:175]
    ds_read_b64_tr_b16 a[88:89], v6 offset:32896
    v_mfma_f32_16x16x32_bf16 v[172:175], a[68:71], a[60:63], v[172:175]
    ds_read_b64_tr_b16 a[90:91], v6 offset:33920
    v_mul_f32 v64, 0xbfb8aa3b, v64
    v_mfma_f32_16x16x32_bf16 v[168:171], a[68:71], a[56:59], v[168:171]
    buffer_load_dwordx4 v21, s[28:31], s62 offen offset:3072  lds
    v_mfma_f32_16x16x32_bf16 v[168:171], a[64:67], a[40:43], v[168:171]
    ds_read_b64_tr_b16 a[92:93], v6 offset:41088
    v_exp_f32 v64, v64
    v_mfma_f32_16x16x32_bf16 v[164:167], a[64:67], a[36:39], v[164:167]
    s_add_u32 m0, s57, 0x102000
    v_mfma_f32_16x16x32_bf16 v[164:167], a[68:71], a[52:55], v[164:167]
    ds_read_b64_tr_b16 a[94:95], v6 offset:42112
    v_mfma_f32_16x16x32_bf16 v[160:163], a[68:71], a[48:51], v[160:163]
    s_nop 0
    v_add_f32 v64, 1.0, v64
    v_mfma_f32_16x16x32_bf16 v[160:163], a[64:67], a[32:35], v[160:163]
    v_rcp_f32 v64, v64
    s_waitcnt lgkmcnt(8)
    v_mfma_f32_16x16x32_bf16 v[176:179], a[72:75], a[32:35], v[176:179]
    ds_read_b64_tr_b16 a[64:65], v6 offset:32928
    v_mfma_f32_16x16x32_bf16 v[176:179], a[76:79], a[48:51], v[176:179]
    ds_read_b64_tr_b16 a[66:67], v6 offset:33952
    s_nop 0
    v_cvt_pk_bf16_f32 v64, v64, v64
    v_mfma_f32_16x16x32_bf16 v[180:183], a[76:79], a[52:55], v[180:183]
    buffer_load_dwordx4 v16, s[24:27], s61 offen offset:0  lds
    v_mfma_f32_16x16x32_bf16 v[180:183], a[72:75], a[36:39], v[180:183]
    ds_read_b64_tr_b16 a[68:69], v6 offset:41120
    v_lshlrev_b32 v64, 16, v64
    v_mfma_f32_16x16x32_bf16 v[184:187], a[72:75], a[40:43], v[184:187]
    buffer_load_dwordx4 v17, s[24:27], s61 offen offset:1024  lds
    v_mfma_f32_16x16x32_bf16 v[184:187], a[76:79], a[56:59], v[184:187]
    ds_read_b64_tr_b16 a[70:71], v6 offset:42144
    v_and_b32 v65, 31, v0
    v_mfma_f32_16x16x32_bf16 v[188:191], a[76:79], a[60:63], v[188:191]
    s_add_u32 m0, s56, 0x108000
    v_mfma_f32_16x16x32_bf16 v[188:191], a[72:75], a[44:47], v[188:191]
    v_cmp_eq_u32 vcc, 0, v65
    s_waitcnt lgkmcnt(8)
    v_mfma_f32_16x16x32_bf16 v[204:207], a[80:83], a[44:47], v[204:207]
    ds_read_b64_tr_b16 a[72:73], v6 offset:32960
    v_mfma_f32_16x16x32_bf16 v[204:207], a[84:87], a[60:63], v[204:207]
    ds_read_b64_tr_b16 a[74:75], v6 offset:33984
    v_lshrrev_b32 v65, 3, v0
    v_mfma_f32_16x16x32_bf16 v[200:203], a[84:87], a[56:59], v[200:203]
    buffer_load_dwordx4 v8, s[20:23], s61 offen offset:0  lds
    v_mfma_f32_16x16x32_bf16 v[200:203], a[80:83], a[40:43], v[200:203]
    ds_read_b64_tr_b16 a[76:77], v6 offset:41152
    v_bfrev_b32 v7, 1
    v_mfma_f32_16x16x32_bf16 v[196:199], a[80:83], a[36:39], v[196:199]
    buffer_load_dwordx4 v9, s[20:23], s61 offen offset:1024  lds
    v_mfma_f32_16x16x32_bf16 v[196:199], a[84:87], a[52:55], v[196:199]
    ds_read_b64_tr_b16 a[78:79], v6 offset:42176
    v_mfma_f32_16x16x32_bf16 v[192:195], a[84:87], a[48:51], v[192:195]
    s_lshr_b32 s18, s60, 9
    s_add_u32 s18, s18, 0x3100000
    v_mfma_f32_16x16x32_bf16 v[192:195], a[80:83], a[32:35], v[192:195]
    s_waitcnt lgkmcnt(8)
    v_mfma_f32_16x16x32_bf16 v[208:211], a[88:91], a[32:35], v[208:211]
    buffer_load_dwordx4 v10, s[20:23], s61 offen offset:2048  lds
    v_mfma_f32_16x16x32_bf16 v[208:211], a[92:95], a[48:51], v[208:211]
    v_cndmask_b32 v65, v7, v65, vcc
    v_mfma_f32_16x16x32_bf16 v[212:215], a[92:95], a[52:55], v[212:215]
    buffer_load_dwordx4 v11, s[20:23], s61 offen offset:3072  lds
    v_mfma_f32_16x16x32_bf16 v[212:215], a[88:91], a[36:39], v[212:215]
    buffer_store_dword v64, v65, s[4:7], s18 offen sc1
    v_mfma_f32_16x16x32_bf16 v[216:219], a[88:91], a[40:43], v[216:219]
    v_mfma_f32_16x16x32_bf16 v[216:219], a[92:95], a[56:59], v[216:219]
    v_mfma_f32_16x16x32_bf16 v[220:223], a[92:95], a[60:63], v[220:223]
    s_add_u32 m0, s56, 0x109000
    v_or_b32 v77, s16, v0
    v_mfma_f32_16x16x32_bf16 v[220:223], a[88:91], a[44:47], v[220:223]
    s_waitcnt vmcnt(13) lgkmcnt(0)
    s_barrier
    v_mfma_f32_16x16x32_bf16 v[236:239], a[64:67], a[44:47], v[236:239]
    ds_read_b128 a[80:83], v4 offset:0
    v_mfma_f32_16x16x32_bf16 v[236:239], a[68:71], a[60:63], v[236:239]
    ds_read_b128 a[84:87], v5 offset:0
    v_cmp_eq_u32 vcc, 0, v77
    v_mfma_f32_16x16x32_bf16 v[232:235], a[68:71], a[56:59], v[232:235]
    ds_read_b128 a[0:3], v2 offset:0
    v_mfma_f32_16x16x32_bf16 v[232:235], a[64:67], a[40:43], v[232:235]
    ds_read_b128 a[16:19], v3 offset:0
    v_mfma_f32_16x16x32_bf16 v[228:231], a[64:67], a[36:39], v[228:231]
    buffer_load_dwordx4 v12, s[20:23], s61 offen offset:0  lds
    v_mfma_f32_16x16x32_bf16 v[228:231], a[68:71], a[52:55], v[228:231]
    ds_read_b128 a[4:7], v2 offset:2048
    buffer_load_dwordx4 v13, s[20:23], s61 offen offset:1024  lds
    v_mfma_f32_16x16x32_bf16 v[224:227], a[68:71], a[48:51], v[224:227]
    ds_read_b128 a[20:23], v3 offset:2048
    v_accvgpr_write_b32 a104, 1
    v_mfma_f32_16x16x32_bf16 v[224:227], a[64:67], a[32:35], v[224:227]
    buffer_load_dwordx4 v14, s[20:23], s61 offen offset:2048  lds
    v_mfma_f32_16x16x32_bf16 v[240:243], a[72:75], a[32:35], v[240:243]
    ds_read_b128 a[88:91], v4 offset:2048
    v_bfrev_b32 v7, 1
    v_mfma_f32_16x16x32_bf16 v[240:243], a[76:79], a[48:51], v[240:243]
    ds_read_b128 a[92:95], v5 offset:2048
    v_mfma_f32_16x16x32_bf16 v[244:247], a[76:79], a[52:55], v[244:247]
    ds_read_b128 a[8:11], v2 offset:4096
    buffer_load_dwordx4 v15, s[20:23], s61 offen offset:3072  lds
    v_mfma_f32_16x16x32_bf16 v[244:247], a[72:75], a[36:39], v[244:247]
    ds_read_b128 a[24:27], v3 offset:4096
    v_mfma_f32_16x16x32_bf16 v[248:251], a[72:75], a[40:43], v[248:251]
    ds_read_b128 a[12:15], v2 offset:6144
    v_mfma_f32_16x16x32_bf16 v[248:251], a[76:79], a[56:59], v[248:251]
    ds_read_b128 a[28:31], v3 offset:6144
    v_mfma_f32_16x16x32_bf16 v[252:255], a[76:79], a[60:63], v[252:255]
    s_nop 0
    v_cndmask_b32 v77, v7, v77, vcc
    v_mfma_f32_16x16x32_bf16 v[252:255], a[72:75], a[44:47], v[252:255]
    s_waitcnt lgkmcnt(6)
    v_mfma_f32_16x16x32_bf16 v[80:83], a[0:3], a[80:83], v[80:83]
    ds_read_b128 a[64:67], v4 offset:4096
    v_mfma_f32_16x16x32_bf16 v[80:83], a[16:19], a[84:87], v[80:83]
    ds_read_b128 a[72:75], v4 offset:6144
    v_mfma_f32_16x16x32_bf16 v[84:87], a[20:23], a[84:87], v[84:87]
    ds_read_b128 a[68:71], v5 offset:4096
    v_mfma_f32_16x16x32_bf16 v[84:87], a[4:7], a[80:83], v[84:87]
    ds_read_b128 a[76:79], v5 offset:6144
    s_waitcnt lgkmcnt(4)
    v_mfma_f32_16x16x32_bf16 v[88:91], a[8:11], a[80:83], v[88:91]
    v_mfma_f32_16x16x32_bf16 v[88:91], a[24:27], a[84:87], v[88:91]
    v_mfma_f32_16x16x32_bf16 v[92:95], a[28:31], a[84:87], v[92:95]
    v_mfma_f32_16x16x32_bf16 v[92:95], a[12:15], a[80:83], v[92:95]
    v_mfma_f32_16x16x32_bf16 v[108:111], a[12:15], a[88:91], v[108:111]
    ds_read_b64_tr_b16 a[80:81], v6 offset:0
    v_mfma_f32_16x16x32_bf16 v[108:111], a[28:31], a[92:95], v[108:111]
    ds_read_b64_tr_b16 a[82:83], v6 offset:1024
    v_mfma_f32_16x16x32_bf16 v[104:107], a[24:27], a[92:95], v[104:107]
    s_addk_i32 s61, 128
    s_bitset0_b32 s61, 11
    v_mfma_f32_16x16x32_bf16 v[104:107], a[8:11], a[88:91], v[104:107]
    ds_read_b64_tr_b16 a[84:85], v6 offset:8192
    v_mfma_f32_16x16x32_bf16 v[100:103], a[4:7], a[88:91], v[100:103]
    s_mul_i32 s62, s61, 3584
    v_mfma_f32_16x16x32_bf16 v[100:103], a[20:23], a[92:95], v[100:103]
    ds_read_b64_tr_b16 a[86:87], v6 offset:9216
    v_mfma_f32_16x16x32_bf16 v[96:99], a[16:19], a[92:95], v[96:99]
    s_add_u32 m0, s58, 0x108000
    v_mfma_f32_16x16x32_bf16 v[96:99], a[0:3], a[88:91], v[96:99]
    s_waitcnt lgkmcnt(5)
    v_mfma_f32_16x16x32_bf16 v[112:115], a[0:3], a[64:67], v[112:115]
    ds_read_b64_tr_b16 a[88:89], v6 offset:32
    v_mfma_f32_16x16x32_bf16 v[112:115], a[16:19], a[68:71], v[112:115]
    ds_read_b64_tr_b16 a[90:91], v6 offset:1056
    v_mfma_f32_16x16x32_bf16 v[116:119], a[20:23], a[68:71], v[116:119]
    buffer_load_dwordx4 v18, s[28:31], s62 offen offset:0  lds
    v_mfma_f32_16x16x32_bf16 v[116:119], a[4:7], a[64:67], v[116:119]
    ds_read_b64_tr_b16 a[92:93], v6 offset:8224
    v_mfma_f32_16x16x32_bf16 v[120:123], a[8:11], a[64:67], v[120:123]
    buffer_load_dwordx4 v19, s[28:31], s62 offen offset:1024  lds
    v_mfma_f32_16x16x32_bf16 v[120:123], a[24:27], a[68:71], v[120:123]
    ds_read_b64_tr_b16 a[94:95], v6 offset:9248
    v_mfma_f32_16x16x32_bf16 v[124:127], a[28:31], a[68:71], v[124:127]
    v_mfma_f32_16x16x32_bf16 v[124:127], a[12:15], a[64:67], v[124:127]
    s_waitcnt lgkmcnt(8)
    v_mfma_f32_16x16x32_bf16 v[140:143], a[12:15], a[72:75], v[140:143]
    ds_read_b64_tr_b16 a[64:65], v6 offset:64
    v_mfma_f32_16x16x32_bf16 v[140:143], a[28:31], a[76:79], v[140:143]
    ds_read_b64_tr_b16 a[66:67], v6 offset:1088
    v_mfma_f32_16x16x32_bf16 v[136:139], a[24:27], a[76:79], v[136:139]
    buffer_load_dwordx4 v20, s[28:31], s62 offen offset:2048  lds
    v_mfma_f32_16x16x32_bf16 v[136:139], a[8:11], a[72:75], v[136:139]
    ds_read_b64_tr_b16 a[68:69], v6 offset:8256
    v_mfma_f32_16x16x32_bf16 v[132:135], a[4:7], a[72:75], v[132:135]
    buffer_load_dwordx4 v21, s[28:31], s62 offen offset:3072  lds
    v_mfma_f32_16x16x32_bf16 v[132:135], a[20:23], a[76:79], v[132:135]
    ds_read_b64_tr_b16 a[70:71], v6 offset:9280
    v_mfma_f32_16x16x32_bf16 v[128:131], a[16:19], a[76:79], v[128:131]
    s_add_u32 m0, s57, 0x104000
    v_mfma_f32_16x16x32_bf16 v[128:131], a[0:3], a[72:75], v[128:131]
    s_waitcnt lgkmcnt(8)
    v_mfma_f32_16x16x32_bf16 v[144:147], a[80:83], a[0:3], v[144:147]
    ds_read_b64_tr_b16 a[72:73], v6 offset:96
    v_mfma_f32_16x16x32_bf16 v[144:147], a[84:87], a[16:19], v[144:147]
    ds_read_b64_tr_b16 a[74:75], v6 offset:1120
    v_mfma_f32_16x16x32_bf16 v[148:151], a[84:87], a[20:23], v[148:151]
    buffer_load_dwordx4 v16, s[24:27], s61 offen offset:0  lds
    v_mfma_f32_16x16x32_bf16 v[148:151], a[80:83], a[4:7], v[148:151]
    ds_read_b64_tr_b16 a[76:77], v6 offset:8288
    v_mfma_f32_16x16x32_bf16 v[152:155], a[80:83], a[8:11], v[152:155]
    buffer_load_dwordx4 v17, s[24:27], s61 offen offset:1024  lds
    v_mfma_f32_16x16x32_bf16 v[152:155], a[84:87], a[24:27], v[152:155]
    ds_read_b64_tr_b16 a[78:79], v6 offset:9312
    v_mfma_f32_16x16x32_bf16 v[156:159], a[84:87], a[28:31], v[156:159]
    v_mfma_f32_16x16x32_bf16 v[156:159], a[80:83], a[12:15], v[156:159]
    s_waitcnt lgkmcnt(8)
    v_mfma_f32_16x16x32_bf16 v[172:175], a[88:91], a[12:15], v[172:175]
    ds_read_b64_tr_b16 a[80:81], v6 offset:128
    v_mfma_f32_16x16x32_bf16 v[172:175], a[92:95], a[28:31], v[172:175]
    ds_read_b64_tr_b16 a[82:83], v6 offset:1152
    v_mfma_f32_16x16x32_bf16 v[168:171], a[92:95], a[24:27], v[168:171]
    s_add_u32 m0, s56, 0x100000
    v_mfma_f32_16x16x32_bf16 v[168:171], a[88:91], a[8:11], v[168:171]
    ds_read_b64_tr_b16 a[84:85], v6 offset:8320
    v_mfma_f32_16x16x32_bf16 v[164:167], a[88:91], a[4:7], v[164:167]
    buffer_load_dwordx4 v8, s[20:23], s61 offen offset:0  lds
    v_mfma_f32_16x16x32_bf16 v[164:167], a[92:95], a[20:23], v[164:167]
    ds_read_b64_tr_b16 a[86:87], v6 offset:9344
    v_mfma_f32_16x16x32_bf16 v[160:163], a[92:95], a[16:19], v[160:163]
    buffer_load_dwordx4 v9, s[20:23], s61 offen offset:1024  lds
    v_mfma_f32_16x16x32_bf16 v[160:163], a[88:91], a[0:3], v[160:163]
    s_waitcnt lgkmcnt(8)
    v_mfma_f32_16x16x32_bf16 v[176:179], a[64:67], a[0:3], v[176:179]
    ds_read_b64_tr_b16 a[88:89], v6 offset:160
    v_mfma_f32_16x16x32_bf16 v[176:179], a[68:71], a[16:19], v[176:179]
    ds_read_b64_tr_b16 a[90:91], v6 offset:1184
    v_mfma_f32_16x16x32_bf16 v[180:183], a[68:71], a[20:23], v[180:183]
    buffer_load_dwordx4 v10, s[20:23], s61 offen offset:2048  lds
    v_mfma_f32_16x16x32_bf16 v[180:183], a[64:67], a[4:7], v[180:183]
    ds_read_b64_tr_b16 a[92:93], v6 offset:8352
    v_mfma_f32_16x16x32_bf16 v[184:187], a[64:67], a[8:11], v[184:187]
    buffer_load_dwordx4 v11, s[20:23], s61 offen offset:3072  lds
    v_mfma_f32_16x16x32_bf16 v[184:187], a[68:71], a[24:27], v[184:187]
    ds_read_b64_tr_b16 a[94:95], v6 offset:9376
    v_mfma_f32_16x16x32_bf16 v[188:191], a[68:71], a[28:31], v[188:191]
    v_mfma_f32_16x16x32_bf16 v[188:191], a[64:67], a[12:15], v[188:191]
    s_waitcnt lgkmcnt(8)
    v_mfma_f32_16x16x32_bf16 v[204:207], a[72:75], a[12:15], v[204:207]
    ds_read_b64_tr_b16 a[64:65], v6 offset:192
    v_mfma_f32_16x16x32_bf16 v[204:207], a[76:79], a[28:31], v[204:207]
    ds_read_b64_tr_b16 a[66:67], v6 offset:1216
    v_mfma_f32_16x16x32_bf16 v[200:203], a[76:79], a[24:27], v[200:203]
    s_add_u32 m0, s56, 0x101000
    v_mfma_f32_16x16x32_bf16 v[200:203], a[72:75], a[8:11], v[200:203]
    ds_read_b64_tr_b16 a[68:69], v6 offset:8384
    v_mfma_f32_16x16x32_bf16 v[196:199], a[72:75], a[4:7], v[196:199]
    buffer_load_dwordx4 v12, s[20:23], s61 offen offset:0  lds
    v_mfma_f32_16x16x32_bf16 v[196:199], a[76:79], a[20:23], v[196:199]
    ds_read_b64_tr_b16 a[70:71], v6 offset:9408
    v_mfma_f32_16x16x32_bf16 v[192:195], a[76:79], a[16:19], v[192:195]
    buffer_load_dwordx4 v13, s[20:23], s61 offen offset:1024  lds
    v_mfma_f32_16x16x32_bf16 v[192:195], a[72:75], a[0:3], v[192:195]
    s_waitcnt lgkmcnt(8)
    v_mfma_f32_16x16x32_bf16 v[208:211], a[80:83], a[0:3], v[208:211]
    v_mfma_f32_16x16x32_bf16 v[208:211], a[84:87], a[16:19], v[208:211]
    buffer_load_dwordx4 v14, s[20:23], s61 offen offset:2048  lds
    v_mfma_f32_16x16x32_bf16 v[212:215], a[84:87], a[20:23], v[212:215]
    v_mfma_f32_16x16x32_bf16 v[212:215], a[80:83], a[4:7], v[212:215]
    v_mfma_f32_16x16x32_bf16 v[216:219], a[80:83], a[8:11], v[216:219]
    buffer_load_dwordx4 v15, s[20:23], s61 offen offset:3072  lds
    v_mfma_f32_16x16x32_bf16 v[216:219], a[84:87], a[24:27], v[216:219]
    v_mfma_f32_16x16x32_bf16 v[220:223], a[84:87], a[28:31], v[220:223]
    v_mfma_f32_16x16x32_bf16 v[220:223], a[80:83], a[12:15], v[220:223]
    s_waitcnt vmcnt(14) lgkmcnt(0)
    s_barrier
    v_mfma_f32_16x16x32_bf16 v[236:239], a[88:91], a[12:15], v[236:239]
    ds_read_b128 a[72:75], v4 offset:8192
    v_mfma_f32_16x16x32_bf16 v[236:239], a[92:95], a[28:31], v[236:239]
    ds_read_b128 a[76:79], v5 offset:8192
    v_mfma_f32_16x16x32_bf16 v[232:235], a[92:95], a[24:27], v[232:235]
    ds_read_b128 a[32:35], v2 offset:32768
    v_mfma_f32_16x16x32_bf16 v[232:235], a[88:91], a[8:11], v[232:235]
    ds_read_b128 a[48:51], v3 offset:32768
    v_mfma_f32_16x16x32_bf16 v[228:231], a[88:91], a[4:7], v[228:231]
    buffer_load_dword a96, v78, s[32:35], s8 offen
    v_mfma_f32_16x16x32_bf16 v[228:231], a[92:95], a[20:23], v[228:231]
    ds_read_b128 a[36:39], v2 offset:34816
    v_mfma_f32_16x16x32_bf16 v[224:227], a[92:95], a[16:19], v[224:227]
    ds_read_b128 a[52:55], v3 offset:34816
    v_mfma_f32_16x16x32_bf16 v[224:227], a[88:91], a[0:3], v[224:227]
    v_mfma_f32_16x16x32_bf16 v[240:243], a[64:67], a[0:3], v[240:243]
    ds_read_b128 a[80:83], v4 offset:10240
    s_lshr_b32 s11, s14, 1
    s_cmp_eq_u32 s11, 0
    s_cselect_b32 s11, 0, 0x400
    v_mfma_f32_16x16x32_bf16 v[240:243], a[68:71], a[16:19], v[240:243]
    ds_read_b128 a[84:87], v5 offset:10240
    v_mfma_f32_16x16x32_bf16 v[244:247], a[68:71], a[20:23], v[244:247]
    ds_read_b128 a[40:43], v2 offset:36864
    v_mfma_f32_16x16x32_bf16 v[244:247], a[64:67], a[4:7], v[244:247]
    ds_read_b128 a[56:59], v3 offset:36864
    buffer_atomic_add a104, v77, s[48:51], s11 offen
    v_mfma_f32_16x16x32_bf16 v[248:251], a[64:67], a[8:11], v[248:251]
    ds_read_b128 a[44:47], v2 offset:38912
    v_mfma_f32_16x16x32_bf16 v[248:251], a[68:71], a[24:27], v[248:251]
    ds_read_b128 a[60:63], v3 offset:38912
    v_mfma_f32_16x16x32_bf16 v[252:255], a[68:71], a[28:31], v[252:255]
    v_mfma_f32_16x16x32_bf16 v[252:255], a[64:67], a[12:15], v[252:255]
    s_waitcnt lgkmcnt(6)
    v_mfma_f32_16x16x32_bf16 v[80:83], a[32:35], a[72:75], v[80:83]
    ds_read_b128 a[88:91], v4 offset:12288
    v_lshlrev_b32 v24, 16, v66
    v_mfma_f32_16x16x32_bf16 v[80:83], a[48:51], a[76:79], v[80:83]
    ds_read_b128 a[64:67], v4 offset:14336
    v_mfma_f32_16x16x32_bf16 v[84:87], a[52:55], a[76:79], v[84:87]
    ds_read_b128 a[92:95], v5 offset:12288
    v_mfma_f32_16x16x32_bf16 v[84:87], a[36:39], a[72:75], v[84:87]
    ds_read_b128 a[68:71], v5 offset:14336
    s_waitcnt lgkmcnt(4)
    v_mfma_f32_16x16x32_bf16 v[88:91], a[40:43], a[72:75], v[88:91]
    v_lshlrev_b32 v26, 16, v68
    v_mfma_f32_16x16x32_bf16 v[88:91], a[56:59], a[76:79], v[88:91]
    v_mfma_f32_16x16x32_bf16 v[92:95], a[60:63], a[76:79], v[92:95]
    v_lshlrev_b32 v28, 16, v70
    v_mfma_f32_16x16x32_bf16 v[92:95], a[44:47], a[72:75], v[92:95]
    v_mfma_f32_16x16x32_bf16 v[108:111], a[44:47], a[80:83], v[108:111]
    ds_read_b64_tr_b16 a[72:73], v6 offset:16384
    v_mfma_f32_16x16x32_bf16 v[108:111], a[60:63], a[84:87], v[108:111]
    ds_read_b64_tr_b16 a[74:75], v6 offset:17408
    v_mfma_f32_16x16x32_bf16 v[104:107], a[56:59], a[84:87], v[104:107]
    v_lshlrev_b32 v25, 16, v67
    v_mfma_f32_16x16x32_bf16 v[104:107], a[40:43], a[80:83], v[104:107]
    ds_read_b64_tr_b16 a[76:77], v6 offset:24576
    v_mfma_f32_16x16x32_bf16 v[100:103], a[36:39], a[80:83], v[100:103]
    v_lshlrev_b32 v27, 16, v69
    v_mfma_f32_16x16x32_bf16 v[100:103], a[52:55], a[84:87], v[100:103]
    ds_read_b64_tr_b16 a[78:79], v6 offset:25600
    v_mfma_f32_16x16x32_bf16 v[96:99], a[48:51], a[84:87], v[96:99]
    v_mfma_f32_16x16x32_bf16 v[96:99], a[32:35], a[80:83], v[96:99]
    s_waitcnt lgkmcnt(5)
    v_mfma_f32_16x16x32_bf16 v[112:115], a[32:35], a[88:91], v[112:115]
    ds_read_b64_tr_b16 a[80:81], v6 offset:16416
    v_mfma_f32_16x16x32_bf16 v[112:115], a[48:51], a[92:95], v[112:115]
    ds_read_b64_tr_b16 a[82:83], v6 offset:17440
    v_mfma_f32_16x16x32_bf16 v[116:119], a[52:55], a[92:95], v[116:119]
    v_lshlrev_b32 v29, 16, v71
    v_mfma_f32_16x16x32_bf16 v[116:119], a[36:39], a[88:91], v[116:119]
    ds_read_b64_tr_b16 a[84:85], v6 offset:24608
    v_mfma_f32_16x16x32_bf16 v[120:123], a[40:43], a[88:91], v[120:123]
    v_mul_f32 v28, 0x3fb8aa3b, v28
    v_mfma_f32_16x16x32_bf16 v[120:123], a[56:59], a[92:95], v[120:123]
    ds_read_b64_tr_b16 a[86:87], v6 offset:25632
    v_mul_f32 v29, 0x3fb8aa3b, v29
    v_mfma_f32_16x16x32_bf16 v[124:127], a[60:63], a[92:95], v[124:127]
    s_addk_i32 s61, 128
    s_bitset0_b32 s61, 11
    v_mfma_f32_16x16x32_bf16 v[124:127], a[44:47], a[88:91], v[124:127]
    s_waitcnt lgkmcnt(8)
    v_mfma_f32_16x16x32_bf16 v[140:143], a[44:47], a[64:67], v[140:143]
    ds_read_b64_tr_b16 a[88:89], v6 offset:16448
    v_exp_f32 v28, v28
    v_mfma_f32_16x16x32_bf16 v[140:143], a[60:63], a[68:71], v[140:143]
    ds_read_b64_tr_b16 a[90:91], v6 offset:17472
    v_mfma_f32_16x16x32_bf16 v[136:139], a[56:59], a[68:71], v[136:139]
    s_mul_i32 s62, s61, 3584
    v_mfma_f32_16x16x32_bf16 v[136:139], a[40:43], a[64:67], v[136:139]
    ds_read_b64_tr_b16 a[92:93], v6 offset:24640
    v_mfma_f32_16x16x32_bf16 v[132:135], a[36:39], a[64:67], v[132:135]
    s_add_u32 m0, s58, 0x100000
    v_mfma_f32_16x16x32_bf16 v[132:135], a[52:55], a[68:71], v[132:135]
    ds_read_b64_tr_b16 a[94:95], v6 offset:25664
    v_mfma_f32_16x16x32_bf16 v[128:131], a[48:51], a[68:71], v[128:131]
    v_exp_f32 v29, v29
    v_mfma_f32_16x16x32_bf16 v[128:131], a[32:35], a[64:67], v[128:131]
    s_nop 0
    v_cvt_pk_bf16_f32 v30, v28, v29
    s_waitcnt lgkmcnt(8)
    v_mfma_f32_16x16x32_bf16 v[144:147], a[72:75], a[32:35], v[144:147]
    ds_read_b64_tr_b16 a[64:65], v6 offset:16480
    v_mfma_f32_16x16x32_bf16 v[144:147], a[76:79], a[48:51], v[144:147]
    ds_read_b64_tr_b16 a[66:67], v6 offset:17504
    v_mfma_f32_16x16x32_bf16 v[148:151], a[76:79], a[52:55], v[148:151]
    buffer_load_dwordx4 v18, s[28:31], s62 offen offset:0  lds
    v_lshlrev_b32 v28, 16, v30
    v_mfma_f32_16x16x32_bf16 v[148:151], a[72:75], a[36:39], v[148:151]
    ds_read_b64_tr_b16 a[68:69], v6 offset:24672
    v_mfma_f32_16x16x32_bf16 v[152:155], a[72:75], a[40:43], v[152:155]
    buffer_load_dwordx4 v19, s[28:31], s62 offen offset:1024  lds
    v_mfma_f32_16x16x32_bf16 v[152:155], a[76:79], a[56:59], v[152:155]
    ds_read_b64_tr_b16 a[70:71], v6 offset:25696
    v_and_b32 v29, 0xffff0000, v30
    v_mfma_f32_16x16x32_bf16 v[156:159], a[76:79], a[60:63], v[156:159]
    buffer_load_dwordx4 v20, s[28:31], s62 offen offset:2048  lds
    v_mfma_f32_16x16x32_bf16 v[156:159], a[72:75], a[44:47], v[156:159]
    s_waitcnt lgkmcnt(8)
    v_mfma_f32_16x16x32_bf16 v[172:175], a[80:83], a[44:47], v[172:175]
    ds_read_b64_tr_b16 a[72:73], v6 offset:16512
    v_mul_f32 v30, v28, v24
    v_mfma_f32_16x16x32_bf16 v[172:175], a[84:87], a[60:63], v[172:175]
    ds_read_b64_tr_b16 a[74:75], v6 offset:17536
    v_mfma_f32_16x16x32_bf16 v[168:171], a[84:87], a[56:59], v[168:171]
    buffer_load_dwordx4 v21, s[28:31], s62 offen offset:3072  lds
    v_mfma_f32_16x16x32_bf16 v[168:171], a[80:83], a[40:43], v[168:171]
    ds_read_b64_tr_b16 a[76:77], v6 offset:24704
    v_mfma_f32_16x16x32_bf16 v[164:167], a[80:83], a[36:39], v[164:167]
    s_add_u32 m0, s57, 0x100000
    v_mfma_f32_16x16x32_bf16 v[164:167], a[84:87], a[52:55], v[164:167]
    ds_read_b64_tr_b16 a[78:79], v6 offset:25728
    v_mfma_f32_16x16x32_bf16 v[160:163], a[84:87], a[48:51], v[160:163]
    v_mul_f32 v32, v28, v26
    v_mfma_f32_16x16x32_bf16 v[160:163], a[80:83], a[32:35], v[160:163]
    v_mul_f32 v31, v29, v25
    s_waitcnt lgkmcnt(8)
    v_mfma_f32_16x16x32_bf16 v[176:179], a[88:91], a[32:35], v[176:179]
    ds_read_b64_tr_b16 a[80:81], v6 offset:16544
    v_mfma_f32_16x16x32_bf16 v[176:179], a[92:95], a[48:51], v[176:179]
    ds_read_b64_tr_b16 a[82:83], v6 offset:17568
    v_mul_f32 v33, v29, v27
    v_mfma_f32_16x16x32_bf16 v[180:183], a[92:95], a[52:55], v[180:183]
    buffer_load_dwordx4 v16, s[24:27], s61 offen offset:0  lds
    v_mfma_f32_16x16x32_bf16 v[180:183], a[88:91], a[36:39], v[180:183]
    ds_read_b64_tr_b16 a[84:85], v6 offset:24736
    v_mfma_f32_16x16x32_bf16 v[184:187], a[88:91], a[40:43], v[184:187]
    buffer_load_dwordx4 v17, s[24:27], s61 offen offset:1024  lds
    v_mul_f32 v30, 0x3fb8aa3b, v30
    v_mfma_f32_16x16x32_bf16 v[184:187], a[92:95], a[56:59], v[184:187]
    ds_read_b64_tr_b16 a[86:87], v6 offset:25760
    v_mfma_f32_16x16x32_bf16 v[188:191], a[92:95], a[60:63], v[188:191]
    s_add_u32 m0, s56, 0x108000
    v_mfma_f32_16x16x32_bf16 v[188:191], a[88:91], a[44:47], v[188:191]
    v_mul_f32 v32, 0.15915494, v32
    s_waitcnt lgkmcnt(8)
    v_mfma_f32_16x16x32_bf16 v[204:207], a[64:67], a[44:47], v[204:207]
    ds_read_b64_tr_b16 a[88:89], v6 offset:16576
    v_mfma_f32_16x16x32_bf16 v[204:207], a[68:71], a[60:63], v[204:207]
    ds_read_b64_tr_b16 a[90:91], v6 offset:17600
    v_mfma_f32_16x16x32_bf16 v[200:203], a[68:71], a[56:59], v[200:203]
    buffer_load_dwordx4 v8, s[20:23], s61 offen offset:0  lds
    v_mul_f32 v31, 0x3fb8aa3b, v31
    v_mfma_f32_16x16x32_bf16 v[200:203], a[64:67], a[40:43], v[200:203]
    ds_read_b64_tr_b16 a[92:93], v6 offset:24768
    v_mfma_f32_16x16x32_bf16 v[196:199], a[64:67], a[36:39], v[196:199]
    buffer_load_dwordx4 v9, s[20:23], s61 offen offset:1024  lds
    v_mfma_f32_16x16x32_bf16 v[196:199], a[68:71], a[52:55], v[196:199]
    ds_read_b64_tr_b16 a[94:95], v6 offset:25792
    v_mfma_f32_16x16x32_bf16 v[192:195], a[68:71], a[48:51], v[192:195]
    v_mul_f32 v33, 0.15915494, v33
    v_mfma_f32_16x16x32_bf16 v[192:195], a[64:67], a[32:35], v[192:195]
    s_waitcnt lgkmcnt(8)
    v_mfma_f32_16x16x32_bf16 v[208:211], a[72:75], a[32:35], v[208:211]
    buffer_load_dwordx4 v10, s[20:23], s61 offen offset:2048  lds
    v_mfma_f32_16x16x32_bf16 v[208:211], a[76:79], a[48:51], v[208:211]
    v_lshrrev_b32 v34, 4, v0
    v_mfma_f32_16x16x32_bf16 v[212:215], a[76:79], a[52:55], v[212:215]
    buffer_load_dwordx4 v11, s[20:23], s61 offen offset:3072  lds
    v_mfma_f32_16x16x32_bf16 v[212:215], a[72:75], a[36:39], v[212:215]
    v_mfma_f32_16x16x32_bf16 v[216:219], a[72:75], a[40:43], v[216:219]
    v_cvt_f32_u32 v34, v34
    v_mfma_f32_16x16x32_bf16 v[216:219], a[76:79], a[56:59], v[216:219]
    v_mfma_f32_16x16x32_bf16 v[220:223], a[76:79], a[60:63], v[220:223]
    s_add_u32 m0, s56, 0x109000
    v_mfma_f32_16x16x32_bf16 v[220:223], a[72:75], a[44:47], v[220:223]
    v_mul_f32 v35, 0x44000000, v34
    s_waitcnt vmcnt(12) lgkmcnt(0)
    s_barrier
    v_mfma_f32_16x16x32_bf16 v[236:239], a[80:83], a[44:47], v[236:239]
    ds_read_b128 a[64:67], v4 offset:16384
    v_mfma_f32_16x16x32_bf16 v[236:239], a[84:87], a[60:63], v[236:239]
    ds_read_b128 a[68:71], v5 offset:16384
L_hop_2:
    s_cbranch_execz L_hop_6
    s_nop 0
    v_mfma_f32_16x16x32_bf16 v[232:235], a[84:87], a[56:59], v[232:235]
    ds_read_b128 a[0:3], v2 offset:0
    v_mul_f32 v34, 0x41800000, v34
    v_mfma_f32_16x16x32_bf16 v[232:235], a[80:83], a[40:43], v[232:235]
    ds_read_b128 a[16:19], v3 offset:0
    v_mfma_f32_16x16x32_bf16 v[228:231], a[80:83], a[36:39], v[228:231]
    buffer_load_dwordx4 v12, s[20:23], s61 offen offset:0  lds
    v_mfma_f32_16x16x32_bf16 v[228:231], a[84:87], a[52:55], v[228:231]
    ds_read_b128 a[4:7], v2 offset:2048
    buffer_load_dwordx4 v13, s[20:23], s61 offen offset:1024  lds
    v_mfma_f32_16x16x32_bf16 v[224:227], a[84:87], a[48:51], v[224:227]
    ds_read_b128 a[20:23], v3 offset:2048
    v_mul_f32 v36, 1.0, v30
    v_mfma_f32_16x16x32_bf16 v[224:227], a[80:83], a[32:35], v[224:227]
    buffer_load_dwordx4 v14, s[20:23], s61 offen offset:2048  lds
    v_mfma_f32_16x16x32_bf16 v[240:243], a[88:91], a[32:35], v[240:243]
    ds_read_b128 a[72:75], v4 offset:18432
    s_lshr_b32 s11, s14, 1
    s_cmp_eq_u32 s11, 1
    s_cselect_b32 s11, 0, 0x400
    v_mfma_f32_16x16x32_bf16 v[240:243], a[92:95], a[48:51], v[240:243]
    ds_read_b128 a[76:79], v5 offset:18432
    v_mul_f32 v40, 1.0, v31
    v_mfma_f32_16x16x32_bf16 v[244:247], a[92:95], a[52:55], v[244:247]
    ds_read_b128 a[8:11], v2 offset:4096
    buffer_load_dwordx4 v15, s[20:23], s61 offen offset:3072  lds
    v_mfma_f32_16x16x32_bf16 v[244:247], a[88:91], a[36:39], v[244:247]
    ds_read_b128 a[24:27], v3 offset:4096
    buffer_atomic_add a104, v77, s[48:51], s11 offen
    v_mfma_f32_16x16x32_bf16 v[248:251], a[88:91], a[40:43], v[248:251]
    ds_read_b128 a[12:15], v2 offset:6144
    v_mfma_f32_16x16x32_bf16 v[248:251], a[92:95], a[56:59], v[248:251]
    ds_read_b128 a[28:31], v3 offset:6144
    v_mfma_f32_16x16x32_bf16 v[252:255], a[92:95], a[60:63], v[252:255]
    v_mul_f32 v37, 1.0, v32
    v_mfma_f32_16x16x32_bf16 v[252:255], a[88:91], a[44:47], v[252:255]
    v_mul_f32 v41, 1.0, v33
    s_waitcnt lgkmcnt(6)
    v_mfma_f32_16x16x32_bf16 v[80:83], a[0:3], a[64:67], v[80:83]
    ds_read_b128 a[80:83], v4 offset:20480
    v_mfma_f32_16x16x32_bf16 v[80:83], a[16:19], a[68:71], v[80:83]
    ds_read_b128 a[88:91], v4 offset:22528
    v_mfma_f32_16x16x32_bf16 v[84:87], a[20:23], a[68:71], v[84:87]
    ds_read_b128 a[84:87], v5 offset:20480
    v_mfma_f32_16x16x32_bf16 v[84:87], a[4:7], a[64:67], v[84:87]
    ds_read_b128 a[92:95], v5 offset:22528
    s_waitcnt lgkmcnt(4)
    v_mfma_f32_16x16x32_bf16 v[88:91], a[8:11], a[64:67], v[88:91]
    v_exp_f32 v36, v36
    v_mfma_f32_16x16x32_bf16 v[88:91], a[24:27], a[68:71], v[88:91]
    v_exp_f32 v40, v40
    v_mfma_f32_16x16x32_bf16 v[92:95], a[28:31], a[68:71], v[92:95]
    v_mfma_f32_16x16x32_bf16 v[92:95], a[12:15], a[64:67], v[92:95]
    v_mfma_f32_16x16x32_bf16 v[108:111], a[12:15], a[72:75], v[108:111]
    ds_read_b64_tr_b16 a[64:65], v6 offset:32768
    v_rndne_f32 v38, v37
    v_mfma_f32_16x16x32_bf16 v[108:111], a[28:31], a[76:79], v[108:111]
    ds_read_b64_tr_b16 a[66:67], v6 offset:33792
    v_mfma_f32_16x16x32_bf16 v[104:107], a[24:27], a[76:79], v[104:107]
    s_addk_i32 s61, 128
    s_bitset0_b32 s61, 11
    v_mfma_f32_16x16x32_bf16 v[104:107], a[8:11], a[72:75], v[104:107]
    ds_read_b64_tr_b16 a[68:69], v6 offset:40960
    v_rndne_f32 v42, v41
    v_mfma_f32_16x16x32_bf16 v[100:103], a[4:7], a[72:75], v[100:103]
    s_mul_i32 s62, s61, 3584
    v_mfma_f32_16x16x32_bf16 v[100:103], a[20:23], a[76:79], v[100:103]
    ds_read_b64_tr_b16 a[70:71], v6 offset:41984
    v_mfma_f32_16x16x32_bf16 v[96:99], a[16:19], a[76:79], v[96:99]
    s_add_u32 m0, s58, 0x104000
    v_sub_f32 v37, v37, v38
    v_mfma_f32_16x16x32_bf16 v[96:99], a[0:3], a[72:75], v[96:99]
    s_waitcnt lgkmcnt(5)
    v_mfma_f32_16x16x32_bf16 v[112:115], a[0:3], a[80:83], v[112:115]
    ds_read_b64_tr_b16 a[72:73], v6 offset:32800
    v_mfma_f32_16x16x32_bf16 v[112:115], a[16:19], a[84:87], v[112:115]
    ds_read_b64_tr_b16 a[74:75], v6 offset:33824
    v_sub_f32 v41, v41, v42
    v_mfma_f32_16x16x32_bf16 v[116:119], a[20:23], a[84:87], v[116:119]
    buffer_load_dwordx4 v18, s[28:31], s62 offen offset:0  lds
    v_mfma_f32_16x16x32_bf16 v[116:119], a[4:7], a[80:83], v[116:119]
    ds_read_b64_tr_b16 a[76:77], v6 offset:40992
    v_mfma_f32_16x16x32_bf16 v[120:123], a[8:11], a[80:83], v[120:123]
    buffer_load_dwordx4 v19, s[28:31], s62 offen offset:1024  lds
    v_mfma_f32_16x16x32_bf16 v[120:123], a[24:27], a[84:87], v[120:123]
    ds_read_b64_tr_b16 a[78:79], v6 offset:42016
    v_mfma_f32_16x16x32_bf16 v[124:127], a[28:31], a[84:87], v[124:127]
    v_cos_f32 v38, v37
    v_mfma_f32_16x16x32_bf16 v[124:127], a[12:15], a[80:83], v[124:127]
    v_cos_f32 v42, v41
    s_waitcnt lgkmcnt(8)
    v_mfma_f32_16x16x32_bf16 v[140:143], a[12:15], a[88:91], v[140:143]
    ds_read_b64_tr_b16 a[80:81], v6 offset:32832
    v_mfma_f32_16x16x32_bf16 v[140:143], a[28:31], a[92:95], v[140:143]
    ds_read_b64_tr_b16 a[82:83], v6 offset:33856
    v_mfma_f32_16x16x32_bf16 v[136:139], a[24:27], a[92:95], v[136:139]
    buffer_load_dwordx4 v20, s[28:31], s62 offen offset:2048  lds
    v_sin_f32 v39, v37
    v_mfma_f32_16x16x32_bf16 v[136:139], a[8:11], a[88:91], v[136:139]
    ds_read_b64_tr_b16 a[84:85], v6 offset:41024
    v_mfma_f32_16x16x32_bf16 v[132:135], a[4:7], a[88:91], v[132:135]
    buffer_load_dwordx4 v21, s[28:31], s62 offen offset:3072  lds
    v_mfma_f32_16x16x32_bf16 v[132:135], a[20:23], a[92:95], v[132:135]
    ds_read_b64_tr_b16 a[86:87], v6 offset:42048
    v_sin_f32 v43, v41
    v_mfma_f32_16x16x32_bf16 v[128:131], a[16:19], a[92:95], v[128:131]
    s_add_u32 m0, s57, 0x102000
    v_mfma_f32_16x16x32_bf16 v[128:131], a[0:3], a[88:91], v[128:131]
    s_waitcnt lgkmcnt(8)
    v_mfma_f32_16x16x32_bf16 v[144:147], a[64:67], a[0:3], v[144:147]
    ds_read_b64_tr_b16 a[88:89], v6 offset:32864
    v_mul_f32 v50, v36, v38
    v_mfma_f32_16x16x32_bf16 v[144:147], a[68:71], a[16:19], v[144:147]
    ds_read_b64_tr_b16 a[90:91], v6 offset:33888
    v_mfma_f32_16x16x32_bf16 v[148:151], a[68:71], a[20:23], v[148:151]
    buffer_load_dwordx4 v16, s[24:27], s61 offen offset:0  lds
    v_mfma_f32_16x16x32_bf16 v[148:151], a[64:67], a[4:7], v[148:151]
    ds_read_b64_tr_b16 a[92:93], v6 offset:41056
    v_mfma_f32_16x16x32_bf16 v[152:155], a[64:67], a[8:11], v[152:155]
    buffer_load_dwordx4 v17, s[24:27], s61 offen offset:1024  lds
    v_mfma_f32_16x16x32_bf16 v[152:155], a[68:71], a[24:27], v[152:155]
    ds_read_b64_tr_b16 a[94:95], v6 offset:42080
    v_mfma_f32_16x16x32_bf16 v[156:159], a[68:71], a[28:31], v[156:159]
    v_mul_f32 v52, v40, v42
    v_mfma_f32_16x16x32_bf16 v[156:159], a[64:67], a[12:15], v[156:159]
    v_mul_f32 v51, v36, v39
    s_waitcnt lgkmcnt(8)
    v_mfma_f32_16x16x32_bf16 v[172:175], a[72:75], a[12:15], v[172:175]
    ds_read_b64_tr_b16 a[64:65], v6 offset:32896
    v_mfma_f32_16x16x32_bf16 v[172:175], a[76:79], a[28:31], v[172:175]
    ds_read_b64_tr_b16 a[66:67], v6 offset:33920
    v_mfma_f32_16x16x32_bf16 v[168:171], a[76:79], a[24:27], v[168:171]
    s_add_u32 m0, s56, 0x100000
    v_mul_f32 v53, v40, v43
    v_mfma_f32_16x16x32_bf16 v[168:171], a[72:75], a[8:11], v[168:171]
    ds_read_b64_tr_b16 a[68:69], v6 offset:41088
    v_mfma_f32_16x16x32_bf16 v[164:167], a[72:75], a[4:7], v[164:167]
    buffer_load_dwordx4 v8, s[20:23], s61 offen offset:0  lds
    v_mfma_f32_16x16x32_bf16 v[164:167], a[76:79], a[20:23], v[164:167]
    ds_read_b64_tr_b16 a[70:71], v6 offset:42112
    v_mul_f32 v36, 2.0, v30
    v_mfma_f32_16x16x32_bf16 v[160:163], a[76:79], a[16:19], v[160:163]
    buffer_load_dwordx4 v9, s[20:23], s61 offen offset:1024  lds
    v_mfma_f32_16x16x32_bf16 v[160:163], a[72:75], a[0:3], v[160:163]
    s_waitcnt lgkmcnt(8)
    v_mfma_f32_16x16x32_bf16 v[176:179], a[80:83], a[0:3], v[176:179]
    ds_read_b64_tr_b16 a[72:73], v6 offset:32928
    v_mul_f32 v40, 2.0, v31
    v_mfma_f32_16x16x32_bf16 v[176:179], a[84:87], a[16:19], v[176:179]
    ds_read_b64_tr_b16 a[74:75], v6 offset:33952
    v_mfma_f32_16x16x32_bf16 v[180:183], a[84:87], a[20:23], v[180:183]
    buffer_load_dwordx4 v10, s[20:23], s61 offen offset:2048  lds
    v_mfma_f32_16x16x32_bf16 v[180:183], a[80:83], a[4:7], v[180:183]
    ds_read_b64_tr_b16 a[76:77], v6 offset:41120
    v_mfma_f32_16x16x32_bf16 v[184:187], a[80:83], a[8:11], v[184:187]
    buffer_load_dwordx4 v11, s[20:23], s61 offen offset:3072  lds
    v_mfma_f32_16x16x32_bf16 v[184:187], a[84:87], a[24:27], v[184:187]
    ds_read_b64_tr_b16 a[78:79], v6 offset:42144
    v_mfma_f32_16x16x32_bf16 v[188:191], a[84:87], a[28:31], v[188:191]
    v_mul_f32 v37, 2.0, v32
    v_mfma_f32_16x16x32_bf16 v[188:191], a[80:83], a[12:15], v[188:191]
    v_mul_f32 v41, 2.0, v33
    s_waitcnt lgkmcnt(8)
    v_mfma_f32_16x16x32_bf16 v[204:207], a[88:91], a[12:15], v[204:207]
    ds_read_b64_tr_b16 a[80:81], v6 offset:32960
    v_mfma_f32_16x16x32_bf16 v[204:207], a[92:95], a[28:31], v[204:207]
    ds_read_b64_tr_b16 a[82:83], v6 offset:33984
    v_exp_f32 v36, v36
    v_mfma_f32_16x16x32_bf16 v[200:203], a[92:95], a[24:27], v[200:203]
    s_add_u32 m0, s56, 0x101000
    v_mfma_f32_16x16x32_bf16 v[200:203], a[88:91], a[8:11], v[200:203]
    ds_read_b64_tr_b16 a[84:85], v6 offset:41152
    v_mfma_f32_16x16x32_bf16 v[196:199], a[88:91], a[4:7], v[196:199]
    buffer_load_dwordx4 v12, s[20:23], s61 offen offset:0  lds
    v_exp_f32 v40, v40
    v_mfma_f32_16x16x32_bf16 v[196:199], a[92:95], a[20:23], v[196:199]
    ds_read_b64_tr_b16 a[86:87], v6 offset:42176
    v_mfma_f32_16x16x32_bf16 v[192:195], a[92:95], a[16:19], v[192:195]
    buffer_load_dwordx4 v13, s[20:23], s61 offen offset:1024  lds
    v_mfma_f32_16x16x32_bf16 v[192:195], a[88:91], a[0:3], v[192:195]
    s_waitcnt lgkmcnt(8)
    v_mfma_f32_16x16x32_bf16 v[208:211], a[64:67], a[0:3], v[208:211]
    v_rndne_f32 v38, v37
    v_mfma_f32_16x16x32_bf16 v[208:211], a[68:71], a[16:19], v[208:211]
    buffer_load_dwordx4 v14, s[20:23], s61 offen offset:2048  lds
    v_mfma_f32_16x16x32_bf16 v[212:215], a[68:71], a[20:23], v[212:215]
    v_rndne_f32 v42, v41
    v_mfma_f32_16x16x32_bf16 v[212:215], a[64:67], a[4:7], v[212:215]
    v_mfma_f32_16x16x32_bf16 v[216:219], a[64:67], a[8:11], v[216:219]
    buffer_load_dwordx4 v15, s[20:23], s61 offen offset:3072  lds
    v_mfma_f32_16x16x32_bf16 v[216:219], a[68:71], a[24:27], v[216:219]
    v_sub_f32 v37, v37, v38
    v_mfma_f32_16x16x32_bf16 v[220:223], a[68:71], a[28:31], v[220:223]
    v_mfma_f32_16x16x32_bf16 v[220:223], a[64:67], a[12:15], v[220:223]
    s_waitcnt vmcnt(15) lgkmcnt(0)
    s_barrier
    v_mfma_f32_16x16x32_bf16 v[236:239], a[72:75], a[12:15], v[236:239]
    ds_read_b128 a[88:91], v4 offset:0
    v_mfma_f32_16x16x32_bf16 v[236:239], a[76:79], a[28:31], v[236:239]
    ds_read_b128 a[92:95], v5 offset:0
    v_sub_f32 v41, v41, v42
    v_mfma_f32_16x16x32_bf16 v[232:235], a[76:79], a[24:27], v[232:235]
    ds_read_b128 a[32:35], v2 offset:32768
    v_mfma_f32_16x16x32_bf16 v[232:235], a[72:75], a[8:11], v[232:235]
    ds_read_b128 a[48:51], v3 offset:32768
    v_mfma_f32_16x16x32_bf16 v[228:231], a[72:75], a[4:7], v[228:231]
    s_add_u32 s63, s63, 1835008
    s_add_u32 s59, s59, 512
    v_cos_f32 v38, v37
    v_mfma_f32_16x16x32_bf16 v[228:231], a[76:79], a[20:23], v[228:231]
    ds_read_b128 a[36:39], v2 offset:34816
    buffer_load_dword a96, v22, s[28:31], s63 offen
    v_mfma_f32_16x16x32_bf16 v[224:227], a[76:79], a[16:19], v[224:227]
    ds_read_b128 a[52:55], v3 offset:34816
    v_mfma_f32_16x16x32_bf16 v[224:227], a[72:75], a[0:3], v[224:227]
    v_cos_f32 v42, v41
    v_mfma_f32_16x16x32_bf16 v[240:243], a[80:83], a[0:3], v[240:243]
    ds_read_b128 a[64:67], v4 offset:2048
    buffer_load_dword a96, v23, s[24:27], s59 offen
    v_mfma_f32_16x16x32_bf16 v[240:243], a[84:87], a[16:19], v[240:243]
    ds_read_b128 a[68:71], v5 offset:2048
    s_lshr_b32 s11, s14, 1
    s_cmp_eq_u32 s11, 2
    s_cselect_b32 s11, 0, 0x400
    v_mfma_f32_16x16x32_bf16 v[244:247], a[84:87], a[20:23], v[244:247]
    ds_read_b128 a[40:43], v2 offset:36864
    v_sin_f32 v39, v37
    v_mfma_f32_16x16x32_bf16 v[244:247], a[80:83], a[4:7], v[244:247]
    ds_read_b128 a[56:59], v3 offset:36864
    buffer_atomic_add a104, v77, s[48:51], s11 offen
    v_mfma_f32_16x16x32_bf16 v[248:251], a[80:83], a[8:11], v[248:251]
    ds_read_b128 a[44:47], v2 offset:38912
    v_mfma_f32_16x16x32_bf16 v[248:251], a[84:87], a[24:27], v[248:251]
    ds_read_b128 a[60:63], v3 offset:38912
    v_mfma_f32_16x16x32_bf16 v[252:255], a[84:87], a[28:31], v[252:255]
    v_sin_f32 v43, v41
    v_mfma_f32_16x16x32_bf16 v[252:255], a[80:83], a[12:15], v[252:255]
    s_waitcnt lgkmcnt(6)
    v_mfma_f32_16x16x32_bf16 v[80:83], a[32:35], a[88:91], v[80:83]
    ds_read_b128 a[72:75], v4 offset:4096
    v_mul_f32 v54, v36, v38
    v_mfma_f32_16x16x32_bf16 v[80:83], a[48:51], a[92:95], v[80:83]
    ds_read_b128 a[80:83], v4 offset:6144
    v_mfma_f32_16x16x32_bf16 v[84:87], a[52:55], a[92:95], v[84:87]
    ds_read_b128 a[76:79], v5 offset:4096
    v_mfma_f32_16x16x32_bf16 v[84:87], a[36:39], a[88:91], v[84:87]
    ds_read_b128 a[84:87], v5 offset:6144
    s_waitcnt lgkmcnt(4)
    v_mfma_f32_16x16x32_bf16 v[88:91], a[40:43], a[88:91], v[88:91]
    v_mul_f32 v56, v40, v42
    v_mfma_f32_16x16x32_bf16 v[88:91], a[56:59], a[92:95], v[88:91]
    v_mfma_f32_16x16x32_bf16 v[92:95], a[60:63], a[92:95], v[92:95]
    v_mul_f32 v55, v36, v39
    v_mfma_f32_16x16x32_bf16 v[92:95], a[44:47], a[88:91], v[92:95]
    v_mfma_f32_16x16x32_bf16 v[108:111], a[44:47], a[64:67], v[108:111]
    ds_read_b64_tr_b16 a[88:89], v6 offset:0
    v_mfma_f32_16x16x32_bf16 v[108:111], a[60:63], a[68:71], v[108:111]
    ds_read_b64_tr_b16 a[90:91], v6 offset:1024
    v_mfma_f32_16x16x32_bf16 v[104:107], a[56:59], a[68:71], v[104:107]
    v_mul_f32 v57, v40, v43
    v_mfma_f32_16x16x32_bf16 v[104:107], a[40:43], a[64:67], v[104:107]
    ds_read_b64_tr_b16 a[92:93], v6 offset:8192
    v_mfma_f32_16x16x32_bf16 v[100:103], a[36:39], a[64:67], v[100:103]
    v_mul_f32 v36, 0x41800000, v30
    v_mfma_f32_16x16x32_bf16 v[100:103], a[52:55], a[68:71], v[100:103]
    ds_read_b64_tr_b16 a[94:95], v6 offset:9216
    v_mfma_f32_16x16x32_bf16 v[96:99], a[48:51], a[68:71], v[96:99]
    v_mfma_f32_16x16x32_bf16 v[96:99], a[32:35], a[64:67], v[96:99]
    s_waitcnt lgkmcnt(5)
    v_mfma_f32_16x16x32_bf16 v[112:115], a[32:35], a[72:75], v[112:115]
    ds_read_b64_tr_b16 a[64:65], v6 offset:32
    v_mfma_f32_16x16x32_bf16 v[112:115], a[48:51], a[76:79], v[112:115]
    ds_read_b64_tr_b16 a[66:67], v6 offset:1056
    v_mfma_f32_16x16x32_bf16 v[116:119], a[52:55], a[76:79], v[116:119]
    v_mul_f32 v40, 0x41800000, v31
    v_mfma_f32_16x16x32_bf16 v[116:119], a[36:39], a[72:75], v[116:119]
    ds_read_b64_tr_b16 a[68:69], v6 offset:8224
    v_mfma_f32_16x16x32_bf16 v[120:123], a[40:43], a[72:75], v[120:123]
    v_mul_f32 v37, 0x41800000, v32
    v_mfma_f32_16x16x32_bf16 v[120:123], a[56:59], a[76:79], v[120:123]
    ds_read_b64_tr_b16 a[70:71], v6 offset:9248
    v_mfma_f32_16x16x32_bf16 v[124:127], a[60:63], a[76:79], v[124:127]
    s_addk_i32 s61, 128
    s_bitset0_b32 s61, 11
    v_mul_f32 v41, 0x41800000, v33
    v_mfma_f32_16x16x32_bf16 v[124:127], a[44:47], a[72:75], v[124:127]
    s_waitcnt lgkmcnt(8)
    v_mfma_f32_16x16x32_bf16 v[140:143], a[44:47], a[80:83], v[140:143]
    ds_read_b64_tr_b16 a[72:73], v6 offset:64
    v_mfma_f32_16x16x32_bf16 v[140:143], a[60:63], a[84:87], v[140:143]
    ds_read_b64_tr_b16 a[74:75], v6 offset:1088
    v_exp_f32 v36, v36
    v_mfma_f32_16x16x32_bf16 v[136:139], a[56:59], a[84:87], v[136:139]
    s_mul_i32 s62, s61, 3584
    v_mfma_f32_16x16x32_bf16 v[136:139], a[40:43], a[80:83], v[136:139]
    ds_read_b64_tr_b16 a[76:77], v6 offset:8256
    v_mfma_f32_16x16x32_bf16 v[132:135], a[36:39], a[80:83], v[132:135]
    s_add_u32 m0, s58, 0x108000
    v_mfma_f32_16x16x32_bf16 v[132:135], a[52:55], a[84:87], v[132:135]
    ds_read_b64_tr_b16 a[78:79], v6 offset:9280
    v_mfma_f32_16x16x32_bf16 v[128:131], a[48:51], a[84:87], v[128:131]
    v_exp_f32 v40, v40
    v_mfma_f32_16x16x32_bf16 v[128:131], a[32:35], a[80:83], v[128:131]
    v_rndne_f32 v38, v37
    s_waitcnt lgkmcnt(8)
    v_mfma_f32_16x16x32_bf16 v[144:147], a[88:91], a[32:35], v[144:147]
    ds_read_b64_tr_b16 a[80:81], v6 offset:96
    v_mfma_f32_16x16x32_bf16 v[144:147], a[92:95], a[48:51], v[144:147]
    ds_read_b64_tr_b16 a[82:83], v6 offset:1120
    v_mfma_f32_16x16x32_bf16 v[148:151], a[92:95], a[52:55], v[148:151]
    buffer_load_dwordx4 v18, s[28:31], s62 offen offset:0  lds
    v_rndne_f32 v42, v41
    v_mfma_f32_16x16x32_bf16 v[148:151], a[88:91], a[36:39], v[148:151]
    ds_read_b64_tr_b16 a[84:85], v6 offset:8288
    v_mfma_f32_16x16x32_bf16 v[152:155], a[88:91], a[40:43], v[152:155]
    buffer_load_dwordx4 v19, s[28:31], s62 offen offset:1024  lds
    v_mfma_f32_16x16x32_bf16 v[152:155], a[92:95], a[56:59], v[152:155]
    ds_read_b64_tr_b16 a[86:87], v6 offset:9312
    v_sub_f32 v37, v37, v38
    v_mfma_f32_16x16x32_bf16 v[156:159], a[92:95], a[60:63], v[156:159]
    buffer_load_dwordx4 v20, s[28:31], s62 offen offset:2048  lds
    v_mfma_f32_16x16x32_bf16 v[156:159], a[88:91], a[44:47], v[156:159]
    s_waitcnt lgkmcnt(8)
    v_mfma_f32_16x16x32_bf16 v[172:175], a[64:67], a[44:47], v[172:175]
    ds_read_b64_tr_b16 a[88:89], v6 offset:128
    v_sub_f32 v41, v41, v42
    v_mfma_f32_16x16x32_bf16 v[172:175], a[68:71], a[60:63], v[172:175]
    ds_read_b64_tr_b16 a[90:91], v6 offset:1152
    v_mfma_f32_16x16x32_bf16 v[168:171], a[68:71], a[56:59], v[168:171]
    buffer_load_dwordx4 v21, s[28:31], s62 offen offset:3072  lds
    v_mfma_f32_16x16x32_bf16 v[168:171], a[64:67], a[40:43], v[168:171]
    ds_read_b64_tr_b16 a[92:93], v6 offset:8320
    v_mfma_f32_16x16x32_bf16 v[164:167], a[64:67], a[36:39], v[164:167]
    s_add_u32 m0, s57, 0x104000
    v_mfma_f32_16x16x32_bf16 v[164:167], a[68:71], a[52:55], v[164:167]
    ds_read_b64_tr_b16 a[94:95], v6 offset:9344
    v_mfma_f32_16x16x32_bf16 v[160:163], a[68:71], a[48:51], v[160:163]
    v_cos_f32 v38, v37
    v_mfma_f32_16x16x32_bf16 v[160:163], a[64:67], a[32:35], v[160:163]
    v_cos_f32 v42, v41
    s_waitcnt lgkmcnt(8)
    v_mfma_f32_16x16x32_bf16 v[176:179], a[72:75], a[32:35], v[176:179]
    ds_read_b64_tr_b16 a[64:65], v6 offset:160
    v_mfma_f32_16x16x32_bf16 v[176:179], a[76:79], a[48:51], v[176:179]
    ds_read_b64_tr_b16 a[66:67], v6 offset:1184
    v_mfma_f32_16x16x32_bf16 v[180:183], a[76:79], a[52:55], v[180:183]
    buffer_load_dwordx4 v16, s[24:27], s61 offen offset:0  lds
    v_sin_f32 v39, v37
    v_mfma_f32_16x16x32_bf16 v[180:183], a[72:75], a[36:39], v[180:183]
    ds_read_b64_tr_b16 a[68:69], v6 offset:8352
    v_mfma_f32_16x16x32_bf16 v[184:187], a[72:75], a[40:43], v[184:187]
    buffer_load_dwordx4 v17, s[24:27], s61 offen offset:1024  lds
    v_mfma_f32_16x16x32_bf16 v[184:187], a[76:79], a[56:59], v[184:187]
    ds_read_b64_tr_b16 a[70:71], v6 offset:9376
    v_sin_f32 v43, v41
    v_mfma_f32_16x16x32_bf16 v[188:191], a[76:79], a[60:63], v[188:191]
    s_add_u32 m0, s56, 0x108000
    v_mfma_f32_16x16x32_bf16 v[188:191], a[72:75], a[44:47], v[188:191]
    s_waitcnt lgkmcnt(8)
    v_mfma_f32_16x16x32_bf16 v[204:207], a[80:83], a[44:47], v[204:207]
    ds_read_b64_tr_b16 a[72:73], v6 offset:192
    v_mul_f32 v58, v36, v38
    v_mfma_f32_16x16x32_bf16 v[204:207], a[84:87], a[60:63], v[204:207]
    ds_read_b64_tr_b16 a[74:75], v6 offset:1216
    v_mfma_f32_16x16x32_bf16 v[200:203], a[84:87], a[56:59], v[200:203]
    buffer_load_dwordx4 v8, s[20:23], s61 offen offset:0  lds
    v_mfma_f32_16x16x32_bf16 v[200:203], a[80:83], a[40:43], v[200:203]
    ds_read_b64_tr_b16 a[76:77], v6 offset:8384
    v_mfma_f32_16x16x32_bf16 v[196:199], a[80:83], a[36:39], v[196:199]
    buffer_load_dwordx4 v9, s[20:23], s61 offen offset:1024  lds
    v_mfma_f32_16x16x32_bf16 v[196:199], a[84:87], a[52:55], v[196:199]
    ds_read_b64_tr_b16 a[78:79], v6 offset:9408
    v_mfma_f32_16x16x32_bf16 v[192:195], a[84:87], a[48:51], v[192:195]
    v_mul_f32 v60, v40, v42
    v_mfma_f32_16x16x32_bf16 v[192:195], a[80:83], a[32:35], v[192:195]
    s_waitcnt lgkmcnt(8)
    v_mfma_f32_16x16x32_bf16 v[208:211], a[88:91], a[32:35], v[208:211]
    buffer_load_dwordx4 v10, s[20:23], s61 offen offset:2048  lds
    v_mfma_f32_16x16x32_bf16 v[208:211], a[92:95], a[48:51], v[208:211]
    v_mul_f32 v59, v36, v39
    v_mfma_f32_16x16x32_bf16 v[212:215], a[92:95], a[52:55], v[212:215]
    buffer_load_dwordx4 v11, s[20:23], s61 offen offset:3072  lds
    v_mfma_f32_16x16x32_bf16 v[212:215], a[88:91], a[36:39], v[212:215]
    v_mul_f32 v61, v40, v43
    v_mfma_f32_16x16x32_bf16 v[216:219], a[88:91], a[40:43], v[216:219]
    v_mul_f32 v36, 0x42800000, v30
    v_mfma_f32_16x16x32_bf16 v[216:219], a[92:95], a[56:59], v[216:219]
    v_mfma_f32_16x16x32_bf16 v[220:223], a[92:95], a[60:63], v[220:223]
    s_add_u32 m0, s56, 0x109000
    v_mfma_f32_16x16x32_bf16 v[220:223], a[88:91], a[44:47], v[220:223]
    v_mul_f32 v40, 0x42800000, v31
    s_waitcnt vmcnt(13) lgkmcnt(0)
    s_barrier
    v_mfma_f32_16x16x32_bf16 v[236:239], a[64:67], a[44:47], v[236:239]
    ds_read_b128 a[80:83], v4 offset:8192
    v_mfma_f32_16x16x32_bf16 v[236:239], a[68:71], a[60:63], v[236:239]
    ds_read_b128 a[84:87], v5 offset:8192
    v_mfma_f32_16x16x32_bf16 v[232:235], a[68:71], a[56:59], v[232:235]
    ds_read_b128 a[0:3], v2 offset:0
    v_mul_f32 v37, 0x42800000, v32
    v_mfma_f32_16x16x32_bf16 v[232:235], a[64:67], a[40:43], v[232:235]
    ds_read_b128 a[16:19], v3 offset:0
    v_mfma_f32_16x16x32_bf16 v[228:231], a[64:67], a[36:39], v[228:231]
    buffer_load_dwordx4 v12, s[20:23], s61 offen offset:0  lds
    v_mfma_f32_16x16x32_bf16 v[228:231], a[68:71], a[52:55], v[228:231]
    ds_read_b128 a[4:7], v2 offset:2048
    buffer_load_dwordx4 v13, s[20:23], s61 offen offset:1024  lds
    v_mfma_f32_16x16x32_bf16 v[224:227], a[68:71], a[48:51], v[224:227]
    ds_read_b128 a[20:23], v3 offset:2048
    v_mul_f32 v41, 0x42800000, v33
    v_mfma_f32_16x16x32_bf16 v[224:227], a[64:67], a[32:35], v[224:227]
    buffer_load_dwordx4 v14, s[20:23], s61 offen offset:2048  lds
    v_mfma_f32_16x16x32_bf16 v[240:243], a[72:75], a[32:35], v[240:243]
    ds_read_b128 a[88:91], v4 offset:10240
    s_lshr_b32 s11, s14, 1
    s_cmp_eq_u32 s11, 3
    s_cselect_b32 s11, 0, 0x400
    v_mfma_f32_16x16x32_bf16 v[240:243], a[76:79], a[48:51], v[240:243]
    ds_read_b128 a[92:95], v5 offset:10240
    v_exp_f32 v36, v36
    v_mfma_f32_16x16x32_bf16 v[244:247], a[76:79], a[52:55], v[244:247]
    ds_read_b128 a[8:11], v2 offset:4096
    buffer_load_dwordx4 v15, s[20:23], s61 offen offset:3072  lds
    v_mfma_f32_16x16x32_bf16 v[244:247], a[72:75], a[36:39], v[244:247]
    ds_read_b128 a[24:27], v3 offset:4096
    buffer_atomic_add a104, v77, s[48:51], s11 offen
    v_mfma_f32_16x16x32_bf16 v[248:251], a[72:75], a[40:43], v[248:251]
    ds_read_b128 a[12:15], v2 offset:6144
    v_mfma_f32_16x16x32_bf16 v[248:251], a[76:79], a[56:59], v[248:251]
    ds_read_b128 a[28:31], v3 offset:6144
    v_mfma_f32_16x16x32_bf16 v[252:255], a[76:79], a[60:63], v[252:255]
    v_exp_f32 v40, v40
    v_mfma_f32_16x16x32_bf16 v[252:255], a[72:75], a[44:47], v[252:255]
    v_rndne_f32 v38, v37
    s_waitcnt lgkmcnt(6)
    v_mfma_f32_16x16x32_bf16 v[80:83], a[0:3], a[80:83], v[80:83]
    ds_read_b128 a[64:67], v4 offset:12288
    v_mfma_f32_16x16x32_bf16 v[80:83], a[16:19], a[84:87], v[80:83]
    ds_read_b128 a[72:75], v4 offset:14336
    v_mfma_f32_16x16x32_bf16 v[84:87], a[20:23], a[84:87], v[84:87]
    ds_read_b128 a[68:71], v5 offset:12288
    v_mfma_f32_16x16x32_bf16 v[84:87], a[4:7], a[80:83], v[84:87]
    ds_read_b128 a[76:79], v5 offset:14336
    s_waitcnt lgkmcnt(4)
    v_mfma_f32_16x16x32_bf16 v[88:91], a[8:11], a[80:83], v[88:91]
    v_rndne_f32 v42, v41
    v_mfma_f32_16x16x32_bf16 v[88:91], a[24:27], a[84:87], v[88:91]
    v_sub_f32 v37, v37, v38
    v_mfma_f32_16x16x32_bf16 v[92:95], a[28:31], a[84:87], v[92:95]
    v_mfma_f32_16x16x32_bf16 v[92:95], a[12:15], a[80:83], v[92:95]
    v_mfma_f32_16x16x32_bf16 v[108:111], a[12:15], a[88:91], v[108:111]
    ds_read_b64_tr_b16 a[80:81], v6 offset:16384
    v_sub_f32 v41, v41, v42
    v_mfma_f32_16x16x32_bf16 v[108:111], a[28:31], a[92:95], v[108:111]
    ds_read_b64_tr_b16 a[82:83], v6 offset:17408
    v_mfma_f32_16x16x32_bf16 v[104:107], a[24:27], a[92:95], v[104:107]
    s_addk_i32 s61, 128
    s_bitset0_b32 s61, 11
    v_mfma_f32_16x16x32_bf16 v[104:107], a[8:11], a[88:91], v[104:107]
    ds_read_b64_tr_b16 a[84:85], v6 offset:24576
    v_cos_f32 v38, v37
    v_mfma_f32_16x16x32_bf16 v[100:103], a[4:7], a[88:91], v[100:103]
    s_mul_i32 s62, s61, 3584
    v_mfma_f32_16x16x32_bf16 v[100:103], a[20:23], a[92:95], v[100:103]
    ds_read_b64_tr_b16 a[86:87], v6 offset:25600
    v_mfma_f32_16x16x32_bf16 v[96:99], a[16:19], a[92:95], v[96:99]
    s_add_u32 m0, s58, 0x100000
    v_cos_f32 v42, v41
    v_mfma_f32_16x16x32_bf16 v[96:99], a[0:3], a[88:91], v[96:99]
    s_waitcnt lgkmcnt(5)
    v_mfma_f32_16x16x32_bf16 v[112:115], a[0:3], a[64:67], v[112:115]
    ds_read_b64_tr_b16 a[88:89], v6 offset:16416
    v_mfma_f32_16x16x32_bf16 v[112:115], a[16:19], a[68:71], v[112:115]
    ds_read_b64_tr_b16 a[90:91], v6 offset:17440
    v_sin_f32 v39, v37
    v_mfma_f32_16x16x32_bf16 v[116:119], a[20:23], a[68:71], v[116:119]
    buffer_load_dwordx4 v18, s[28:31], s62 offen offset:0  lds
    v_mfma_f32_16x16x32_bf16 v[116:119], a[4:7], a[64:67], v[116:119]
    ds_read_b64_tr_b16 a[92:93], v6 offset:24608
    v_mfma_f32_16x16x32_bf16 v[120:123], a[8:11], a[64:67], v[120:123]
    buffer_load_dwordx4 v19, s[28:31], s62 offen offset:1024  lds
    v_mfma_f32_16x16x32_bf16 v[120:123], a[24:27], a[68:71], v[120:123]
    ds_read_b64_tr_b16 a[94:95], v6 offset:25632
    v_mfma_f32_16x16x32_bf16 v[124:127], a[28:31], a[68:71], v[124:127]
    v_sin_f32 v43, v41
    v_mfma_f32_16x16x32_bf16 v[124:127], a[12:15], a[64:67], v[124:127]
    s_waitcnt lgkmcnt(8)
    v_mfma_f32_16x16x32_bf16 v[140:143], a[12:15], a[72:75], v[140:143]
    ds_read_b64_tr_b16 a[64:65], v6 offset:16448
    v_mul_f32 v62, v36, v38
    v_mfma_f32_16x16x32_bf16 v[140:143], a[28:31], a[76:79], v[140:143]
    ds_read_b64_tr_b16 a[66:67], v6 offset:17472
    v_mfma_f32_16x16x32_bf16 v[136:139], a[24:27], a[76:79], v[136:139]
    buffer_load_dwordx4 v20, s[28:31], s62 offen offset:2048  lds
    v_mfma_f32_16x16x32_bf16 v[136:139], a[8:11], a[72:75], v[136:139]
    ds_read_b64_tr_b16 a[68:69], v6 offset:24640
    v_mul_f32 v64, v40, v42
    v_mfma_f32_16x16x32_bf16 v[132:135], a[4:7], a[72:75], v[132:135]
    buffer_load_dwordx4 v21, s[28:31], s62 offen offset:3072  lds
    v_mfma_f32_16x16x32_bf16 v[132:135], a[20:23], a[76:79], v[132:135]
    ds_read_b64_tr_b16 a[70:71], v6 offset:25664
    v_mfma_f32_16x16x32_bf16 v[128:131], a[16:19], a[76:79], v[128:131]
    s_add_u32 m0, s57, 0x100000
    v_mul_f32 v63, v36, v39
    v_mfma_f32_16x16x32_bf16 v[128:131], a[0:3], a[72:75], v[128:131]
    s_waitcnt lgkmcnt(8)
    v_mfma_f32_16x16x32_bf16 v[144:147], a[80:83], a[0:3], v[144:147]
    ds_read_b64_tr_b16 a[72:73], v6 offset:16480
    v_mfma_f32_16x16x32_bf16 v[144:147], a[84:87], a[16:19], v[144:147]
    ds_read_b64_tr_b16 a[74:75], v6 offset:17504
    v_mul_f32 v65, v40, v43
    v_mfma_f32_16x16x32_bf16 v[148:151], a[84:87], a[20:23], v[148:151]
    buffer_load_dwordx4 v16, s[24:27], s61 offen offset:0  lds
    v_mfma_f32_16x16x32_bf16 v[148:151], a[80:83], a[4:7], v[148:151]
    ds_read_b64_tr_b16 a[76:77], v6 offset:24672
    v_mfma_f32_16x16x32_bf16 v[152:155], a[80:83], a[8:11], v[152:155]
    buffer_load_dwordx4 v17, s[24:27], s61 offen offset:1024  lds
    v_mfma_f32_16x16x32_bf16 v[152:155], a[84:87], a[24:27], v[152:155]
    ds_read_b64_tr_b16 a[78:79], v6 offset:25696
    v_mfma_f32_16x16x32_bf16 v[156:159], a[84:87], a[28:31], v[156:159]
    v_mul_f32 v36, v35, v30
    v_mfma_f32_16x16x32_bf16 v[156:159], a[80:83], a[12:15], v[156:159]
    v_mul_f32 v40, v35, v31
    s_waitcnt lgkmcnt(8)
    v_mfma_f32_16x16x32_bf16 v[172:175], a[88:91], a[12:15], v[172:175]
    ds_read_b64_tr_b16 a[80:81], v6 offset:16512
    v_mfma_f32_16x16x32_bf16 v[172:175], a[92:95], a[28:31], v[172:175]
    ds_read_b64_tr_b16 a[82:83], v6 offset:17536
    v_mfma_f32_16x16x32_bf16 v[168:171], a[92:95], a[24:27], v[168:171]
    s_add_u32 m0, s56, 0x100000
    v_mul_f32 v37, v35, v32
    v_mfma_f32_16x16x32_bf16 v[168:171], a[88:91], a[8:11], v[168:171]
    ds_read_b64_tr_b16 a[84:85], v6 offset:24704
    v_mfma_f32_16x16x32_bf16 v[164:167], a[88:91], a[4:7], v[164:167]
    buffer_load_dwordx4 v8, s[20:23], s61 offen offset:0  lds
    v_mfma_f32_16x16x32_bf16 v[164:167], a[92:95], a[20:23], v[164:167]
    ds_read_b64_tr_b16 a[86:87], v6 offset:25728
    v_mul_f32 v41, v35, v33
    v_mfma_f32_16x16x32_bf16 v[160:163], a[92:95], a[16:19], v[160:163]
    buffer_load_dwordx4 v9, s[20:23], s61 offen offset:1024  lds
    v_mfma_f32_16x16x32_bf16 v[160:163], a[88:91], a[0:3], v[160:163]
    s_waitcnt lgkmcnt(8)
    v_mfma_f32_16x16x32_bf16 v[176:179], a[64:67], a[0:3], v[176:179]
    ds_read_b64_tr_b16 a[88:89], v6 offset:16544
    v_exp_f32 v36, v36
    v_mfma_f32_16x16x32_bf16 v[176:179], a[68:71], a[16:19], v[176:179]
    ds_read_b64_tr_b16 a[90:91], v6 offset:17568
    v_mfma_f32_16x16x32_bf16 v[180:183], a[68:71], a[20:23], v[180:183]
    buffer_load_dwordx4 v10, s[20:23], s61 offen offset:2048  lds
    v_mfma_f32_16x16x32_bf16 v[180:183], a[64:67], a[4:7], v[180:183]
    ds_read_b64_tr_b16 a[92:93], v6 offset:24736
    v_mfma_f32_16x16x32_bf16 v[184:187], a[64:67], a[8:11], v[184:187]
    buffer_load_dwordx4 v11, s[20:23], s61 offen offset:3072  lds
    v_mfma_f32_16x16x32_bf16 v[184:187], a[68:71], a[24:27], v[184:187]
    ds_read_b64_tr_b16 a[94:95], v6 offset:25760
    v_mfma_f32_16x16x32_bf16 v[188:191], a[68:71], a[28:31], v[188:191]
    v_exp_f32 v40, v40
    v_mfma_f32_16x16x32_bf16 v[188:191], a[64:67], a[12:15], v[188:191]
    v_rndne_f32 v38, v37
    s_waitcnt lgkmcnt(8)
    v_mfma_f32_16x16x32_bf16 v[204:207], a[72:75], a[12:15], v[204:207]
    ds_read_b64_tr_b16 a[64:65], v6 offset:16576
    v_mfma_f32_16x16x32_bf16 v[204:207], a[76:79], a[28:31], v[204:207]
    ds_read_b64_tr_b16 a[66:67], v6 offset:17600
    v_mfma_f32_16x16x32_bf16 v[200:203], a[76:79], a[24:27], v[200:203]
    s_add_u32 m0, s56, 0x101000
    v_rndne_f32 v42, v41
    v_mfma_f32_16x16x32_bf16 v[200:203], a[72:75], a[8:11], v[200:203]
L_hop_3:
    s_cbranch_execz L_hop_7
    s_nop 0
    ds_read_b64_tr_b16 a[68:69], v6 offset:24768
    v_mfma_f32_16x16x32_bf16 v[196:199], a[72:75], a[4:7], v[196:199]
    buffer_load_dwordx4 v12, s[20:23], s61 offen offset:0  lds
    v_mfma_f32_16x16x32_bf16 v[196:199], a[76:79], a[20:23], v[196:199]
    ds_read_b64_tr_b16 a[70:71], v6 offset:25792
    v_mfma_f32_16x16x32_bf16 v[192:195], a[76:79], a[16:19], v[192:195]
    buffer_load_dwordx4 v13, s[20:23], s61 offen offset:1024  lds
    v_mfma_f32_16x16x32_bf16 v[192:195], a[72:75], a[0:3], v[192:195]
    s_waitcnt lgkmcnt(8)
    v_mfma_f32_16x16x32_bf16 v[208:211], a[80:83], a[0:3], v[208:211]
    v_sub_f32 v37, v37, v38
    v_mfma_f32_16x16x32_bf16 v[208:211], a[84:87], a[16:19], v[208:211]
    buffer_load_dwordx4 v14, s[20:23], s61 offen offset:2048  lds
    v_mfma_f32_16x16x32_bf16 v[212:215], a[84:87], a[20:23], v[212:215]
    v_sub_f32 v41, v41, v42
    v_mfma_f32_16x16x32_bf16 v[212:215], a[80:83], a[4:7], v[212:215]
    v_cos_f32 v38, v37
    v_mfma_f32_16x16x32_bf16 v[216:219], a[80:83], a[8:11], v[216:219]
    buffer_load_dwordx4 v15, s[20:23], s61 offen offset:3072  lds
    v_mfma_f32_16x16x32_bf16 v[216:219], a[84:87], a[24:27], v[216:219]
    v_mfma_f32_16x16x32_bf16 v[220:223], a[84:87], a[28:31], v[220:223]
    v_cos_f32 v42, v41
    v_mfma_f32_16x16x32_bf16 v[220:223], a[80:83], a[12:15], v[220:223]
    s_waitcnt vmcnt(15) lgkmcnt(0)
    s_barrier
    v_mfma_f32_16x16x32_bf16 v[236:239], a[88:91], a[12:15], v[236:239]
    ds_read_b128 a[72:75], v4 offset:16384
    v_mfma_f32_16x16x32_bf16 v[236:239], a[92:95], a[28:31], v[236:239]
    ds_read_b128 a[76:79], v5 offset:16384
    v_sin_f32 v39, v37
    v_mfma_f32_16x16x32_bf16 v[232:235], a[92:95], a[24:27], v[232:235]
    ds_read_b128 a[32:35], v2 offset:32768
    v_mfma_f32_16x16x32_bf16 v[232:235], a[88:91], a[8:11], v[232:235]
    ds_read_b128 a[48:51], v3 offset:32768
    v_mfma_f32_16x16x32_bf16 v[228:231], a[88:91], a[4:7], v[228:231]
    buffer_load_dword a96, v78, s[32:35], s9 offen
    v_sin_f32 v43, v41
    v_mfma_f32_16x16x32_bf16 v[228:231], a[92:95], a[20:23], v[228:231]
    ds_read_b128 a[36:39], v2 offset:34816
    v_mfma_f32_16x16x32_bf16 v[224:227], a[92:95], a[16:19], v[224:227]
    ds_read_b128 a[52:55], v3 offset:34816
    v_mfma_f32_16x16x32_bf16 v[224:227], a[88:91], a[0:3], v[224:227]
    v_mul_f32 v66, v36, v38
    v_mfma_f32_16x16x32_bf16 v[240:243], a[64:67], a[0:3], v[240:243]
    ds_read_b128 a[80:83], v4 offset:18432
    v_mfma_f32_16x16x32_bf16 v[240:243], a[68:71], a[16:19], v[240:243]
    ds_read_b128 a[84:87], v5 offset:18432
    v_mfma_f32_16x16x32_bf16 v[244:247], a[68:71], a[20:23], v[244:247]
    ds_read_b128 a[40:43], v2 offset:36864
    v_mul_f32 v68, v40, v42
    v_mfma_f32_16x16x32_bf16 v[244:247], a[64:67], a[4:7], v[244:247]
    ds_read_b128 a[56:59], v3 offset:36864
    v_mfma_f32_16x16x32_bf16 v[248:251], a[64:67], a[8:11], v[248:251]
    ds_read_b128 a[44:47], v2 offset:38912
    v_mfma_f32_16x16x32_bf16 v[248:251], a[68:71], a[24:27], v[248:251]
    ds_read_b128 a[60:63], v3 offset:38912
    v_mfma_f32_16x16x32_bf16 v[252:255], a[68:71], a[28:31], v[252:255]
    v_mul_f32 v67, v36, v39
    v_mfma_f32_16x16x32_bf16 v[252:255], a[64:67], a[12:15], v[252:255]
    s_waitcnt lgkmcnt(6)
    v_mfma_f32_16x16x32_bf16 v[80:83], a[32:35], a[72:75], v[80:83]
    ds_read_b128 a[88:91], v4 offset:20480
    v_mfma_f32_16x16x32_bf16 v[80:83], a[48:51], a[76:79], v[80:83]
    ds_read_b128 a[64:67], v4 offset:22528
    v_mfma_f32_16x16x32_bf16 v[84:87], a[52:55], a[76:79], v[84:87]
    ds_read_b128 a[92:95], v5 offset:20480
    v_mfma_f32_16x16x32_bf16 v[84:87], a[36:39], a[72:75], v[84:87]
    ds_read_b128 a[68:71], v5 offset:22528
    s_waitcnt lgkmcnt(4)
    v_mfma_f32_16x16x32_bf16 v[88:91], a[40:43], a[72:75], v[88:91]
    v_mul_f32 v69, v40, v43
    v_mfma_f32_16x16x32_bf16 v[88:91], a[56:59], a[76:79], v[88:91]
    v_mul_f32 v36, v34, v30
    v_mfma_f32_16x16x32_bf16 v[92:95], a[60:63], a[76:79], v[92:95]
    v_mfma_f32_16x16x32_bf16 v[92:95], a[44:47], a[72:75], v[92:95]
    v_mfma_f32_16x16x32_bf16 v[108:111], a[44:47], a[80:83], v[108:111]
    ds_read_b64_tr_b16 a[72:73], v6 offset:32768
    v_mfma_f32_16x16x32_bf16 v[108:111], a[60:63], a[84:87], v[108:111]
    ds_read_b64_tr_b16 a[74:75], v6 offset:33792
    v_mfma_f32_16x16x32_bf16 v[104:107], a[56:59], a[84:87], v[104:107]
    v_mul_f32 v40, v34, v31
    v_mfma_f32_16x16x32_bf16 v[104:107], a[40:43], a[80:83], v[104:107]
    ds_read_b64_tr_b16 a[76:77], v6 offset:40960
    v_mfma_f32_16x16x32_bf16 v[100:103], a[36:39], a[80:83], v[100:103]
    v_mul_f32 v37, v34, v32
    v_mfma_f32_16x16x32_bf16 v[100:103], a[52:55], a[84:87], v[100:103]
    ds_read_b64_tr_b16 a[78:79], v6 offset:41984
    v_mfma_f32_16x16x32_bf16 v[96:99], a[48:51], a[84:87], v[96:99]
    v_mul_f32 v41, v34, v33
    v_mfma_f32_16x16x32_bf16 v[96:99], a[32:35], a[80:83], v[96:99]
    s_waitcnt lgkmcnt(5)
    v_mfma_f32_16x16x32_bf16 v[112:115], a[32:35], a[88:91], v[112:115]
    ds_read_b64_tr_b16 a[80:81], v6 offset:32800
    v_mfma_f32_16x16x32_bf16 v[112:115], a[48:51], a[92:95], v[112:115]
    ds_read_b64_tr_b16 a[82:83], v6 offset:33824
    v_mfma_f32_16x16x32_bf16 v[116:119], a[52:55], a[92:95], v[116:119]
    v_exp_f32 v36, v36
    v_mfma_f32_16x16x32_bf16 v[116:119], a[36:39], a[88:91], v[116:119]
    ds_read_b64_tr_b16 a[84:85], v6 offset:40992
    v_mfma_f32_16x16x32_bf16 v[120:123], a[40:43], a[88:91], v[120:123]
    v_exp_f32 v40, v40
    v_mfma_f32_16x16x32_bf16 v[120:123], a[56:59], a[92:95], v[120:123]
    ds_read_b64_tr_b16 a[86:87], v6 offset:42016
    v_mfma_f32_16x16x32_bf16 v[124:127], a[60:63], a[92:95], v[124:127]
    s_addk_i32 s61, 128
    s_bitset0_b32 s61, 11
    v_rndne_f32 v38, v37
    v_mfma_f32_16x16x32_bf16 v[124:127], a[44:47], a[88:91], v[124:127]
    s_waitcnt lgkmcnt(8)
    v_mfma_f32_16x16x32_bf16 v[140:143], a[44:47], a[64:67], v[140:143]
    ds_read_b64_tr_b16 a[88:89], v6 offset:32832
    v_mfma_f32_16x16x32_bf16 v[140:143], a[60:63], a[68:71], v[140:143]
    ds_read_b64_tr_b16 a[90:91], v6 offset:33856
    v_rndne_f32 v42, v41
    v_mfma_f32_16x16x32_bf16 v[136:139], a[56:59], a[68:71], v[136:139]
    s_mul_i32 s62, s61, 3584
    v_mfma_f32_16x16x32_bf16 v[136:139], a[40:43], a[64:67], v[136:139]
    ds_read_b64_tr_b16 a[92:93], v6 offset:41024
    v_mfma_f32_16x16x32_bf16 v[132:135], a[36:39], a[64:67], v[132:135]
    s_add_u32 m0, s58, 0x104000
    v_mfma_f32_16x16x32_bf16 v[132:135], a[52:55], a[68:71], v[132:135]
    ds_read_b64_tr_b16 a[94:95], v6 offset:42048
    v_mfma_f32_16x16x32_bf16 v[128:131], a[48:51], a[68:71], v[128:131]
    v_sub_f32 v37, v37, v38
    v_mfma_f32_16x16x32_bf16 v[128:131], a[32:35], a[64:67], v[128:131]
    s_waitcnt lgkmcnt(8)
    v_mfma_f32_16x16x32_bf16 v[144:147], a[72:75], a[32:35], v[144:147]
    ds_read_b64_tr_b16 a[64:65], v6 offset:32864
    v_sub_f32 v41, v41, v42
    v_mfma_f32_16x16x32_bf16 v[144:147], a[76:79], a[48:51], v[144:147]
    ds_read_b64_tr_b16 a[66:67], v6 offset:33888
    v_mfma_f32_16x16x32_bf16 v[148:151], a[76:79], a[52:55], v[148:151]
    buffer_load_dwordx4 v18, s[28:31], s62 offen offset:0  lds
    v_mfma_f32_16x16x32_bf16 v[148:151], a[72:75], a[36:39], v[148:151]
    ds_read_b64_tr_b16 a[68:69], v6 offset:41056
    v_cos_f32 v38, v37
    v_mfma_f32_16x16x32_bf16 v[152:155], a[72:75], a[40:43], v[152:155]
    buffer_load_dwordx4 v19, s[28:31], s62 offen offset:1024  lds
    v_mfma_f32_16x16x32_bf16 v[152:155], a[76:79], a[56:59], v[152:155]
    ds_read_b64_tr_b16 a[70:71], v6 offset:42080
    v_mfma_f32_16x16x32_bf16 v[156:159], a[76:79], a[60:63], v[156:159]
    buffer_load_dwordx4 v20, s[28:31], s62 offen offset:2048  lds
    v_cos_f32 v42, v41
    v_mfma_f32_16x16x32_bf16 v[156:159], a[72:75], a[44:47], v[156:159]
    s_waitcnt lgkmcnt(8)
    v_mfma_f32_16x16x32_bf16 v[172:175], a[80:83], a[44:47], v[172:175]
    ds_read_b64_tr_b16 a[72:73], v6 offset:32896
    v_mfma_f32_16x16x32_bf16 v[172:175], a[84:87], a[60:63], v[172:175]
    ds_read_b64_tr_b16 a[74:75], v6 offset:33920
    v_sin_f32 v39, v37
    v_mfma_f32_16x16x32_bf16 v[168:171], a[84:87], a[56:59], v[168:171]
    buffer_load_dwordx4 v21, s[28:31], s62 offen offset:3072  lds
    v_mfma_f32_16x16x32_bf16 v[168:171], a[80:83], a[40:43], v[168:171]
    ds_read_b64_tr_b16 a[76:77], v6 offset:41088
    v_mfma_f32_16x16x32_bf16 v[164:167], a[80:83], a[36:39], v[164:167]
    s_add_u32 m0, s57, 0x102000
    v_mfma_f32_16x16x32_bf16 v[164:167], a[84:87], a[52:55], v[164:167]
    ds_read_b64_tr_b16 a[78:79], v6 offset:42112
    v_mfma_f32_16x16x32_bf16 v[160:163], a[84:87], a[48:51], v[160:163]
    v_sin_f32 v43, v41
    v_mfma_f32_16x16x32_bf16 v[160:163], a[80:83], a[32:35], v[160:163]
    v_mul_f32 v70, v36, v38
    s_waitcnt lgkmcnt(8)
    v_mfma_f32_16x16x32_bf16 v[176:179], a[88:91], a[32:35], v[176:179]
    ds_read_b64_tr_b16 a[80:81], v6 offset:32928
    v_mfma_f32_16x16x32_bf16 v[176:179], a[92:95], a[48:51], v[176:179]
    ds_read_b64_tr_b16 a[82:83], v6 offset:33952
    v_mfma_f32_16x16x32_bf16 v[180:183], a[92:95], a[52:55], v[180:183]
    buffer_load_dwordx4 v16, s[24:27], s61 offen offset:0  lds
    v_mul_f32 v72, v40, v42
    v_mfma_f32_16x16x32_bf16 v[180:183], a[88:91], a[36:39], v[180:183]
    ds_read_b64_tr_b16 a[84:85], v6 offset:41120
    v_mfma_f32_16x16x32_bf16 v[184:187], a[88:91], a[40:43], v[184:187]
    buffer_load_dwordx4 v17, s[24:27], s61 offen offset:1024  lds
    v_mfma_f32_16x16x32_bf16 v[184:187], a[92:95], a[56:59], v[184:187]
    ds_read_b64_tr_b16 a[86:87], v6 offset:42144
    v_mul_f32 v71, v36, v39
    v_mfma_f32_16x16x32_bf16 v[188:191], a[92:95], a[60:63], v[188:191]
    s_add_u32 m0, s56, 0x108000
    v_mfma_f32_16x16x32_bf16 v[188:191], a[88:91], a[44:47], v[188:191]
    s_waitcnt lgkmcnt(8)
    v_mfma_f32_16x16x32_bf16 v[204:207], a[64:67], a[44:47], v[204:207]
    ds_read_b64_tr_b16 a[88:89], v6 offset:32960
    v_mul_f32 v73, v40, v43
    v_mfma_f32_16x16x32_bf16 v[204:207], a[68:71], a[60:63], v[204:207]
    ds_read_b64_tr_b16 a[90:91], v6 offset:33984
    v_mfma_f32_16x16x32_bf16 v[200:203], a[68:71], a[56:59], v[200:203]
    buffer_load_dwordx4 v8, s[20:23], s61 offen offset:0  lds
    v_mfma_f32_16x16x32_bf16 v[200:203], a[64:67], a[40:43], v[200:203]
    ds_read_b64_tr_b16 a[92:93], v6 offset:41152
    v_mfma_f32_16x16x32_bf16 v[196:199], a[64:67], a[36:39], v[196:199]
    buffer_load_dwordx4 v9, s[20:23], s61 offen offset:1024  lds
    v_mfma_f32_16x16x32_bf16 v[196:199], a[68:71], a[52:55], v[196:199]
    ds_read_b64_tr_b16 a[94:95], v6 offset:42176
    v_mfma_f32_16x16x32_bf16 v[192:195], a[68:71], a[48:51], v[192:195]
    v_mul_f32 v36, v24, v24
    v_mfma_f32_16x16x32_bf16 v[192:195], a[64:67], a[32:35], v[192:195]
    s_waitcnt lgkmcnt(8)
    v_mfma_f32_16x16x32_bf16 v[208:211], a[72:75], a[32:35], v[208:211]
    buffer_load_dwordx4 v10, s[20:23], s61 offen offset:2048  lds
    v_mfma_f32_16x16x32_bf16 v[208:211], a[76:79], a[48:51], v[208:211]
    v_mul_f32 v40, v25, v25
    v_mfma_f32_16x16x32_bf16 v[212:215], a[76:79], a[52:55], v[212:215]
    buffer_load_dwordx4 v11, s[20:23], s61 offen offset:3072  lds
    v_mfma_f32_16x16x32_bf16 v[212:215], a[72:75], a[36:39], v[212:215]
    v_fmac_f32 v36, v26, v26
    v_mfma_f32_16x16x32_bf16 v[216:219], a[72:75], a[40:43], v[216:219]
    v_mfma_f32_16x16x32_bf16 v[216:219], a[76:79], a[56:59], v[216:219]
    v_fmac_f32 v40, v27, v27
    v_mfma_f32_16x16x32_bf16 v[220:223], a[76:79], a[60:63], v[220:223]
    s_add_u32 m0, s56, 0x109000
    v_mfma_f32_16x16x32_bf16 v[220:223], a[72:75], a[44:47], v[220:223]
    s_waitcnt vmcnt(11) lgkmcnt(0)
    s_barrier
    v_mfma_f32_16x16x32_bf16 v[236:239], a[80:83], a[44:47], v[236:239]
    ds_read_b128 a[64:67], v4 offset:0
    v_rcp_f32 v36, v36
    v_mfma_f32_16x16x32_bf16 v[236:239], a[84:87], a[60:63], v[236:239]
    ds_read_b128 a[68:71], v5 offset:0
    v_mfma_f32_16x16x32_bf16 v[232:235], a[84:87], a[56:59], v[232:235]
    ds_read_b128 a[0:3], v2 offset:0
    v_mfma_f32_16x16x32_bf16 v[232:235], a[80:83], a[40:43], v[232:235]
    ds_read_b128 a[16:19], v3 offset:0
    v_rcp_f32 v40, v40
    v_mfma_f32_16x16x32_bf16 v[228:231], a[80:83], a[36:39], v[228:231]
    buffer_load_dwordx4 v12, s[20:23], s61 offen offset:0  lds
    v_mfma_f32_16x16x32_bf16 v[228:231], a[84:87], a[52:55], v[228:231]
    ds_read_b128 a[4:7], v2 offset:2048
    buffer_load_dwordx4 v13, s[20:23], s61 offen offset:1024  lds
    v_mfma_f32_16x16x32_bf16 v[224:227], a[84:87], a[48:51], v[224:227]
    ds_read_b128 a[20:23], v3 offset:2048
    v_add_f32 v37, -1.0, v50
    v_mfma_f32_16x16x32_bf16 v[224:227], a[80:83], a[32:35], v[224:227]
    buffer_load_dwordx4 v14, s[20:23], s61 offen offset:2048  lds
    v_mfma_f32_16x16x32_bf16 v[240:243], a[88:91], a[32:35], v[240:243]
    ds_read_b128 a[72:75], v4 offset:2048
    v_mfma_f32_16x16x32_bf16 v[240:243], a[92:95], a[48:51], v[240:243]
    ds_read_b128 a[76:79], v5 offset:2048
    v_add_f32 v41, -1.0, v52
    v_mfma_f32_16x16x32_bf16 v[244:247], a[92:95], a[52:55], v[244:247]
    ds_read_b128 a[8:11], v2 offset:4096
    buffer_load_dwordx4 v15, s[20:23], s61 offen offset:3072  lds
    v_mfma_f32_16x16x32_bf16 v[244:247], a[88:91], a[36:39], v[244:247]
    ds_read_b128 a[24:27], v3 offset:4096
    v_mfma_f32_16x16x32_bf16 v[248:251], a[88:91], a[40:43], v[248:251]
    ds_read_b128 a[12:15], v2 offset:6144
    v_mfma_f32_16x16x32_bf16 v[248:251], a[92:95], a[56:59], v[248:251]
    ds_read_b128 a[28:31], v3 offset:6144
    v_mfma_f32_16x16x32_bf16 v[252:255], a[92:95], a[60:63], v[252:255]
    v_add_f32 v36, v36, v36
    v_mfma_f32_16x16x32_bf16 v[252:255], a[88:91], a[44:47], v[252:255]
    v_add_f32 v40, v40, v40
    s_waitcnt lgkmcnt(6)
    v_mfma_f32_16x16x32_bf16 v[80:83], a[0:3], a[64:67], v[80:83]
    ds_read_b128 a[80:83], v4 offset:4096
    v_mfma_f32_16x16x32_bf16 v[80:83], a[16:19], a[68:71], v[80:83]
    ds_read_b128 a[88:91], v4 offset:6144
    v_mfma_f32_16x16x32_bf16 v[84:87], a[20:23], a[68:71], v[84:87]
    ds_read_b128 a[84:87], v5 offset:4096
    v_mfma_f32_16x16x32_bf16 v[84:87], a[4:7], a[64:67], v[84:87]
    ds_read_b128 a[92:95], v5 offset:6144
    s_waitcnt lgkmcnt(4)
    v_mfma_f32_16x16x32_bf16 v[88:91], a[8:11], a[64:67], v[88:91]
    v_mul_f32 v38, v37, v24
    v_mfma_f32_16x16x32_bf16 v[88:91], a[24:27], a[68:71], v[88:91]
    v_mul_f32 v42, v41, v25
    v_mfma_f32_16x16x32_bf16 v[92:95], a[28:31], a[68:71], v[92:95]
    v_mfma_f32_16x16x32_bf16 v[92:95], a[12:15], a[64:67], v[92:95]
    v_mfma_f32_16x16x32_bf16 v[108:111], a[12:15], a[72:75], v[108:111]
    ds_read_b64_tr_b16 a[64:65], v6 offset:0
    v_mfma_f32_16x16x32_bf16 v[108:111], a[28:31], a[76:79], v[108:111]
    ds_read_b64_tr_b16 a[66:67], v6 offset:1024
    v_mul_f32 v39, v51, v24
    v_mfma_f32_16x16x32_bf16 v[104:107], a[24:27], a[76:79], v[104:107]
    s_addk_i32 s61, 128
    s_bitset0_b32 s61, 11
    v_mfma_f32_16x16x32_bf16 v[104:107], a[8:11], a[72:75], v[104:107]
    ds_read_b64_tr_b16 a[68:69], v6 offset:8192
    v_mfma_f32_16x16x32_bf16 v[100:103], a[4:7], a[72:75], v[100:103]
    s_mul_i32 s62, s61, 3584
    v_mul_f32 v43, v53, v25
    v_mfma_f32_16x16x32_bf16 v[100:103], a[20:23], a[76:79], v[100:103]
    ds_read_b64_tr_b16 a[70:71], v6 offset:9216
    v_mfma_f32_16x16x32_bf16 v[96:99], a[16:19], a[76:79], v[96:99]
    s_add_u32 m0, s58, 0x108000
    v_mfma_f32_16x16x32_bf16 v[96:99], a[0:3], a[72:75], v[96:99]
    v_fmac_f32 v38, v51, v26
    s_waitcnt lgkmcnt(5)
    v_mfma_f32_16x16x32_bf16 v[112:115], a[0:3], a[80:83], v[112:115]
    ds_read_b64_tr_b16 a[72:73], v6 offset:32
    v_mfma_f32_16x16x32_bf16 v[112:115], a[16:19], a[84:87], v[112:115]
    ds_read_b64_tr_b16 a[74:75], v6 offset:1056
    v_mfma_f32_16x16x32_bf16 v[116:119], a[20:23], a[84:87], v[116:119]
    buffer_load_dwordx4 v18, s[28:31], s62 offen offset:0  lds
    v_fmac_f32 v42, v53, v27
    v_mfma_f32_16x16x32_bf16 v[116:119], a[4:7], a[80:83], v[116:119]
    ds_read_b64_tr_b16 a[76:77], v6 offset:8224
    v_mfma_f32_16x16x32_bf16 v[120:123], a[8:11], a[80:83], v[120:123]
    buffer_load_dwordx4 v19, s[28:31], s62 offen offset:1024  lds
    v_mfma_f32_16x16x32_bf16 v[120:123], a[24:27], a[84:87], v[120:123]
    ds_read_b64_tr_b16 a[78:79], v6 offset:9248
    v_mfma_f32_16x16x32_bf16 v[124:127], a[28:31], a[84:87], v[124:127]
    v_fma_f32 v39, -v37, v26, v39
    v_mfma_f32_16x16x32_bf16 v[124:127], a[12:15], a[80:83], v[124:127]
    s_waitcnt lgkmcnt(8)
    v_mfma_f32_16x16x32_bf16 v[140:143], a[12:15], a[88:91], v[140:143]
    ds_read_b64_tr_b16 a[80:81], v6 offset:64
    v_fma_f32 v43, -v41, v27, v43
    v_mfma_f32_16x16x32_bf16 v[140:143], a[28:31], a[92:95], v[140:143]
    ds_read_b64_tr_b16 a[82:83], v6 offset:1088
    v_mfma_f32_16x16x32_bf16 v[136:139], a[24:27], a[92:95], v[136:139]
    buffer_load_dwordx4 v20, s[28:31], s62 offen offset:2048  lds
    v_mfma_f32_16x16x32_bf16 v[136:139], a[8:11], a[88:91], v[136:139]
    ds_read_b64_tr_b16 a[84:85], v6 offset:8256
    v_mul_f32 v74, v38, v36
    v_mfma_f32_16x16x32_bf16 v[132:135], a[4:7], a[88:91], v[132:135]
    buffer_load_dwordx4 v21, s[28:31], s62 offen offset:3072  lds
    v_mfma_f32_16x16x32_bf16 v[132:135], a[20:23], a[92:95], v[132:135]
    ds_read_b64_tr_b16 a[86:87], v6 offset:9280
    v_mfma_f32_16x16x32_bf16 v[128:131], a[16:19], a[92:95], v[128:131]
    s_add_u32 m0, s57, 0x104000
    v_mul_f32 v76, v42, v40
    v_mfma_f32_16x16x32_bf16 v[128:131], a[0:3], a[88:91], v[128:131]
    s_waitcnt lgkmcnt(8)
    v_mfma_f32_16x16x32_bf16 v[144:147], a[64:67], a[0:3], v[144:147]
    ds_read_b64_tr_b16 a[88:89], v6 offset:96
    v_mfma_f32_16x16x32_bf16 v[144:147], a[68:71], a[16:19], v[144:147]
    ds_read_b64_tr_b16 a[90:91], v6 offset:1120
    v_mul_f32 v75, v39, v36
    v_mfma_f32_16x16x32_bf16 v[148:151], a[68:71], a[20:23], v[148:151]
    buffer_load_dwordx4 v16, s[24:27], s61 offen offset:0  lds
    v_mfma_f32_16x16x32_bf16 v[148:151], a[64:67], a[4:7], v[148:151]
    ds_read_b64_tr_b16 a[92:93], v6 offset:8288
    v_mfma_f32_16x16x32_bf16 v[152:155], a[64:67], a[8:11], v[152:155]
    buffer_load_dwordx4 v17, s[24:27], s61 offen offset:1024  lds
    v_mfma_f32_16x16x32_bf16 v[152:155], a[68:71], a[24:27], v[152:155]
    ds_read_b64_tr_b16 a[94:95], v6 offset:9312
    v_mfma_f32_16x16x32_bf16 v[156:159], a[68:71], a[28:31], v[156:159]
    v_mul_f32 v77, v43, v40
    v_mfma_f32_16x16x32_bf16 v[156:159], a[64:67], a[12:15], v[156:159]
    s_waitcnt lgkmcnt(8)
    v_mfma_f32_16x16x32_bf16 v[172:175], a[72:75], a[12:15], v[172:175]
    ds_read_b64_tr_b16 a[64:65], v6 offset:128
    v_mfma_f32_16x16x32_bf16 v[172:175], a[76:79], a[28:31], v[172:175]
    ds_read_b64_tr_b16 a[66:67], v6 offset:1152
    v_mfma_f32_16x16x32_bf16 v[168:171], a[76:79], a[24:27], v[168:171]
    s_add_u32 m0, s56, 0x100000
    s_add_u32 s59, s57, 32768
    v_mfma_f32_16x16x32_bf16 v[168:171], a[72:75], a[8:11], v[168:171]
    ds_read_b64_tr_b16 a[68:69], v6 offset:8320
    v_mfma_f32_16x16x32_bf16 v[164:167], a[72:75], a[4:7], v[164:167]
    buffer_load_dwordx4 v8, s[20:23], s61 offen offset:0  lds
    v_mfma_f32_16x16x32_bf16 v[164:167], a[76:79], a[20:23], v[164:167]
    ds_read_b64_tr_b16 a[70:71], v6 offset:9344
    s_sub_u32 s60, s58, 90112
    v_mfma_f32_16x16x32_bf16 v[160:163], a[76:79], a[16:19], v[160:163]
    buffer_load_dwordx4 v9, s[20:23], s61 offen offset:1024  lds
    v_mfma_f32_16x16x32_bf16 v[160:163], a[72:75], a[0:3], v[160:163]
    s_waitcnt lgkmcnt(8)
    v_mfma_f32_16x16x32_bf16 v[176:179], a[80:83], a[0:3], v[176:179]
    ds_read_b64_tr_b16 a[72:73], v6 offset:160
    v_mfma_f32_16x16x32_bf16 v[176:179], a[84:87], a[16:19], v[176:179]
    ds_read_b64_tr_b16 a[74:75], v6 offset:1184
    v_lshrrev_b32 v32, 4, v0
    v_mfma_f32_16x16x32_bf16 v[180:183], a[84:87], a[20:23], v[180:183]
    buffer_load_dwordx4 v10, s[20:23], s61 offen offset:2048  lds
    v_mfma_f32_16x16x32_bf16 v[180:183], a[80:83], a[4:7], v[180:183]
    ds_read_b64_tr_b16 a[76:77], v6 offset:8352
    v_mfma_f32_16x16x32_bf16 v[184:187], a[80:83], a[8:11], v[184:187]
    buffer_load_dwordx4 v11, s[20:23], s61 offen offset:3072  lds
    v_mfma_f32_16x16x32_bf16 v[184:187], a[84:87], a[24:27], v[184:187]
    ds_read_b64_tr_b16 a[78:79], v6 offset:9376
    v_mfma_f32_16x16x32_bf16 v[188:191], a[84:87], a[28:31], v[188:191]
    v_bfe_u32 v33, v0, 1, 3
    v_mfma_f32_16x16x32_bf16 v[188:191], a[80:83], a[12:15], v[188:191]
    s_waitcnt lgkmcnt(8)
    v_mfma_f32_16x16x32_bf16 v[204:207], a[88:91], a[12:15], v[204:207]
    ds_read_b64_tr_b16 a[80:81], v6 offset:192
    v_xor_b32 v33, v33, v32
    v_mfma_f32_16x16x32_bf16 v[204:207], a[92:95], a[28:31], v[204:207]
    ds_read_b64_tr_b16 a[82:83], v6 offset:1216
    v_lshlrev_b32 v7, 2, v0
    v_mfma_f32_16x16x32_bf16 v[200:203], a[92:95], a[24:27], v[200:203]
    s_add_u32 m0, s56, 0x101000
    v_mfma_f32_16x16x32_bf16 v[200:203], a[88:91], a[8:11], v[200:203]
    ds_read_b64_tr_b16 a[84:85], v6 offset:8384
    s_lshl_b32 s18, s15, 1
    v_mfma_f32_16x16x32_bf16 v[196:199], a[88:91], a[4:7], v[196:199]
    buffer_load_dwordx4 v12, s[20:23], s61 offen offset:0  lds
    v_mfma_f32_16x16x32_bf16 v[196:199], a[92:95], a[20:23], v[196:199]
    ds_read_b64_tr_b16 a[86:87], v6 offset:9408
    buffer_load_dword v23, off, s[48:51], 0 sc1
    v_mfma_f32_16x16x32_bf16 v[192:195], a[92:95], a[16:19], v[192:195]
    buffer_load_dwordx4 v13, s[20:23], s61 offen offset:1024  lds
    v_mfma_f32_16x16x32_bf16 v[192:195], a[88:91], a[0:3], v[192:195]
    s_waitcnt lgkmcnt(8)
    v_mfma_f32_16x16x32_bf16 v[208:211], a[64:67], a[0:3], v[208:211]
    v_add_u32 v33, s18, v33
    v_mfma_f32_16x16x32_bf16 v[208:211], a[68:71], a[16:19], v[208:211]
    buffer_load_dwordx4 v14, s[20:23], s61 offen offset:2048  lds
    v_mfma_f32_16x16x32_bf16 v[212:215], a[68:71], a[20:23], v[212:215]
    v_and_b32 v33, 7, v33
    v_mfma_f32_16x16x32_bf16 v[212:215], a[64:67], a[4:7], v[212:215]
    v_mfma_f32_16x16x32_bf16 v[216:219], a[64:67], a[8:11], v[216:219]
    buffer_load_dwordx4 v15, s[20:23], s61 offen offset:3072  lds
    v_mfma_f32_16x16x32_bf16 v[216:219], a[68:71], a[24:27], v[216:219]
    v_mfma_f32_16x16x32_bf16 v[220:223], a[68:71], a[28:31], v[220:223]
    v_and_b32 v34, 1, v0
    v_mfma_f32_16x16x32_bf16 v[220:223], a[64:67], a[12:15], v[220:223]
    s_waitcnt vmcnt(15) lgkmcnt(0)
    s_barrier
    v_mfma_f32_16x16x32_bf16 v[236:239], a[72:75], a[12:15], v[236:239]
    ds_read_b128 a[88:91], v4 offset:8192
    v_mfma_f32_16x16x32_bf16 v[236:239], a[76:79], a[28:31], v[236:239]
    ds_read_b128 a[92:95], v5 offset:8192
    buffer_load_dword a96, v79, s[36:39], s10 offen
    v_mfma_f32_16x16x32_bf16 v[232:235], a[76:79], a[24:27], v[232:235]
    ds_read_b128 a[32:35], v2 offset:32768
    v_lshlrev_b32 v34, 4, v34
    v_mfma_f32_16x16x32_bf16 v[232:235], a[72:75], a[8:11], v[232:235]
    ds_read_b128 a[48:51], v3 offset:32768
    v_mfma_f32_16x16x32_bf16 v[228:231], a[72:75], a[4:7], v[228:231]
    buffer_load_dword a96, v79, s[40:43], s10 offen
    v_mfma_f32_16x16x32_bf16 v[228:231], a[76:79], a[20:23], v[228:231]
    ds_read_b128 a[36:39], v2 offset:34816
    v_lshl_add_u32 v33, v33, 5, v34
    v_mfma_f32_16x16x32_bf16 v[224:227], a[76:79], a[16:19], v[224:227]
    ds_read_b128 a[52:55], v3 offset:34816
    v_mfma_f32_16x16x32_bf16 v[224:227], a[72:75], a[0:3], v[224:227]
    v_mfma_f32_16x16x32_bf16 v[240:243], a[80:83], a[0:3], v[240:243]
    ds_read_b128 a[64:67], v4 offset:10240
    v_lshl_add_u32 v33, v32, 11, v33
    v_mfma_f32_16x16x32_bf16 v[240:243], a[84:87], a[16:19], v[240:243]
    ds_read_b128 a[68:71], v5 offset:10240
    v_mfma_f32_16x16x32_bf16 v[244:247], a[84:87], a[20:23], v[244:247]
    ds_read_b128 a[40:43], v2 offset:36864
    v_mfma_f32_16x16x32_bf16 v[244:247], a[80:83], a[4:7], v[244:247]
    ds_read_b128 a[56:59], v3 offset:36864
    v_mfma_f32_16x16x32_bf16 v[248:251], a[80:83], a[8:11], v[248:251]
    ds_read_b128 a[44:47], v2 offset:38912
    v_mfma_f32_16x16x32_bf16 v[248:251], a[84:87], a[24:27], v[248:251]
    ds_read_b128 a[60:63], v3 offset:38912
    v_mfma_f32_16x16x32_bf16 v[252:255], a[84:87], a[28:31], v[252:255]
    s_lshl_b32 s18, s14, 8
    v_add_u32 v33, s18, v33
    v_mfma_f32_16x16x32_bf16 v[252:255], a[80:83], a[12:15], v[252:255]
    v_xor_b32 v34, 0x80, v33
    s_waitcnt lgkmcnt(6)
    v_mfma_f32_16x16x32_bf16 v[80:83], a[32:35], a[88:91], v[80:83]
    ds_read_b128 a[72:75], v4 offset:12288
    v_mfma_f32_16x16x32_bf16 v[80:83], a[48:51], a[92:95], v[80:83]
    ds_read_b128 a[80:83], v4 offset:14336
    v_mfma_f32_16x16x32_bf16 v[84:87], a[52:55], a[92:95], v[84:87]
    ds_read_b128 a[76:79], v5 offset:12288
    v_mfma_f32_16x16x32_bf16 v[84:87], a[36:39], a[88:91], v[84:87]
    ds_read_b128 a[84:87], v5 offset:14336
    s_waitcnt lgkmcnt(4)
    v_mfma_f32_16x16x32_bf16 v[88:91], a[40:43], a[88:91], v[88:91]
    s_lshl_b32 s18, s16, 14
    v_add_u32 v24, s18, v33
    v_mfma_f32_16x16x32_bf16 v[88:91], a[56:59], a[92:95], v[88:91]
    v_mfma_f32_16x16x32_bf16 v[92:95], a[60:63], a[92:95], v[92:95]
    s_add_u32 s18, s18, 7168
    v_add_u32 v25, s18, v34
    v_mfma_f32_16x16x32_bf16 v[92:95], a[44:47], a[88:91], v[92:95]
    v_mfma_f32_16x16x32_bf16 v[108:111], a[44:47], a[64:67], v[108:111]
    ds_read_b64_tr_b16 a[88:89], v6 offset:16384
    v_mfma_f32_16x16x32_bf16 v[108:111], a[60:63], a[68:71], v[108:111]
    ds_read_b64_tr_b16 a[90:91], v6 offset:17408
    v_mfma_f32_16x16x32_bf16 v[104:107], a[56:59], a[68:71], v[104:107]
    s_and_b32 s18, s16, 1
    s_lshr_b32 s19, s16, 1
    v_mfma_f32_16x16x32_bf16 v[104:107], a[40:43], a[64:67], v[104:107]
    ds_read_b64_tr_b16 a[92:93], v6 offset:24576
    v_mfma_f32_16x16x32_bf16 v[100:103], a[36:39], a[64:67], v[100:103]
    v_mfma_f32_16x16x32_bf16 v[100:103], a[52:55], a[68:71], v[100:103]
    ds_read_b64_tr_b16 a[94:95], v6 offset:25600
    v_mfma_f32_16x16x32_bf16 v[96:99], a[48:51], a[68:71], v[96:99]
    s_lshl2_add_u32 s18, s18, s19
    s_lshl_b32 s18, s18, 13
    v_mfma_f32_16x16x32_bf16 v[96:99], a[32:35], a[64:67], v[96:99]
    s_waitcnt lgkmcnt(5)
    v_mfma_f32_16x16x32_bf16 v[112:115], a[32:35], a[72:75], v[112:115]
    ds_read_b64_tr_b16 a[64:65], v6 offset:16416
    v_mfma_f32_16x16x32_bf16 v[112:115], a[48:51], a[76:79], v[112:115]
    ds_read_b64_tr_b16 a[66:67], v6 offset:17440
    v_mfma_f32_16x16x32_bf16 v[116:119], a[52:55], a[76:79], v[116:119]
    v_add_u32 v26, s18, v33
    v_mfma_f32_16x16x32_bf16 v[116:119], a[36:39], a[72:75], v[116:119]
    ds_read_b64_tr_b16 a[68:69], v6 offset:24608
    v_mfma_f32_16x16x32_bf16 v[120:123], a[40:43], a[72:75], v[120:123]
    s_add_u32 s18, s18, 15360
    v_add_u32 v27, s18, v34
    v_mfma_f32_16x16x32_bf16 v[120:123], a[56:59], a[76:79], v[120:123]
    ds_read_b64_tr_b16 a[70:71], v6 offset:25632
    v_mfma_f32_16x16x32_bf16 v[124:127], a[60:63], a[76:79], v[124:127]
    s_addk_i32 s61, 128
    s_bitset0_b32 s61, 11
    v_mfma_f32_16x16x32_bf16 v[124:127], a[44:47], a[72:75], v[124:127]
    s_waitcnt lgkmcnt(8)
    v_mfma_f32_16x16x32_bf16 v[140:143], a[44:47], a[80:83], v[140:143]
    ds_read_b64_tr_b16 a[72:73], v6 offset:16448
    v_and_b32 v33, 7, v0
    v_mfma_f32_16x16x32_bf16 v[140:143], a[60:63], a[84:87], v[140:143]
    ds_read_b64_tr_b16 a[74:75], v6 offset:17472
    v_mfma_f32_16x16x32_bf16 v[136:139], a[56:59], a[84:87], v[136:139]
    s_mul_i32 s62, s61, 3584
    v_mfma_f32_16x16x32_bf16 v[136:139], a[40:43], a[80:83], v[136:139]
    ds_read_b64_tr_b16 a[76:77], v6 offset:24640
    v_mfma_f32_16x16x32_bf16 v[132:135], a[36:39], a[80:83], v[132:135]
    s_add_u32 m0, s58, 0x100000
    v_mfma_f32_16x16x32_bf16 v[132:135], a[52:55], a[84:87], v[132:135]
    ds_read_b64_tr_b16 a[78:79], v6 offset:25664
    v_mfma_f32_16x16x32_bf16 v[128:131], a[48:51], a[84:87], v[128:131]
    v_xor_b32 v33, v33, v32
    v_mfma_f32_16x16x32_bf16 v[128:131], a[32:35], a[80:83], v[128:131]
    v_lshlrev_b32 v33, 4, v33
    s_waitcnt lgkmcnt(8)
    v_mfma_f32_16x16x32_bf16 v[144:147], a[88:91], a[32:35], v[144:147]
    ds_read_b64_tr_b16 a[80:81], v6 offset:16480
    v_mfma_f32_16x16x32_bf16 v[144:147], a[92:95], a[48:51], v[144:147]
    ds_read_b64_tr_b16 a[82:83], v6 offset:17504
    v_mfma_f32_16x16x32_bf16 v[148:151], a[92:95], a[52:55], v[148:151]
    buffer_load_dwordx4 v18, s[28:31], s62 offen offset:0  lds
    v_lshrrev_b32 v34, 3, v0
    v_mfma_f32_16x16x32_bf16 v[148:151], a[88:91], a[36:39], v[148:151]
    ds_read_b64_tr_b16 a[84:85], v6 offset:24672
    v_mfma_f32_16x16x32_bf16 v[152:155], a[88:91], a[40:43], v[152:155]
    buffer_load_dwordx4 v19, s[28:31], s62 offen offset:1024  lds
    v_mfma_f32_16x16x32_bf16 v[152:155], a[92:95], a[56:59], v[152:155]
    ds_read_b64_tr_b16 a[86:87], v6 offset:25696
    v_mfma_f32_16x16x32_bf16 v[156:159], a[92:95], a[60:63], v[156:159]
    buffer_load_dwordx4 v20, s[28:31], s62 offen offset:2048  lds
    v_lshl_add_u32 v33, v34, 11, v33
    v_mfma_f32_16x16x32_bf16 v[156:159], a[88:91], a[44:47], v[156:159]
    s_waitcnt lgkmcnt(8)
    v_mfma_f32_16x16x32_bf16 v[172:175], a[64:67], a[44:47], v[172:175]
    ds_read_b64_tr_b16 a[88:89], v6 offset:16512
    v_mfma_f32_16x16x32_bf16 v[172:175], a[68:71], a[60:63], v[172:175]
    ds_read_b64_tr_b16 a[90:91], v6 offset:17536
    s_add_u32 s18, s16, s15
    s_and_b32 s18, s18, 3
    v_mfma_f32_16x16x32_bf16 v[168:171], a[68:71], a[56:59], v[168:171]
    buffer_load_dwordx4 v21, s[28:31], s62 offen offset:3072  lds
    v_mfma_f32_16x16x32_bf16 v[168:171], a[64:67], a[40:43], v[168:171]
    ds_read_b64_tr_b16 a[92:93], v6 offset:24704
    v_mfma_f32_16x16x32_bf16 v[164:167], a[64:67], a[36:39], v[164:167]
    s_add_u32 m0, s57, 0x100000
    v_mfma_f32_16x16x32_bf16 v[164:167], a[68:71], a[52:55], v[164:167]
    ds_read_b64_tr_b16 a[94:95], v6 offset:25728
    v_mfma_f32_16x16x32_bf16 v[160:163], a[68:71], a[48:51], v[160:163]
    s_lshl2_add_u32 s18, s14, s18
    s_lshl_b32 s18, s18, 16
    v_mfma_f32_16x16x32_bf16 v[160:163], a[64:67], a[32:35], v[160:163]
    s_waitcnt lgkmcnt(8)
    v_mfma_f32_16x16x32_bf16 v[176:179], a[72:75], a[32:35], v[176:179]
    ds_read_b64_tr_b16 a[64:65], v6 offset:16544
    v_add_u32 v33, s18, v33
    v_mfma_f32_16x16x32_bf16 v[176:179], a[76:79], a[48:51], v[176:179]
    ds_read_b64_tr_b16 a[66:67], v6 offset:17568
    v_mfma_f32_16x16x32_bf16 v[180:183], a[76:79], a[52:55], v[180:183]
    buffer_load_dwordx4 v16, s[24:27], s61 offen offset:0  lds
    v_mfma_f32_16x16x32_bf16 v[180:183], a[72:75], a[36:39], v[180:183]
    ds_read_b64_tr_b16 a[68:69], v6 offset:24736
    v_mfma_f32_16x16x32_bf16 v[184:187], a[72:75], a[40:43], v[184:187]
    buffer_load_dwordx4 v17, s[24:27], s61 offen offset:1024  lds
    v_xor_b32 v34, 64, v33
    v_mfma_f32_16x16x32_bf16 v[184:187], a[76:79], a[56:59], v[184:187]
    ds_read_b64_tr_b16 a[70:71], v6 offset:25760
L_hop_4:
    s_cbranch_execz L_hop_8
    s_nop 0
    v_mfma_f32_16x16x32_bf16 v[188:191], a[76:79], a[60:63], v[188:191]
    s_add_u32 m0, s56, 0x108000
    v_mfma_f32_16x16x32_bf16 v[188:191], a[72:75], a[44:47], v[188:191]
    v_add_u32 v28, 0, v33
    s_waitcnt lgkmcnt(8)
    v_mfma_f32_16x16x32_bf16 v[204:207], a[80:83], a[44:47], v[204:207]
    ds_read_b64_tr_b16 a[72:73], v6 offset:16576
    v_mfma_f32_16x16x32_bf16 v[204:207], a[84:87], a[60:63], v[204:207]
    ds_read_b64_tr_b16 a[74:75], v6 offset:17600
    v_mfma_f32_16x16x32_bf16 v[200:203], a[84:87], a[56:59], v[200:203]
    buffer_load_dwordx4 v8, s[20:23], s61 offen offset:0  lds
    v_mfma_f32_16x16x32_bf16 v[200:203], a[80:83], a[40:43], v[200:203]
    ds_read_b64_tr_b16 a[76:77], v6 offset:24768
    v_mfma_f32_16x16x32_bf16 v[196:199], a[80:83], a[36:39], v[196:199]
    buffer_load_dwordx4 v9, s[20:23], s61 offen offset:1024  lds
    v_mfma_f32_16x16x32_bf16 v[196:199], a[84:87], a[52:55], v[196:199]
    ds_read_b64_tr_b16 a[78:79], v6 offset:25792
    v_mfma_f32_16x16x32_bf16 v[192:195], a[84:87], a[48:51], v[192:195]
    v_add_u32 v29, 15360, v34
    v_mfma_f32_16x16x32_bf16 v[192:195], a[80:83], a[32:35], v[192:195]
    s_waitcnt lgkmcnt(8)
    v_mfma_f32_16x16x32_bf16 v[208:211], a[88:91], a[32:35], v[208:211]
    buffer_load_dwordx4 v10, s[20:23], s61 offen offset:2048  lds
    v_mfma_f32_16x16x32_bf16 v[208:211], a[92:95], a[48:51], v[208:211]
    v_add_u32 v30, 30720, v33
    v_mfma_f32_16x16x32_bf16 v[212:215], a[92:95], a[52:55], v[212:215]
    buffer_load_dwordx4 v11, s[20:23], s61 offen offset:3072  lds
    v_mfma_f32_16x16x32_bf16 v[212:215], a[88:91], a[36:39], v[212:215]
    v_add_u32 v31, 46080, v34
    v_mfma_f32_16x16x32_bf16 v[216:219], a[88:91], a[40:43], v[216:219]
    v_mfma_f32_16x16x32_bf16 v[216:219], a[92:95], a[56:59], v[216:219]
    v_mfma_f32_16x16x32_bf16 v[220:223], a[92:95], a[60:63], v[220:223]
    s_add_u32 m0, s56, 0x109000
    v_mfma_f32_16x16x32_bf16 v[220:223], a[88:91], a[44:47], v[220:223]
    s_waitcnt vmcnt(12) lgkmcnt(0)
    s_barrier
    v_mfma_f32_16x16x32_bf16 v[236:239], a[64:67], a[44:47], v[236:239]
    ds_read_b128 a[80:83], v4 offset:16384
    v_mfma_f32_16x16x32_bf16 v[236:239], a[68:71], a[60:63], v[236:239]
    ds_read_b128 a[84:87], v5 offset:16384
    v_mfma_f32_16x16x32_bf16 v[232:235], a[68:71], a[56:59], v[232:235]
    ds_read_b128 a[0:3], v2 offset:0
    v_mfma_f32_16x16x32_bf16 v[232:235], a[64:67], a[40:43], v[232:235]
    ds_read_b128 a[16:19], v3 offset:0
    v_mfma_f32_16x16x32_bf16 v[228:231], a[64:67], a[36:39], v[228:231]
    buffer_load_dwordx4 v12, s[20:23], s61 offen offset:0  lds
    v_mfma_f32_16x16x32_bf16 v[228:231], a[68:71], a[52:55], v[228:231]
    ds_read_b128 a[4:7], v2 offset:2048
    buffer_load_dwordx4 v13, s[20:23], s61 offen offset:1024  lds
    v_mfma_f32_16x16x32_bf16 v[224:227], a[68:71], a[48:51], v[224:227]
    ds_read_b128 a[20:23], v3 offset:2048
    v_mfma_f32_16x16x32_bf16 v[224:227], a[64:67], a[32:35], v[224:227]
    buffer_load_dwordx4 v14, s[20:23], s61 offen offset:2048  lds
    v_mfma_f32_16x16x32_bf16 v[240:243], a[72:75], a[32:35], v[240:243]
    ds_read_b128 a[88:91], v4 offset:18432
    v_mfma_f32_16x16x32_bf16 v[240:243], a[76:79], a[48:51], v[240:243]
    ds_read_b128 a[92:95], v5 offset:18432
    v_mfma_f32_16x16x32_bf16 v[244:247], a[76:79], a[52:55], v[244:247]
    ds_read_b128 a[8:11], v2 offset:4096
    buffer_load_dwordx4 v15, s[20:23], s61 offen offset:3072  lds
    v_mfma_f32_16x16x32_bf16 v[244:247], a[72:75], a[36:39], v[244:247]
    ds_read_b128 a[24:27], v3 offset:4096
    v_mfma_f32_16x16x32_bf16 v[248:251], a[72:75], a[40:43], v[248:251]
    ds_read_b128 a[12:15], v2 offset:6144
    v_mfma_f32_16x16x32_bf16 v[248:251], a[76:79], a[56:59], v[248:251]
    ds_read_b128 a[28:31], v3 offset:6144
    v_mfma_f32_16x16x32_bf16 v[252:255], a[76:79], a[60:63], v[252:255]
    v_mfma_f32_16x16x32_bf16 v[252:255], a[72:75], a[44:47], v[252:255]
    s_waitcnt lgkmcnt(6)
    v_mfma_f32_16x16x32_bf16 v[80:83], a[0:3], a[80:83], v[80:83]
    ds_read_b128 a[64:67], v4 offset:20480
    v_mfma_f32_16x16x32_bf16 v[80:83], a[16:19], a[84:87], v[80:83]
    ds_read_b128 a[72:75], v4 offset:22528
    v_mfma_f32_16x16x32_bf16 v[84:87], a[20:23], a[84:87], v[84:87]
    ds_read_b128 a[68:71], v5 offset:20480
    v_mfma_f32_16x16x32_bf16 v[84:87], a[4:7], a[80:83], v[84:87]
    ds_read_b128 a[76:79], v5 offset:22528
    s_waitcnt lgkmcnt(4)
    v_mfma_f32_16x16x32_bf16 v[88:91], a[8:11], a[80:83], v[88:91]
    v_readfirstlane_b32 s18, v23
    s_nop 0
    s_cmp_ge_u32 s18, 256
    s_cbranch_scc0 L_slow_arr
L_back_arr:
    v_mfma_f32_16x16x32_bf16 v[88:91], a[24:27], a[84:87], v[88:91]
    v_mfma_f32_16x16x32_bf16 v[92:95], a[28:31], a[84:87], v[92:95]
    v_mfma_f32_16x16x32_bf16 v[92:95], a[12:15], a[80:83], v[92:95]
    s_lshl_b32 s18, s3, 8
    s_add_u32 s18, s18, 0x3100000
    v_mfma_f32_16x16x32_bf16 v[108:111], a[12:15], a[88:91], v[108:111]
    ds_read_b64_tr_b16 a[80:81], v6 offset:32768
    v_mfma_f32_16x16x32_bf16 v[108:111], a[28:31], a[92:95], v[108:111]
    ds_read_b64_tr_b16 a[82:83], v6 offset:33792
    v_mfma_f32_16x16x32_bf16 v[104:107], a[24:27], a[92:95], v[104:107]
    s_add_u32 s62, s89, 0x100000
    v_mfma_f32_16x16x32_bf16 v[104:107], a[8:11], a[88:91], v[104:107]
    ds_read_b64_tr_b16 a[84:85], v6 offset:40960
    v_mfma_f32_16x16x32_bf16 v[100:103], a[4:7], a[88:91], v[100:103]
    s_add_u32 m0, s59, 0x10a000
    v_mfma_f32_16x16x32_bf16 v[100:103], a[20:23], a[92:95], v[100:103]
    ds_read_b64_tr_b16 a[86:87], v6 offset:41984
    v_mfma_f32_16x16x32_bf16 v[96:99], a[16:19], a[92:95], v[96:99]
    v_and_b32 v78, 48, v0
    v_mfma_f32_16x16x32_bf16 v[96:99], a[0:3], a[88:91], v[96:99]
    v_lshlrev_b32 v78, 2, v78
    s_waitcnt lgkmcnt(5)
    v_mfma_f32_16x16x32_bf16 v[112:115], a[0:3], a[64:67], v[112:115]
    ds_read_b64_tr_b16 a[88:89], v6 offset:32800
    v_mfma_f32_16x16x32_bf16 v[112:115], a[16:19], a[68:71], v[112:115]
    ds_read_b64_tr_b16 a[90:91], v6 offset:33824
    v_and_b32 v7, 12, v0
    v_mfma_f32_16x16x32_bf16 v[116:119], a[20:23], a[68:71], v[116:119]
    buffer_load_dwordx4 v24, s[32:35], s62 offen offset:0  lds
    v_mfma_f32_16x16x32_bf16 v[116:119], a[4:7], a[64:67], v[116:119]
    ds_read_b64_tr_b16 a[92:93], v6 offset:40992
    v_mfma_f32_16x16x32_bf16 v[120:123], a[8:11], a[64:67], v[120:123]
    buffer_load_dwordx4 v25, s[32:35], s62 offen offset:1024  lds
    v_mfma_f32_16x16x32_bf16 v[120:123], a[24:27], a[68:71], v[120:123]
    ds_read_b64_tr_b16 a[94:95], v6 offset:42016
    v_mfma_f32_16x16x32_bf16 v[124:127], a[28:31], a[68:71], v[124:127]
    v_and_b32 v79, 3, v0
    v_mfma_f32_16x16x32_bf16 v[124:127], a[12:15], a[64:67], v[124:127]
    s_waitcnt lgkmcnt(8)
    v_mfma_f32_16x16x32_bf16 v[140:143], a[12:15], a[72:75], v[140:143]
    ds_read_b64_tr_b16 a[64:65], v6 offset:32832
    v_lshl_add_u32 v7, v7, 2, v79
    v_mfma_f32_16x16x32_bf16 v[140:143], a[28:31], a[76:79], v[140:143]
    ds_read_b64_tr_b16 a[66:67], v6 offset:33856
    v_mfma_f32_16x16x32_bf16 v[136:139], a[24:27], a[76:79], v[136:139]
    s_add_u32 s62, s89, 0x110000
    v_mfma_f32_16x16x32_bf16 v[136:139], a[8:11], a[72:75], v[136:139]
    ds_read_b64_tr_b16 a[68:69], v6 offset:41024
    v_mfma_f32_16x16x32_bf16 v[132:135], a[4:7], a[72:75], v[132:135]
    s_add_u32 m0, s59, 0x10c000
    v_lshlrev_b32 v7, 2, v7
    v_mfma_f32_16x16x32_bf16 v[132:135], a[20:23], a[76:79], v[132:135]
    ds_read_b64_tr_b16 a[70:71], v6 offset:42048
    v_mfma_f32_16x16x32_bf16 v[128:131], a[16:19], a[76:79], v[128:131]
    buffer_load_dwordx4 v24, s[32:35], s62 offen offset:0  lds
    v_mfma_f32_16x16x32_bf16 v[128:131], a[0:3], a[72:75], v[128:131]
    buffer_load_dwordx4 v[8:11], v78, s[4:7], s18 offen offset:0 sc1
    s_waitcnt lgkmcnt(8)
    v_mfma_f32_16x16x32_bf16 v[144:147], a[80:83], a[0:3], v[144:147]
    ds_read_b64_tr_b16 a[72:73], v6 offset:32864
    v_mfma_f32_16x16x32_bf16 v[144:147], a[84:87], a[16:19], v[144:147]
    ds_read_b64_tr_b16 a[74:75], v6 offset:33888
    v_mfma_f32_16x16x32_bf16 v[148:151], a[84:87], a[20:23], v[148:151]
    buffer_load_dwordx4 v25, s[32:35], s62 offen offset:1024  lds
    v_mfma_f32_16x16x32_bf16 v[148:151], a[80:83], a[4:7], v[148:151]
    ds_read_b64_tr_b16 a[76:77], v6 offset:41056
    v_mfma_f32_16x16x32_bf16 v[152:155], a[80:83], a[8:11], v[152:155]
    buffer_load_dwordx4 v[12:15], v78, s[4:7], s18 offen offset:16 sc1
    v_mfma_f32_16x16x32_bf16 v[152:155], a[84:87], a[24:27], v[152:155]
    ds_read_b64_tr_b16 a[78:79], v6 offset:42080
    v_mfma_f32_16x16x32_bf16 v[156:159], a[84:87], a[28:31], v[156:159]
    s_add_u32 s62, s89, 0x120000
    buffer_load_dwordx4 v[16:19], v78, s[4:7], s18 offen offset:32 sc1
    v_mfma_f32_16x16x32_bf16 v[156:159], a[80:83], a[12:15], v[156:159]
    s_waitcnt lgkmcnt(8)
    v_mfma_f32_16x16x32_bf16 v[172:175], a[88:91], a[12:15], v[172:175]
    ds_read_b64_tr_b16 a[80:81], v6 offset:32896
    v_mfma_f32_16x16x32_bf16 v[172:175], a[92:95], a[28:31], v[172:175]
    ds_read_b64_tr_b16 a[82:83], v6 offset:33920
    v_mfma_f32_16x16x32_bf16 v[168:171], a[92:95], a[24:27], v[168:171]
    s_add_u32 m0, s59, 0x10e000
    v_mfma_f32_16x16x32_bf16 v[168:171], a[88:91], a[8:11], v[168:171]
    ds_read_b64_tr_b16 a[84:85], v6 offset:41088
    v_mfma_f32_16x16x32_bf16 v[164:167], a[88:91], a[4:7], v[164:167]
    buffer_load_dwordx4 v[20:23], v78, s[4:7], s18 offen offset:48 sc1
    v_mfma_f32_16x16x32_bf16 v[164:167], a[92:95], a[20:23], v[164:167]
    ds_read_b64_tr_b16 a[86:87], v6 offset:42112
    buffer_load_dword v46, v7, s[4:7], s18 offen offset:0 sc1
    v_mfma_f32_16x16x32_bf16 v[160:163], a[92:95], a[16:19], v[160:163]
    buffer_load_dwordx4 v24, s[32:35], s62 offen offset:0  lds
    v_mfma_f32_16x16x32_bf16 v[160:163], a[88:91], a[0:3], v[160:163]
    s_waitcnt lgkmcnt(8)
    v_mfma_f32_16x16x32_bf16 v[176:179], a[64:67], a[0:3], v[176:179]
    ds_read_b64_tr_b16 a[88:89], v6 offset:32928
    v_mfma_f32_16x16x32_bf16 v[176:179], a[68:71], a[16:19], v[176:179]
    ds_read_b64_tr_b16 a[90:91], v6 offset:33952
    v_mfma_f32_16x16x32_bf16 v[180:183], a[68:71], a[20:23], v[180:183]
    buffer_load_dwordx4 v25, s[32:35], s62 offen offset:1024  lds
    v_mfma_f32_16x16x32_bf16 v[180:183], a[64:67], a[4:7], v[180:183]
    ds_read_b64_tr_b16 a[92:93], v6 offset:41120
    v_mfma_f32_16x16x32_bf16 v[184:187], a[64:67], a[8:11], v[184:187]
    buffer_load_dword v47, v7, s[4:7], s18 offen offset:16 sc1
    v_mfma_f32_16x16x32_bf16 v[184:187], a[68:71], a[24:27], v[184:187]
    ds_read_b64_tr_b16 a[94:95], v6 offset:42144
    buffer_load_dword v48, v7, s[4:7], s18 offen offset:32 sc1
    v_mfma_f32_16x16x32_bf16 v[188:191], a[68:71], a[28:31], v[188:191]
    s_add_u32 s62, s71, 0x100000
    v_mfma_f32_16x16x32_bf16 v[188:191], a[64:67], a[12:15], v[188:191]
    s_waitcnt lgkmcnt(8)
    v_mfma_f32_16x16x32_bf16 v[204:207], a[72:75], a[12:15], v[204:207]
    ds_read_b64_tr_b16 a[64:65], v6 offset:32960
    buffer_load_dword v49, v7, s[4:7], s18 offen offset:48 sc1
    v_mfma_f32_16x16x32_bf16 v[204:207], a[76:79], a[28:31], v[204:207]
    ds_read_b64_tr_b16 a[66:67], v6 offset:33984
    v_mfma_f32_16x16x32_bf16 v[200:203], a[76:79], a[24:27], v[200:203]
    s_add_u32 m0, s59, 0x102000
    v_mfma_f32_16x16x32_bf16 v[200:203], a[72:75], a[8:11], v[200:203]
    ds_read_b64_tr_b16 a[68:69], v6 offset:41152
    v_mfma_f32_16x16x32_bf16 v[196:199], a[72:75], a[4:7], v[196:199]
    v_mfma_f32_16x16x32_bf16 v[196:199], a[76:79], a[20:23], v[196:199]
    ds_read_b64_tr_b16 a[70:71], v6 offset:42176
    v_mfma_f32_16x16x32_bf16 v[192:195], a[76:79], a[16:19], v[192:195]
    buffer_load_dwordx4 v24, s[32:35], s62 offen offset:0  lds
    v_mfma_f32_16x16x32_bf16 v[192:195], a[72:75], a[0:3], v[192:195]
    s_waitcnt lgkmcnt(8)
    v_mfma_f32_16x16x32_bf16 v[208:211], a[80:83], a[0:3], v[208:211]
    s_lshl_b32 s19, s14, 14
    s_sub_u32 s56, s92, s19
    v_mfma_f32_16x16x32_bf16 v[208:211], a[84:87], a[16:19], v[208:211]
    buffer_load_dwordx4 v25, s[32:35], s62 offen offset:1024  lds
    v_mfma_f32_16x16x32_bf16 v[212:215], a[84:87], a[20:23], v[212:215]
    s_add_u32 s56, s56, 384
    v_mfma_f32_16x16x32_bf16 v[212:215], a[80:83], a[4:7], v[212:215]
    v_mfma_f32_16x16x32_bf16 v[216:219], a[80:83], a[8:11], v[216:219]
    s_add_u32 s62, s71, 0x110000
    v_mfma_f32_16x16x32_bf16 v[216:219], a[84:87], a[24:27], v[216:219]
    v_mfma_f32_16x16x32_bf16 v[220:223], a[84:87], a[28:31], v[220:223]
    s_mov_b32 s8, 0xffff0000
    v_mfma_f32_16x16x32_bf16 v[220:223], a[80:83], a[12:15], v[220:223]
    s_waitcnt vmcnt(16) lgkmcnt(0)
    s_barrier
    v_mfma_f32_16x16x32_bf16 v[236:239], a[88:91], a[12:15], v[236:239]
    ds_read_b128 a[72:75], v4 offset:0
    v_mfma_f32_16x16x32_bf16 v[236:239], a[92:95], a[28:31], v[236:239]
    ds_read_b128 a[76:79], v5 offset:0
    v_mfma_f32_16x16x32_bf16 v[232:235], a[92:95], a[24:27], v[232:235]
    ds_read_b128 a[32:35], v2 offset:32768
    s_mov_b32 s9, 0
    s_mov_b32 s10, 0
    v_mfma_f32_16x16x32_bf16 v[232:235], a[88:91], a[8:11], v[232:235]
    ds_read_b128 a[48:51], v3 offset:32768
    v_mfma_f32_16x16x32_bf16 v[228:231], a[88:91], a[4:7], v[228:231]
    s_add_u32 m0, s59, 0x104000
    v_mfma_f32_16x16x32_bf16 v[228:231], a[92:95], a[20:23], v[228:231]
    ds_read_b128 a[36:39], v2 offset:34816
    buffer_load_dwordx4 v24, s[32:35], s62 offen offset:0  lds
    v_mfma_f32_16x16x32_bf16 v[224:227], a[92:95], a[16:19], v[224:227]
    ds_read_b128 a[52:55], v3 offset:34816
    v_mfma_f32_16x16x32_bf16 v[224:227], a[88:91], a[0:3], v[224:227]
    s_mov_b32 s11, 0xffff
    v_mfma_f32_16x16x32_bf16 v[240:243], a[64:67], a[0:3], v[240:243]
    ds_read_b128 a[80:83], v4 offset:2048
    buffer_load_dwordx4 v25, s[32:35], s62 offen offset:1024  lds
    v_mfma_f32_16x16x32_bf16 v[240:243], a[68:71], a[16:19], v[240:243]
    ds_read_b128 a[84:87], v5 offset:2048
    v_mfma_f32_16x16x32_bf16 v[244:247], a[68:71], a[20:23], v[244:247]
    ds_read_b128 a[40:43], v2 offset:36864
    v_mfma_f32_16x16x32_bf16 v[244:247], a[64:67], a[4:7], v[244:247]
    ds_read_b128 a[56:59], v3 offset:36864
    v_mfma_f32_16x16x32_bf16 v[248:251], a[64:67], a[8:11], v[248:251]
    ds_read_b128 a[44:47], v2 offset:38912
    v_mfma_f32_16x16x32_bf16 v[248:251], a[68:71], a[24:27], v[248:251]
    ds_read_b128 a[60:63], v3 offset:38912
    v_mfma_f32_16x16x32_bf16 v[252:255], a[68:71], a[28:31], v[252:255]
    s_mov_b32 vcc_lo, 0
    s_mov_b32 vcc_hi, s8
    v_mfma_f32_16x16x32_bf16 v[252:255], a[64:67], a[12:15], v[252:255]
    s_mov_b32 s19, 0x7e000000
    s_waitcnt lgkmcnt(6)
    v_mfma_f32_16x16x32_bf16 v[80:83], a[32:35], a[72:75], v[80:83]
    ds_read_b128 a[88:91], v4 offset:4096
    s_add_u32 m0, s60, 0x100000
    v_mfma_f32_16x16x32_bf16 v[80:83], a[48:51], a[76:79], v[80:83]
    ds_read_b128 a[64:67], v4 offset:6144
    v_mfma_f32_16x16x32_bf16 v[84:87], a[52:55], a[76:79], v[84:87]
    ds_read_b128 a[92:95], v5 offset:4096
    v_mfma_f32_16x16x32_bf16 v[84:87], a[36:39], a[72:75], v[84:87]
    ds_read_b128 a[68:71], v5 offset:6144
    v_accvgpr_read_b32 v7, a137
    s_waitcnt lgkmcnt(4)
    v_mfma_f32_16x16x32_bf16 v[88:91], a[40:43], a[72:75], v[88:91]
    buffer_load_dwordx4 v28, s[36:39], s90 offen offset:0  lds
    v_mfma_f32_16x16x32_bf16 v[88:91], a[56:59], a[76:79], v[88:91]
    buffer_load_dwordx4 v29, s[36:39], s90 offen offset:1024  lds
    v_mfma_f32_16x16x32_bf16 v[92:95], a[60:63], a[76:79], v[92:95]
    s_add_u32 m0, s60, 0x100000
    v_mfma_f32_16x16x32_bf16 v[92:95], a[44:47], a[72:75], v[92:95]
    v_mfma_f32_16x16x32_bf16 v[108:111], a[44:47], a[80:83], v[108:111]
    ds_read_b64_tr_b16 a[72:73], v6 offset:0
    v_mfma_f32_16x16x32_bf16 v[108:111], a[60:63], a[84:87], v[108:111]
    ds_read_b64_tr_b16 a[74:75], v6 offset:1024
    v_mfma_f32_16x16x32_bf16 v[104:107], a[56:59], a[84:87], v[104:107]
    buffer_load_dwordx4 v30, s[36:39], s90 offen offset:2048  lds
    v_mfma_f32_16x16x32_bf16 v[104:107], a[40:43], a[80:83], v[104:107]
    ds_read_b64_tr_b16 a[76:77], v6 offset:8192
    v_mfma_f32_16x16x32_bf16 v[100:103], a[36:39], a[80:83], v[100:103]
    buffer_load_dwordx4 v31, s[36:39], s90 offen offset:3072  lds
    s_waitcnt vmcnt(8)
    v_mfma_f32_16x16x32_bf16 v[100:103], a[52:55], a[84:87], v[100:103]
    ds_read_b64_tr_b16 a[78:79], v6 offset:9216
    v_sub_f32 v42, 1.0, v46
    v_mfma_f32_16x16x32_bf16 v[96:99], a[48:51], a[84:87], v[96:99]
    s_add_u32 m0, s60, 0x104000
    v_sub_f32 v43, 1.0, v47
    v_mfma_f32_16x16x32_bf16 v[96:99], a[32:35], a[80:83], v[96:99]
    buffer_load_dwordx4 v28, s[40:43], s90 offen offset:0  lds
    s_waitcnt lgkmcnt(5)
    v_mfma_f32_16x16x32_bf16 v[112:115], a[32:35], a[88:91], v[112:115]
    ds_read_b64_tr_b16 a[80:81], v6 offset:32
    v_sub_f32 v44, 1.0, v48
    v_mfma_f32_16x16x32_bf16 v[112:115], a[48:51], a[92:95], v[112:115]
    ds_read_b64_tr_b16 a[82:83], v6 offset:1056
    v_sub_f32 v45, 1.0, v49
    v_mfma_f32_16x16x32_bf16 v[116:119], a[52:55], a[92:95], v[116:119]
    buffer_load_dwordx4 v29, s[40:43], s90 offen offset:1024  lds
    v_mfma_f32_16x16x32_bf16 v[116:119], a[36:39], a[88:91], v[116:119]
    ds_read_b64_tr_b16 a[84:85], v6 offset:8224
    v_cvt_pk_bf16_f32 v32, v42, v43
    v_mfma_f32_16x16x32_bf16 v[120:123], a[40:43], a[88:91], v[120:123]
    s_add_u32 m0, s60, 0x104000
    v_lshlrev_b32 v42, 16, v32
    v_mfma_f32_16x16x32_bf16 v[120:123], a[56:59], a[92:95], v[120:123]
    ds_read_b64_tr_b16 a[86:87], v6 offset:9248
    v_mfma_f32_16x16x32_bf16 v[124:127], a[60:63], a[92:95], v[124:127]
    buffer_load_dwordx4 v30, s[40:43], s90 offen offset:2048  lds
    v_and_b32 v43, s8, v32
    v_mfma_f32_16x16x32_bf16 v[124:127], a[44:47], a[88:91], v[124:127]
    buffer_load_dwordx4 v31, s[40:43], s90 offen offset:3072  lds
    s_waitcnt lgkmcnt(8)
    v_mfma_f32_16x16x32_bf16 v[140:143], a[44:47], a[64:67], v[140:143]
    ds_read_b64_tr_b16 a[88:89], v6 offset:64
    v_cvt_pk_bf16_f32 v32, v44, v45
    v_mfma_f32_16x16x32_bf16 v[140:143], a[60:63], a[68:71], v[140:143]
    ds_read_b64_tr_b16 a[90:91], v6 offset:1088
    v_lshlrev_b32 v44, 16, v32
    v_mfma_f32_16x16x32_bf16 v[136:139], a[56:59], a[68:71], v[136:139]
    s_add_u32 s62, s71, 0x120000
    v_and_b32 v45, s8, v32
    v_mfma_f32_16x16x32_bf16 v[136:139], a[40:43], a[64:67], v[136:139]
    ds_read_b64_tr_b16 a[92:93], v6 offset:8256
    v_mfma_f32_16x16x32_bf16 v[132:135], a[36:39], a[64:67], v[132:135]
    s_add_u32 m0, s59, 0x106000
    v_rcp_f32 v78, v42
    v_mfma_f32_16x16x32_bf16 v[132:135], a[52:55], a[68:71], v[132:135]
    ds_read_b64_tr_b16 a[94:95], v6 offset:9280
    v_rcp_f32 v79, v43
    v_mfma_f32_16x16x32_bf16 v[128:131], a[48:51], a[68:71], v[128:131]
    buffer_load_dwordx4 v24, s[32:35], s62 offen offset:0  lds
    v_mfma_f32_16x16x32_bf16 v[128:131], a[32:35], a[64:67], v[128:131]
    buffer_load_dwordx4 v25, s[32:35], s62 offen offset:1024  lds
    s_waitcnt lgkmcnt(8)
    v_mfma_f32_16x16x32_bf16 v[144:147], a[72:75], a[32:35], v[144:147]
    ds_read_b64_tr_b16 a[64:65], v6 offset:96
    v_rcp_f32 v40, v44
    v_mfma_f32_16x16x32_bf16 v[144:147], a[76:79], a[48:51], v[144:147]
    ds_read_b64_tr_b16 a[66:67], v6 offset:1120
    v_rcp_f32 v41, v45
    v_mfma_f32_16x16x32_bf16 v[148:151], a[76:79], a[52:55], v[148:151]
    s_add_u32 s62, s72, 0x100000
    v_min_f32 v78, s19, v78
    v_mfma_f32_16x16x32_bf16 v[148:151], a[72:75], a[36:39], v[148:151]
    ds_read_b64_tr_b16 a[68:69], v6 offset:8288
    v_min_f32 v79, s19, v79
    v_mfma_f32_16x16x32_bf16 v[152:155], a[72:75], a[40:43], v[152:155]
    s_add_u32 m0, s59, 0x108000
    v_mfma_f32_16x16x32_bf16 v[152:155], a[76:79], a[56:59], v[152:155]
    ds_read_b64_tr_b16 a[70:71], v6 offset:9312
    v_min_f32 v40, s19, v40
    v_mfma_f32_16x16x32_bf16 v[156:159], a[76:79], a[60:63], v[156:159]
    buffer_load_dwordx4 v24, s[32:35], s62 offen offset:0  lds
    v_min_f32 v41, s19, v41
    v_mfma_f32_16x16x32_bf16 v[156:159], a[72:75], a[44:47], v[156:159]
    buffer_load_dwordx4 v25, s[32:35], s62 offen offset:1024  lds
    s_waitcnt lgkmcnt(8)
    v_mfma_f32_16x16x32_bf16 v[172:175], a[80:83], a[44:47], v[172:175]
    ds_read_b64_tr_b16 a[72:73], v6 offset:128
    v_fmac_f32 v81, v50, v80
    v_mfma_f32_16x16x32_bf16 v[172:175], a[84:87], a[60:63], v[172:175]
    ds_read_b64_tr_b16 a[74:75], v6 offset:1152
    v_fmac_f32 v97, v52, v96
    v_mfma_f32_16x16x32_bf16 v[168:171], a[84:87], a[56:59], v[168:171]
    v_accvgpr_read_b32 v33, a145
    v_fmac_f32 v113, v50, v112
    v_fmac_f32 v129, v52, v128
    v_mfma_f32_16x16x32_bf16 v[168:171], a[80:83], a[40:43], v[168:171]
    ds_read_b64_tr_b16 a[76:77], v6 offset:8320
    v_fma_f32 v81, -v51, v112, v81
    v_mfma_f32_16x16x32_bf16 v[164:167], a[80:83], a[36:39], v[164:167]
    s_add_u32 m0, s60, 0x112000
    v_fma_f32 v97, -v53, v128, v97
    v_fmac_f32 v113, v51, v80
    v_mfma_f32_16x16x32_bf16 v[164:167], a[84:87], a[52:55], v[164:167]
    ds_read_b64_tr_b16 a[78:79], v6 offset:9344
    v_fmac_f32 v129, v53, v96
    v_mfma_f32_16x16x32_bf16 v[160:163], a[84:87], a[48:51], v[160:163]
    s_movk_i32 s62, 0
    v_fmac_f32 v82, v50, v81
    v_fmac_f32 v98, v52, v97
    v_mfma_f32_16x16x32_bf16 v[160:163], a[80:83], a[32:35], v[160:163]
    buffer_load_dwordx4 v33, s[20:23], s62 offen offset:0 lds
    v_fmac_f32 v114, v50, v113
    s_waitcnt lgkmcnt(8)
    v_mfma_f32_16x16x32_bf16 v[176:179], a[88:91], a[32:35], v[176:179]
    ds_read_b64_tr_b16 a[80:81], v6 offset:160
    v_fmac_f32 v130, v52, v129
    v_fma_f32 v82, -v51, v113, v82
    v_mfma_f32_16x16x32_bf16 v[176:179], a[92:95], a[48:51], v[176:179]
    ds_read_b64_tr_b16 a[82:83], v6 offset:1184
    v_fma_f32 v98, -v53, v129, v98
    v_mfma_f32_16x16x32_bf16 v[180:183], a[92:95], a[52:55], v[180:183]
    s_movk_i32 s62, 7168
    v_fmac_f32 v114, v51, v81
    v_fmac_f32 v130, v53, v97
    v_mfma_f32_16x16x32_bf16 v[180:183], a[88:91], a[36:39], v[180:183]
    ds_read_b64_tr_b16 a[84:85], v6 offset:8352
    v_fmac_f32 v83, v50, v82
    v_mfma_f32_16x16x32_bf16 v[184:187], a[88:91], a[40:43], v[184:187]
    buffer_load_dwordx4 v33, s[20:23], s62 offen offset:1024 lds
    v_fmac_f32 v99, v52, v98
    v_fmac_f32 v115, v50, v114
    v_mfma_f32_16x16x32_bf16 v[184:187], a[92:95], a[56:59], v[184:187]
    ds_read_b64_tr_b16 a[86:87], v6 offset:9376
    v_fmac_f32 v131, v52, v130
    v_mfma_f32_16x16x32_bf16 v[188:191], a[92:95], a[60:63], v[188:191]
    s_movk_i32 s62, 14336
    v_fma_f32 v83, -v51, v114, v83
    v_fma_f32 v99, -v53, v130, v99
    v_mfma_f32_16x16x32_bf16 v[188:191], a[88:91], a[44:47], v[188:191]
    buffer_load_dwordx4 v33, s[20:23], s62 offen offset:2048 lds
    v_fmac_f32 v115, v51, v82
    s_waitcnt lgkmcnt(8)
    v_mfma_f32_16x16x32_bf16 v[204:207], a[64:67], a[44:47], v[204:207]
    ds_read_b64_tr_b16 a[88:89], v6 offset:192
    v_fmac_f32 v131, v53, v98
    v_fmac_f32 v84, v50, v83
    v_mfma_f32_16x16x32_bf16 v[204:207], a[68:71], a[60:63], v[204:207]
    ds_read_b64_tr_b16 a[90:91], v6 offset:1216
    v_fmac_f32 v100, v52, v99
    v_mfma_f32_16x16x32_bf16 v[200:203], a[68:71], a[56:59], v[200:203]
    s_movk_i32 s62, 21504
    v_fmac_f32 v116, v50, v115
    v_fmac_f32 v132, v52, v131
    v_mfma_f32_16x16x32_bf16 v[200:203], a[64:67], a[40:43], v[200:203]
    ds_read_b64_tr_b16 a[92:93], v6 offset:8384
    buffer_load_dwordx4 v33, s[20:23], s62 offen offset:3072 lds
    v_fma_f32 v84, -v51, v115, v84
    v_mfma_f32_16x16x32_bf16 v[196:199], a[64:67], a[36:39], v[196:199]
    v_fma_f32 v100, -v53, v131, v100
    v_fmac_f32 v116, v51, v83
    v_mfma_f32_16x16x32_bf16 v[196:199], a[68:71], a[52:55], v[196:199]
    ds_read_b64_tr_b16 a[94:95], v6 offset:9408
    v_fmac_f32 v132, v53, v99
    v_mfma_f32_16x16x32_bf16 v[192:195], a[68:71], a[48:51], v[192:195]
    v_fmac_f32 v85, v50, v84
    v_fmac_f32 v101, v52, v100
    v_mfma_f32_16x16x32_bf16 v[192:195], a[64:67], a[32:35], v[192:195]
    v_fmac_f32 v117, v50, v116
    s_waitcnt lgkmcnt(8)
    v_mfma_f32_16x16x32_bf16 v[208:211], a[72:75], a[32:35], v[208:211]
    v_fmac_f32 v133, v52, v132
    v_fma_f32 v85, -v51, v116, v85
    v_mfma_f32_16x16x32_bf16 v[208:211], a[76:79], a[48:51], v[208:211]
    v_fma_f32 v101, -v53, v132, v101
    v_mfma_f32_16x16x32_bf16 v[212:215], a[76:79], a[52:55], v[212:215]
    v_fmac_f32 v117, v51, v84
    v_fmac_f32 v133, v53, v100
    v_mfma_f32_16x16x32_bf16 v[212:215], a[72:75], a[36:39], v[212:215]
    v_fmac_f32 v86, v50, v85
    v_mfma_f32_16x16x32_bf16 v[216:219], a[72:75], a[40:43], v[216:219]
    v_fmac_f32 v102, v52, v101
    v_fmac_f32 v118, v50, v117
    v_mfma_f32_16x16x32_bf16 v[216:219], a[76:79], a[56:59], v[216:219]
    v_fmac_f32 v134, v52, v133
    v_mfma_f32_16x16x32_bf16 v[220:223], a[76:79], a[60:63], v[220:223]
    v_fma_f32 v86, -v51, v117, v86
    v_fma_f32 v102, -v53, v133, v102
    v_mfma_f32_16x16x32_bf16 v[220:223], a[72:75], a[44:47], v[220:223]
    v_fmac_f32 v118, v51, v85
    s_waitcnt lgkmcnt(4)
    v_mfma_f32_16x16x32_bf16 v[236:239], a[80:83], a[44:47], v[236:239]
    v_fmac_f32 v134, v53, v101
    v_fmac_f32 v87, v50, v86
    v_mfma_f32_16x16x32_bf16 v[236:239], a[84:87], a[60:63], v[236:239]
    v_fmac_f32 v103, v52, v102
    v_mfma_f32_16x16x32_bf16 v[232:235], a[84:87], a[56:59], v[232:235]
    v_fmac_f32 v119, v50, v118
    v_fmac_f32 v135, v52, v134
    v_mfma_f32_16x16x32_bf16 v[232:235], a[80:83], a[40:43], v[232:235]
    v_fma_f32 v87, -v51, v118, v87
    v_mfma_f32_16x16x32_bf16 v[228:231], a[80:83], a[36:39], v[228:231]
    v_fma_f32 v103, -v53, v134, v103
    v_fmac_f32 v119, v51, v86
    v_mfma_f32_16x16x32_bf16 v[228:231], a[84:87], a[52:55], v[228:231]
    v_fmac_f32 v135, v53, v102
    v_mfma_f32_16x16x32_bf16 v[224:227], a[84:87], a[48:51], v[224:227]
    v_fmac_f32 v88, v50, v87
    v_fmac_f32 v104, v52, v103
    v_mfma_f32_16x16x32_bf16 v[224:227], a[80:83], a[32:35], v[224:227]
    v_fmac_f32 v120, v50, v119
    s_waitcnt lgkmcnt(0)
    v_mfma_f32_16x16x32_bf16 v[240:243], a[88:91], a[32:35], v[240:243]
    v_fmac_f32 v136, v52, v135
    v_fma_f32 v88, -v51, v119, v88
    v_mfma_f32_16x16x32_bf16 v[240:243], a[92:95], a[48:51], v[240:243]
    v_fma_f32 v104, -v53, v135, v104
    v_mfma_f32_16x16x32_bf16 v[244:247], a[92:95], a[52:55], v[244:247]
    v_fmac_f32 v120, v51, v87
    v_fmac_f32 v136, v53, v103
    v_mfma_f32_16x16x32_bf16 v[244:247], a[88:91], a[36:39], v[244:247]
    v_fmac_f32 v89, v50, v88
    v_mfma_f32_16x16x32_bf16 v[248:251], a[88:91], a[40:43], v[248:251]
    v_fmac_f32 v105, v52, v104
    v_fmac_f32 v121, v50, v120
    v_mfma_f32_16x16x32_bf16 v[248:251], a[92:95], a[56:59], v[248:251]
    v_fmac_f32 v137, v52, v136
    v_mfma_f32_16x16x32_bf16 v[252:255], a[92:95], a[60:63], v[252:255]
    v_fma_f32 v89, -v51, v120, v89
    v_fma_f32 v105, -v53, v136, v105
    v_mfma_f32_16x16x32_bf16 v[252:255], a[88:91], a[44:47], v[252:255]
    v_fmac_f32 v121, v51, v88
    v_fmac_f32 v137, v53, v104
L_mid:
    v_fmac_f32 v90, v50, v89
    v_fmac_f32 v106, v52, v105
    v_fmac_f32 v122, v50, v121
    v_fmac_f32 v138, v52, v137
    v_fma_f32 v90, -v51, v121, v90
    v_fma_f32 v106, -v53, v137, v106
    v_fmac_f32 v122, v51, v89
    v_fmac_f32 v138, v53, v105
    v_fmac_f32 v91, v50, v90
    v_fmac_f32 v107, v52, v106
    v_fmac_f32 v123, v50, v122
    v_fmac_f32 v139, v52, v138
    v_fma_f32 v91, -v51, v122, v91
    v_fma_f32 v107, -v53, v138, v107
    v_fmac_f32 v123, v51, v90
    v_fmac_f32 v139, v53, v106
    v_fmac_f32 v92, v50, v91
    v_fmac_f32 v108, v52, v107
    v_fmac_f32 v124, v50, v123
    v_fmac_f32 v140, v52, v139
    v_fma_f32 v92, -v51, v123, v92
    v_fma_f32 v108, -v53, v139, v108
    v_fmac_f32 v124, v51, v91
    v_fmac_f32 v140, v53, v107
    v_fmac_f32 v93, v50, v92
    v_fmac_f32 v109, v52, v108
    v_fmac_f32 v125, v50, v124
    v_fmac_f32 v141, v52, v140
    v_fma_f32 v93, -v51, v124, v93
    v_fma_f32 v109, -v53, v140, v109
    v_fmac_f32 v125, v51, v92
    v_fmac_f32 v141, v53, v108
    v_fmac_f32 v94, v50, v93
    v_fmac_f32 v110, v52, v109
    v_fmac_f32 v126, v50, v125
    v_fmac_f32 v142, v52, v141
    v_fma_f32 v94, -v51, v125, v94
    v_fma_f32 v110, -v53, v141, v110
    v_fmac_f32 v126, v51, v93
    v_fmac_f32 v142, v53, v109
    v_fmac_f32 v95, v50, v94
    v_fmac_f32 v111, v52, v110
    v_fmac_f32 v127, v50, v126
    v_fmac_f32 v143, v52, v142
    v_fma_f32 v95, -v51, v126, v95
    v_fma_f32 v111, -v53, v142, v111
    v_fmac_f32 v127, v51, v94
    v_fmac_f32 v143, v53, v110
    v_accvgpr_read_b32 v6, a136
    v_mov_b32 v32, v95
    v_mov_b32 v34, v95
    v_mov_b32 v33, v127
    v_mov_b32 v35, v127
    s_nop 0
    v_permlane16_swap_b32 v32, v34
    v_permlane16_swap_b32 v33, v35
    v_mov_b64 v[36:37], v[32:33]
    v_mov_b64 v[38:39], v[34:35]
    s_nop 0
    v_permlane32_swap_b32 v32, v36
    v_permlane32_swap_b32 v33, v37
    v_permlane32_swap_b32 v34, v38
    v_permlane32_swap_b32 v35, v39
    v_cndmask_b32 v2, 0, v32, s[8:9]
    v_cndmask_b32 v3, 0, v33, s[8:9]
    v_pk_fma_f32 v[34:35], v[32:33], v[58:59], v[34:35] op_sel:[0,0,0] op_sel_hi:[1,0,1]
    v_pk_fma_f32 v[34:35], v[32:33], v[58:59], v[34:35] op_sel:[1,1,0] op_sel_hi:[0,1,1] neg_lo:[0,1,0]
    v_cndmask_b32 v2, v2, v34, s[10:11]
    v_cndmask_b32 v3, v3, v35, s[10:11]
    v_pk_fma_f32 v[36:37], v[34:35], v[58:59], v[36:37] op_sel:[0,0,0] op_sel_hi:[1,0,1]
    v_pk_fma_f32 v[36:37], v[34:35], v[58:59], v[36:37] op_sel:[1,1,0] op_sel_hi:[0,1,1] neg_lo:[0,1,0]
    v_cndmask_b32 v2, v2, v36, vcc
    v_cndmask_b32 v3, v3, v37, vcc
    v_pk_fma_f32 v[38:39], v[36:37], v[58:59], v[38:39] op_sel:[0,0,0] op_sel_hi:[1,0,1]
    v_pk_fma_f32 v[58:59], v[36:37], v[58:59], v[38:39] op_sel:[1,1,0] op_sel_hi:[0,1,1] neg_lo:[0,1,0]
    v_mov_b32 v32, v111
    v_mov_b32 v34, v111
    v_mov_b32 v33, v143
    v_mov_b32 v35, v143
    s_nop 0
    v_permlane16_swap_b32 v32, v34
    v_permlane16_swap_b32 v33, v35
    v_mov_b64 v[36:37], v[32:33]
    v_mov_b64 v[38:39], v[34:35]
    s_nop 0
    v_permlane32_swap_b32 v32, v36
    v_permlane32_swap_b32 v33, v37
L_hop_5:
    s_cbranch_execz L_hop_9
    s_nop 0
    v_permlane32_swap_b32 v34, v38
    v_permlane32_swap_b32 v35, v39
    v_cndmask_b32 v4, 0, v32, s[8:9]
    v_cndmask_b32 v5, 0, v33, s[8:9]
    v_pk_fma_f32 v[34:35], v[32:33], v[60:61], v[34:35] op_sel:[0,0,0] op_sel_hi:[1,0,1]
    v_pk_fma_f32 v[34:35], v[32:33], v[60:61], v[34:35] op_sel:[1,1,0] op_sel_hi:[0,1,1] neg_lo:[0,1,0]
    v_cndmask_b32 v4, v4, v34, s[10:11]
    v_cndmask_b32 v5, v5, v35, s[10:11]
    v_pk_fma_f32 v[36:37], v[34:35], v[60:61], v[36:37] op_sel:[0,0,0] op_sel_hi:[1,0,1]
    v_pk_fma_f32 v[36:37], v[34:35], v[60:61], v[36:37] op_sel:[1,1,0] op_sel_hi:[0,1,1] neg_lo:[0,1,0]
    v_cndmask_b32 v4, v4, v36, vcc
    v_cndmask_b32 v5, v5, v37, vcc
    v_pk_fma_f32 v[38:39], v[36:37], v[60:61], v[38:39] op_sel:[0,0,0] op_sel_hi:[1,0,1]
    v_pk_fma_f32 v[60:61], v[36:37], v[60:61], v[38:39] op_sel:[1,1,0] op_sel_hi:[0,1,1] neg_lo:[0,1,0]
    buffer_store_dwordx4 v[58:61], v6, s[4:7], s92 offen sc1
    v_accvgpr_read_b32 v6, a138
    .p2align 3
    s_add_u32 s63, s86, 0x100000
    v_pk_mul_f32 v[32:33], v[144:145], v[144:145]
    v_pk_mul_f32 v[34:35], v[146:147], v[146:147]
    v_pk_mul_f32 v[36:37], v[160:161], v[160:161]
    v_pk_mul_f32 v[38:39], v[162:163], v[162:163]
    v_pk_fma_f32 v[32:33], v[32:33], s[94:95], s[94:95] op_sel:[0,0,1] op_sel_hi:[1,0,1]
    v_pk_fma_f32 v[34:35], v[34:35], s[94:95], s[94:95] op_sel:[0,0,1] op_sel_hi:[1,0,1]
    v_pk_fma_f32 v[36:37], v[36:37], s[94:95], s[94:95] op_sel:[0,0,1] op_sel_hi:[1,0,1]
    v_pk_fma_f32 v[38:39], v[38:39], s[94:95], s[94:95] op_sel:[0,0,1] op_sel_hi:[1,0,1]
    v_pk_mul_f32 v[32:33], v[32:33], v[144:145]
    v_pk_mul_f32 v[34:35], v[34:35], v[146:147]
    v_pk_mul_f32 v[36:37], v[36:37], v[160:161]
    v_pk_mul_f32 v[38:39], v[38:39], v[162:163]
    v_exp_f32_e32 v32, v32
    v_exp_f32_e32 v34, v34
    v_exp_f32_e32 v36, v36
    v_exp_f32_e32 v38, v38
    v_exp_f32_e32 v33, v33
    v_exp_f32_e32 v35, v35
    v_exp_f32_e32 v37, v37
    v_exp_f32_e32 v39, v39
    v_pk_fma_f32 v[32:33], v[32:33], v[78:79], v[78:79] op_sel:[0,0,0] op_sel_hi:[1,0,0]
    v_pk_fma_f32 v[34:35], v[34:35], v[78:79], v[78:79] op_sel:[0,0,0] op_sel_hi:[1,0,0]
    v_pk_fma_f32 v[36:37], v[36:37], v[78:79], v[78:79] op_sel:[0,0,0] op_sel_hi:[1,0,0]
    v_pk_fma_f32 v[38:39], v[38:39], v[78:79], v[78:79] op_sel:[0,0,0] op_sel_hi:[1,0,0]
    v_rcp_f32_e32 v32, v32
    v_rcp_f32_e32 v34, v34
    v_rcp_f32_e32 v36, v36
    v_rcp_f32_e32 v38, v38
    v_rcp_f32_e32 v33, v33
    v_rcp_f32_e32 v35, v35
    v_rcp_f32_e32 v37, v37
    v_rcp_f32_e32 v39, v39
    v_pk_mul_f32 v[32:33], v[32:33], v[144:145]
    v_pk_mul_f32 v[34:35], v[34:35], v[146:147]
    v_pk_mul_f32 v[36:37], v[36:37], v[160:161]
    v_pk_mul_f32 v[38:39], v[38:39], v[162:163]
    v_cvt_pk_bf16_f32 v144, v32, v33
    v_cvt_pk_bf16_f32 v145, v34, v35
    v_cvt_pk_bf16_f32 v146, v36, v37
    v_cvt_pk_bf16_f32 v147, v38, v39
    buffer_store_dwordx4 v[144:147], v1, s[4:7], s63 offen offset:0 sc1
    v_pk_mul_f32 v[32:33], v[148:149], v[148:149]
    v_pk_mul_f32 v[34:35], v[150:151], v[150:151]
    v_pk_mul_f32 v[36:37], v[164:165], v[164:165]
    v_pk_mul_f32 v[38:39], v[166:167], v[166:167]
    v_pk_fma_f32 v[32:33], v[32:33], s[94:95], s[94:95] op_sel:[0,0,1] op_sel_hi:[1,0,1]
    v_pk_fma_f32 v[34:35], v[34:35], s[94:95], s[94:95] op_sel:[0,0,1] op_sel_hi:[1,0,1]
    v_pk_fma_f32 v[36:37], v[36:37], s[94:95], s[94:95] op_sel:[0,0,1] op_sel_hi:[1,0,1]
    v_pk_fma_f32 v[38:39], v[38:39], s[94:95], s[94:95] op_sel:[0,0,1] op_sel_hi:[1,0,1]
    v_pk_mul_f32 v[32:33], v[32:33], v[148:149]
    v_pk_mul_f32 v[34:35], v[34:35], v[150:151]
    v_pk_mul_f32 v[36:37], v[36:37], v[164:165]
    v_pk_mul_f32 v[38:39], v[38:39], v[166:167]
    v_exp_f32_e32 v32, v32
    v_exp_f32_e32 v34, v34
    v_exp_f32_e32 v36, v36
    v_exp_f32_e32 v38, v38
    v_exp_f32_e32 v33, v33
    v_exp_f32_e32 v35, v35
    v_exp_f32_e32 v37, v37
    v_exp_f32_e32 v39, v39
    v_pk_fma_f32 v[32:33], v[32:33], v[78:79], v[78:79] op_sel:[0,1,1] op_sel_hi:[1,1,1]
    v_pk_fma_f32 v[34:35], v[34:35], v[78:79], v[78:79] op_sel:[0,1,1] op_sel_hi:[1,1,1]
    v_pk_fma_f32 v[36:37], v[36:37], v[78:79], v[78:79] op_sel:[0,1,1] op_sel_hi:[1,1,1]
    v_pk_fma_f32 v[38:39], v[38:39], v[78:79], v[78:79] op_sel:[0,1,1] op_sel_hi:[1,1,1]
    v_rcp_f32_e32 v32, v32
    v_rcp_f32_e32 v34, v34
    v_rcp_f32_e32 v36, v36
    v_rcp_f32_e32 v38, v38
    v_rcp_f32_e32 v33, v33
    v_rcp_f32_e32 v35, v35
    v_rcp_f32_e32 v37, v37
    v_rcp_f32_e32 v39, v39
    v_pk_mul_f32 v[32:33], v[32:33], v[148:149]
    v_pk_mul_f32 v[34:35], v[34:35], v[150:151]
    v_pk_mul_f32 v[36:37], v[36:37], v[164:165]
    v_pk_mul_f32 v[38:39], v[38:39], v[166:167]
    v_cvt_pk_bf16_f32 v148, v32, v33
    v_cvt_pk_bf16_f32 v149, v34, v35
    v_cvt_pk_bf16_f32 v150, v36, v37
    v_cvt_pk_bf16_f32 v151, v38, v39
    buffer_store_dwordx4 v[148:151], v1, s[4:7], s63 offen offset:1024 sc1
    v_pk_mul_f32 v[32:33], v[152:153], v[152:153]
    v_pk_mul_f32 v[34:35], v[154:155], v[154:155]
    v_pk_mul_f32 v[36:37], v[168:169], v[168:169]
    v_pk_mul_f32 v[38:39], v[170:171], v[170:171]
    v_pk_fma_f32 v[32:33], v[32:33], s[94:95], s[94:95] op_sel:[0,0,1] op_sel_hi:[1,0,1]
    v_pk_fma_f32 v[34:35], v[34:35], s[94:95], s[94:95] op_sel:[0,0,1] op_sel_hi:[1,0,1]
    v_pk_fma_f32 v[36:37], v[36:37], s[94:95], s[94:95] op_sel:[0,0,1] op_sel_hi:[1,0,1]
    v_pk_fma_f32 v[38:39], v[38:39], s[94:95], s[94:95] op_sel:[0,0,1] op_sel_hi:[1,0,1]
    v_pk_mul_f32 v[32:33], v[32:33], v[152:153]
    v_pk_mul_f32 v[34:35], v[34:35], v[154:155]
    v_pk_mul_f32 v[36:37], v[36:37], v[168:169]
    v_pk_mul_f32 v[38:39], v[38:39], v[170:171]
    v_exp_f32_e32 v32, v32
    v_exp_f32_e32 v34, v34
    v_exp_f32_e32 v36, v36
    v_exp_f32_e32 v38, v38
    v_exp_f32_e32 v33, v33
    v_exp_f32_e32 v35, v35
    v_exp_f32_e32 v37, v37
    v_exp_f32_e32 v39, v39
    v_pk_fma_f32 v[32:33], v[32:33], v[40:41], v[40:41] op_sel:[0,0,0] op_sel_hi:[1,0,0]
    v_pk_fma_f32 v[34:35], v[34:35], v[40:41], v[40:41] op_sel:[0,0,0] op_sel_hi:[1,0,0]
    v_pk_fma_f32 v[36:37], v[36:37], v[40:41], v[40:41] op_sel:[0,0,0] op_sel_hi:[1,0,0]
    v_pk_fma_f32 v[38:39], v[38:39], v[40:41], v[40:41] op_sel:[0,0,0] op_sel_hi:[1,0,0]
    v_rcp_f32_e32 v32, v32
    v_rcp_f32_e32 v34, v34
    v_rcp_f32_e32 v36, v36
    v_rcp_f32_e32 v38, v38
    v_rcp_f32_e32 v33, v33
    v_rcp_f32_e32 v35, v35
    v_rcp_f32_e32 v37, v37
    v_rcp_f32_e32 v39, v39
    v_pk_mul_f32 v[32:33], v[32:33], v[152:153]
    v_pk_mul_f32 v[34:35], v[34:35], v[154:155]
    v_pk_mul_f32 v[36:37], v[36:37], v[168:169]
    v_pk_mul_f32 v[38:39], v[38:39], v[170:171]
    v_cvt_pk_bf16_f32 v152, v32, v33
    v_cvt_pk_bf16_f32 v153, v34, v35
    v_cvt_pk_bf16_f32 v154, v36, v37
    v_cvt_pk_bf16_f32 v155, v38, v39
    buffer_store_dwordx4 v[152:155], v1, s[4:7], s63 offen offset:2048 sc1
    v_pk_mul_f32 v[32:33], v[156:157], v[156:157]
    v_pk_mul_f32 v[34:35], v[158:159], v[158:159]
    v_pk_mul_f32 v[36:37], v[172:173], v[172:173]
    v_pk_mul_f32 v[38:39], v[174:175], v[174:175]
    v_pk_fma_f32 v[32:33], v[32:33], s[94:95], s[94:95] op_sel:[0,0,1] op_sel_hi:[1,0,1]
    v_pk_fma_f32 v[34:35], v[34:35], s[94:95], s[94:95] op_sel:[0,0,1] op_sel_hi:[1,0,1]
    v_pk_fma_f32 v[36:37], v[36:37], s[94:95], s[94:95] op_sel:[0,0,1] op_sel_hi:[1,0,1]
    v_pk_fma_f32 v[38:39], v[38:39], s[94:95], s[94:95] op_sel:[0,0,1] op_sel_hi:[1,0,1]
    v_pk_mul_f32 v[32:33], v[32:33], v[156:157]
    v_pk_mul_f32 v[34:35], v[34:35], v[158:159]
    v_pk_mul_f32 v[36:37], v[36:37], v[172:173]
    v_pk_mul_f32 v[38:39], v[38:39], v[174:175]
    v_exp_f32_e32 v32, v32
    v_exp_f32_e32 v34, v34
    v_exp_f32_e32 v36, v36
    v_exp_f32_e32 v38, v38
    v_exp_f32_e32 v33, v33
    v_exp_f32_e32 v35, v35
    v_exp_f32_e32 v37, v37
    v_exp_f32_e32 v39, v39
    v_pk_fma_f32 v[32:33], v[32:33], v[40:41], v[40:41] op_sel:[0,1,1] op_sel_hi:[1,1,1]
    v_pk_fma_f32 v[34:35], v[34:35], v[40:41], v[40:41] op_sel:[0,1,1] op_sel_hi:[1,1,1]
    v_pk_fma_f32 v[36:37], v[36:37], v[40:41], v[40:41] op_sel:[0,1,1] op_sel_hi:[1,1,1]
    v_pk_fma_f32 v[38:39], v[38:39], v[40:41], v[40:41] op_sel:[0,1,1] op_sel_hi:[1,1,1]
    v_rcp_f32_e32 v32, v32
    v_rcp_f32_e32 v34, v34
    v_rcp_f32_e32 v36, v36
    v_rcp_f32_e32 v38, v38
    v_rcp_f32_e32 v33, v33
    v_rcp_f32_e32 v35, v35
    v_rcp_f32_e32 v37, v37
    v_rcp_f32_e32 v39, v39
    v_pk_mul_f32 v[32:33], v[32:33], v[156:157]
    v_pk_mul_f32 v[34:35], v[34:35], v[158:159]
    v_pk_mul_f32 v[36:37], v[36:37], v[172:173]
    v_pk_mul_f32 v[38:39], v[38:39], v[174:175]
    v_cvt_pk_bf16_f32 v156, v32, v33
    v_cvt_pk_bf16_f32 v157, v34, v35
    v_cvt_pk_bf16_f32 v158, v36, v37
    v_cvt_pk_bf16_f32 v159, v38, v39
    buffer_store_dwordx4 v[156:159], v1, s[4:7], s63 offen offset:3072 sc1
    s_add_u32 s63, s86, 0x101000
    v_pk_mul_f32 v[32:33], v[176:177], v[176:177]
    v_pk_mul_f32 v[34:35], v[178:179], v[178:179]
    v_pk_mul_f32 v[36:37], v[192:193], v[192:193]
    v_pk_mul_f32 v[38:39], v[194:195], v[194:195]
    v_pk_fma_f32 v[32:33], v[32:33], s[94:95], s[94:95] op_sel:[0,0,1] op_sel_hi:[1,0,1]
    v_pk_fma_f32 v[34:35], v[34:35], s[94:95], s[94:95] op_sel:[0,0,1] op_sel_hi:[1,0,1]
    v_pk_fma_f32 v[36:37], v[36:37], s[94:95], s[94:95] op_sel:[0,0,1] op_sel_hi:[1,0,1]
    v_pk_fma_f32 v[38:39], v[38:39], s[94:95], s[94:95] op_sel:[0,0,1] op_sel_hi:[1,0,1]
    v_pk_mul_f32 v[32:33], v[32:33], v[176:177]
    v_pk_mul_f32 v[34:35], v[34:35], v[178:179]
    v_pk_mul_f32 v[36:37], v[36:37], v[192:193]
    v_pk_mul_f32 v[38:39], v[38:39], v[194:195]
    v_exp_f32_e32 v32, v32
    v_exp_f32_e32 v34, v34
    v_exp_f32_e32 v36, v36
    v_exp_f32_e32 v38, v38
    v_exp_f32_e32 v33, v33
    v_exp_f32_e32 v35, v35
    v_exp_f32_e32 v37, v37
    v_exp_f32_e32 v39, v39
    v_pk_fma_f32 v[32:33], v[32:33], v[78:79], v[78:79] op_sel:[0,0,0] op_sel_hi:[1,0,0]
    v_pk_fma_f32 v[34:35], v[34:35], v[78:79], v[78:79] op_sel:[0,0,0] op_sel_hi:[1,0,0]
    v_pk_fma_f32 v[36:37], v[36:37], v[78:79], v[78:79] op_sel:[0,0,0] op_sel_hi:[1,0,0]
    v_pk_fma_f32 v[38:39], v[38:39], v[78:79], v[78:79] op_sel:[0,0,0] op_sel_hi:[1,0,0]
    v_rcp_f32_e32 v32, v32
    v_rcp_f32_e32 v34, v34
    v_rcp_f32_e32 v36, v36
    v_rcp_f32_e32 v38, v38
    v_rcp_f32_e32 v33, v33
    v_rcp_f32_e32 v35, v35
    v_rcp_f32_e32 v37, v37
    v_rcp_f32_e32 v39, v39
    v_pk_mul_f32 v[32:33], v[32:33], v[176:177]
    v_pk_mul_f32 v[34:35], v[34:35], v[178:179]
    v_pk_mul_f32 v[36:37], v[36:37], v[192:193]
    v_pk_mul_f32 v[38:39], v[38:39], v[194:195]
    v_cvt_pk_bf16_f32 v176, v32, v33
    v_cvt_pk_bf16_f32 v177, v34, v35
    v_cvt_pk_bf16_f32 v178, v36, v37
    v_cvt_pk_bf16_f32 v179, v38, v39
    buffer_store_dwordx4 v[176:179], v1, s[4:7], s63 offen offset:0 sc1
    v_pk_mul_f32 v[32:33], v[180:181], v[180:181]
    v_pk_mul_f32 v[34:35], v[182:183], v[182:183]
    v_pk_mul_f32 v[36:37], v[196:197], v[196:197]
    v_pk_mul_f32 v[38:39], v[198:199], v[198:199]
    v_pk_fma_f32 v[32:33], v[32:33], s[94:95], s[94:95] op_sel:[0,0,1] op_sel_hi:[1,0,1]
    v_pk_fma_f32 v[34:35], v[34:35], s[94:95], s[94:95] op_sel:[0,0,1] op_sel_hi:[1,0,1]
    v_pk_fma_f32 v[36:37], v[36:37], s[94:95], s[94:95] op_sel:[0,0,1] op_sel_hi:[1,0,1]
    v_pk_fma_f32 v[38:39], v[38:39], s[94:95], s[94:95] op_sel:[0,0,1] op_sel_hi:[1,0,1]
    v_pk_mul_f32 v[32:33], v[32:33], v[180:181]
    v_pk_mul_f32 v[34:35], v[34:35], v[182:183]
    v_pk_mul_f32 v[36:37], v[36:37], v[196:197]
    v_pk_mul_f32 v[38:39], v[38:39], v[198:199]
    v_exp_f32_e32 v32, v32
    v_exp_f32_e32 v34, v34
    v_exp_f32_e32 v36, v36
    v_exp_f32_e32 v38, v38
    v_exp_f32_e32 v33, v33
    v_exp_f32_e32 v35, v35
    v_exp_f32_e32 v37, v37
    v_exp_f32_e32 v39, v39
    v_pk_fma_f32 v[32:33], v[32:33], v[78:79], v[78:79] op_sel:[0,1,1] op_sel_hi:[1,1,1]
    v_pk_fma_f32 v[34:35], v[34:35], v[78:79], v[78:79] op_sel:[0,1,1] op_sel_hi:[1,1,1]
    v_pk_fma_f32 v[36:37], v[36:37], v[78:79], v[78:79] op_sel:[0,1,1] op_sel_hi:[1,1,1]
    v_pk_fma_f32 v[38:39], v[38:39], v[78:79], v[78:79] op_sel:[0,1,1] op_sel_hi:[1,1,1]
    v_rcp_f32_e32 v32, v32
    v_rcp_f32_e32 v34, v34
    v_rcp_f32_e32 v36, v36
    v_rcp_f32_e32 v38, v38
    v_rcp_f32_e32 v33, v33
    v_rcp_f32_e32 v35, v35
    v_rcp_f32_e32 v37, v37
    v_rcp_f32_e32 v39, v39
    v_pk_mul_f32 v[32:33], v[32:33], v[180:181]
    v_pk_mul_f32 v[34:35], v[34:35], v[182:183]
    v_pk_mul_f32 v[36:37], v[36:37], v[196:197]
    v_pk_mul_f32 v[38:39], v[38:39], v[198:199]
    v_cvt_pk_bf16_f32 v180, v32, v33
    v_cvt_pk_bf16_f32 v181, v34, v35
    v_cvt_pk_bf16_f32 v182, v36, v37
    v_cvt_pk_bf16_f32 v183, v38, v39
    buffer_store_dwordx4 v[180:183], v1, s[4:7], s63 offen offset:1024 sc1
    v_pk_mul_f32 v[32:33], v[184:185], v[184:185]
    v_pk_mul_f32 v[34:35], v[186:187], v[186:187]
    v_pk_mul_f32 v[36:37], v[200:201], v[200:201]
    v_pk_mul_f32 v[38:39], v[202:203], v[202:203]
    v_pk_fma_f32 v[32:33], v[32:33], s[94:95], s[94:95] op_sel:[0,0,1] op_sel_hi:[1,0,1]
    v_pk_fma_f32 v[34:35], v[34:35], s[94:95], s[94:95] op_sel:[0,0,1] op_sel_hi:[1,0,1]
    v_pk_fma_f32 v[36:37], v[36:37], s[94:95], s[94:95] op_sel:[0,0,1] op_sel_hi:[1,0,1]
    v_pk_fma_f32 v[38:39], v[38:39], s[94:95], s[94:95] op_sel:[0,0,1] op_sel_hi:[1,0,1]
    v_pk_mul_f32 v[32:33], v[32:33], v[184:185]
    v_pk_mul_f32 v[34:35], v[34:35], v[186:187]
    v_pk_mul_f32 v[36:37], v[36:37], v[200:201]
    v_pk_mul_f32 v[38:39], v[38:39], v[202:203]
    v_exp_f32_e32 v32, v32
    v_exp_f32_e32 v34, v34
    v_exp_f32_e32 v36, v36
    v_exp_f32_e32 v38, v38
    v_exp_f32_e32 v33, v33
    v_exp_f32_e32 v35, v35
    v_exp_f32_e32 v37, v37
    v_exp_f32_e32 v39, v39
    v_pk_fma_f32 v[32:33], v[32:33], v[40:41], v[40:41] op_sel:[0,0,0] op_sel_hi:[1,0,0]
    v_pk_fma_f32 v[34:35], v[34:35], v[40:41], v[40:41] op_sel:[0,0,0] op_sel_hi:[1,0,0]
    v_pk_fma_f32 v[36:37], v[36:37], v[40:41], v[40:41] op_sel:[0,0,0] op_sel_hi:[1,0,0]
    v_pk_fma_f32 v[38:39], v[38:39], v[40:41], v[40:41] op_sel:[0,0,0] op_sel_hi:[1,0,0]
    v_rcp_f32_e32 v32, v32
    v_rcp_f32_e32 v34, v34
    v_rcp_f32_e32 v36, v36
    v_rcp_f32_e32 v38, v38
    v_rcp_f32_e32 v33, v33
    v_rcp_f32_e32 v35, v35
    v_rcp_f32_e32 v37, v37
    v_rcp_f32_e32 v39, v39
    v_pk_mul_f32 v[32:33], v[32:33], v[184:185]
    v_pk_mul_f32 v[34:35], v[34:35], v[186:187]
    v_pk_mul_f32 v[36:37], v[36:37], v[200:201]
    v_pk_mul_f32 v[38:39], v[38:39], v[202:203]
    v_cvt_pk_bf16_f32 v184, v32, v33
    v_cvt_pk_bf16_f32 v185, v34, v35
    v_cvt_pk_bf16_f32 v186, v36, v37
    v_cvt_pk_bf16_f32 v187, v38, v39
    buffer_store_dwordx4 v[184:187], v1, s[4:7], s63 offen offset:2048 sc1
    v_pk_mul_f32 v[32:33], v[188:189], v[188:189]
    v_pk_mul_f32 v[34:35], v[190:191], v[190:191]
    v_pk_mul_f32 v[36:37], v[204:205], v[204:205]
    v_pk_mul_f32 v[38:39], v[206:207], v[206:207]
    v_pk_fma_f32 v[32:33], v[32:33], s[94:95], s[94:95] op_sel:[0,0,1] op_sel_hi:[1,0,1]
    v_pk_fma_f32 v[34:35], v[34:35], s[94:95], s[94:95] op_sel:[0,0,1] op_sel_hi:[1,0,1]
    v_pk_fma_f32 v[36:37], v[36:37], s[94:95], s[94:95] op_sel:[0,0,1] op_sel_hi:[1,0,1]
    v_pk_fma_f32 v[38:39], v[38:39], s[94:95], s[94:95] op_sel:[0,0,1] op_sel_hi:[1,0,1]
    v_pk_mul_f32 v[32:33], v[32:33], v[188:189]
    v_pk_mul_f32 v[34:35], v[34:35], v[190:191]
    v_pk_mul_f32 v[36:37], v[36:37], v[204:205]
    v_pk_mul_f32 v[38:39], v[38:39], v[206:207]
    v_exp_f32_e32 v32, v32
    v_exp_f32_e32 v34, v34
    v_exp_f32_e32 v36, v36
    v_exp_f32_e32 v38, v38
    v_exp_f32_e32 v33, v33
    v_exp_f32_e32 v35, v35
    v_exp_f32_e32 v37, v37
    v_exp_f32_e32 v39, v39
    v_pk_fma_f32 v[32:33], v[32:33], v[40:41], v[40:41] op_sel:[0,1,1] op_sel_hi:[1,1,1]
    v_pk_fma_f32 v[34:35], v[34:35], v[40:41], v[40:41] op_sel:[0,1,1] op_sel_hi:[1,1,1]
    v_pk_fma_f32 v[36:37], v[36:37], v[40:41], v[40:41] op_sel:[0,1,1] op_sel_hi:[1,1,1]
    v_pk_fma_f32 v[38:39], v[38:39], v[40:41], v[40:41] op_sel:[0,1,1] op_sel_hi:[1,1,1]
    v_rcp_f32_e32 v32, v32
    v_rcp_f32_e32 v34, v34
    v_rcp_f32_e32 v36, v36
    v_rcp_f32_e32 v38, v38
    v_rcp_f32_e32 v33, v33
    v_rcp_f32_e32 v35, v35
    v_rcp_f32_e32 v37, v37
    v_rcp_f32_e32 v39, v39
    v_pk_mul_f32 v[32:33], v[32:33], v[188:189]
    v_pk_mul_f32 v[34:35], v[34:35], v[190:191]
    v_pk_mul_f32 v[36:37], v[36:37], v[204:205]
    v_pk_mul_f32 v[38:39], v[38:39], v[206:207]
    v_cvt_pk_bf16_f32 v188, v32, v33
    v_cvt_pk_bf16_f32 v189, v34, v35
    v_cvt_pk_bf16_f32 v190, v36, v37
    v_cvt_pk_bf16_f32 v191, v38, v39
    buffer_store_dwordx4 v[188:191], v1, s[4:7], s63 offen offset:3072 sc1
    buffer_load_dwordx4 v[160:163], v7, s[52:55], 0 offen offset:0 sc1
    buffer_load_dwordx4 v[164:167], v7, s[52:55], 0 offen offset:512 sc1
    buffer_load_dwordx4 v[168:171], v7, s[52:55], 0 offen offset:1024 sc1
    buffer_load_dwordx4 v[172:175], v7, s[52:55], 0 offen offset:1536 sc1
    buffer_load_dwordx4 v[192:195], v7, s[52:55], 0 offen offset:2048 sc1
    buffer_load_dwordx4 v[196:199], v7, s[52:55], 0 offen offset:2560 sc1
    buffer_load_dwordx4 v[200:203], v7, s[52:55], 0 offen offset:3072 sc1
    buffer_load_dwordx4 v[204:207], v7, s[52:55], 0 offen offset:3584 sc1
    v_accvgpr_read_b32 v32, a146
    s_waitcnt vmcnt(17)
    v_xor_b32 v33, 32, v32
    ds_read_b64 a[0:1], v32 offset:0
    ds_read_b64 a[2:3], v33 offset:0
    ds_read_b64 a[4:5], v32 offset:1024
    ds_read_b64 a[6:7], v33 offset:1024
    ds_read_b64 a[8:9], v32 offset:2048
    ds_read_b64 a[10:11], v33 offset:2048
    ds_read_b64 a[12:13], v32 offset:3072
    ds_read_b64 a[14:15], v33 offset:3072
    s_add_u32 s63, s86, 0x102000
    v_pk_mul_f32 v[32:33], v[208:209], v[208:209]
    v_pk_mul_f32 v[34:35], v[210:211], v[210:211]
    v_pk_mul_f32 v[36:37], v[224:225], v[224:225]
    v_pk_mul_f32 v[38:39], v[226:227], v[226:227]
    v_pk_fma_f32 v[32:33], v[32:33], s[94:95], s[94:95] op_sel:[0,0,1] op_sel_hi:[1,0,1]
    v_pk_fma_f32 v[34:35], v[34:35], s[94:95], s[94:95] op_sel:[0,0,1] op_sel_hi:[1,0,1]
    v_pk_fma_f32 v[36:37], v[36:37], s[94:95], s[94:95] op_sel:[0,0,1] op_sel_hi:[1,0,1]
    v_pk_fma_f32 v[38:39], v[38:39], s[94:95], s[94:95] op_sel:[0,0,1] op_sel_hi:[1,0,1]
    v_pk_mul_f32 v[32:33], v[32:33], v[208:209]
    v_pk_mul_f32 v[34:35], v[34:35], v[210:211]
    v_pk_mul_f32 v[36:37], v[36:37], v[224:225]
    v_pk_mul_f32 v[38:39], v[38:39], v[226:227]
    v_exp_f32_e32 v32, v32
    v_exp_f32_e32 v34, v34
    v_exp_f32_e32 v36, v36
    v_exp_f32_e32 v38, v38
    v_exp_f32_e32 v33, v33
    v_exp_f32_e32 v35, v35
    v_exp_f32_e32 v37, v37
    v_exp_f32_e32 v39, v39
    v_pk_fma_f32 v[32:33], v[32:33], v[78:79], v[78:79] op_sel:[0,0,0] op_sel_hi:[1,0,0]
    v_pk_fma_f32 v[34:35], v[34:35], v[78:79], v[78:79] op_sel:[0,0,0] op_sel_hi:[1,0,0]
    v_pk_fma_f32 v[36:37], v[36:37], v[78:79], v[78:79] op_sel:[0,0,0] op_sel_hi:[1,0,0]
    v_pk_fma_f32 v[38:39], v[38:39], v[78:79], v[78:79] op_sel:[0,0,0] op_sel_hi:[1,0,0]
    v_rcp_f32_e32 v32, v32
    v_rcp_f32_e32 v34, v34
    v_rcp_f32_e32 v36, v36
    v_rcp_f32_e32 v38, v38
    v_rcp_f32_e32 v33, v33
    v_rcp_f32_e32 v35, v35
    v_rcp_f32_e32 v37, v37
    v_rcp_f32_e32 v39, v39
    v_pk_mul_f32 v[32:33], v[32:33], v[208:209]
    v_pk_mul_f32 v[34:35], v[34:35], v[210:211]
    v_pk_mul_f32 v[36:37], v[36:37], v[224:225]
    v_pk_mul_f32 v[38:39], v[38:39], v[226:227]
    v_cvt_pk_bf16_f32 v208, v32, v33
    v_cvt_pk_bf16_f32 v209, v34, v35
    v_cvt_pk_bf16_f32 v210, v36, v37
    v_cvt_pk_bf16_f32 v211, v38, v39
    buffer_store_dwordx4 v[208:211], v1, s[4:7], s63 offen offset:0 sc1
    v_pk_mul_f32 v[32:33], v[212:213], v[212:213]
    v_pk_mul_f32 v[34:35], v[214:215], v[214:215]
    v_pk_mul_f32 v[36:37], v[228:229], v[228:229]
    v_pk_mul_f32 v[38:39], v[230:231], v[230:231]
    v_pk_fma_f32 v[32:33], v[32:33], s[94:95], s[94:95] op_sel:[0,0,1] op_sel_hi:[1,0,1]
    v_pk_fma_f32 v[34:35], v[34:35], s[94:95], s[94:95] op_sel:[0,0,1] op_sel_hi:[1,0,1]
    v_pk_fma_f32 v[36:37], v[36:37], s[94:95], s[94:95] op_sel:[0,0,1] op_sel_hi:[1,0,1]
    v_pk_fma_f32 v[38:39], v[38:39], s[94:95], s[94:95] op_sel:[0,0,1] op_sel_hi:[1,0,1]
    v_pk_mul_f32 v[32:33], v[32:33], v[212:213]
    v_pk_mul_f32 v[34:35], v[34:35], v[214:215]
    v_pk_mul_f32 v[36:37], v[36:37], v[228:229]
    v_pk_mul_f32 v[38:39], v[38:39], v[230:231]
    v_exp_f32_e32 v32, v32
    v_exp_f32_e32 v34, v34
    v_exp_f32_e32 v36, v36
    v_exp_f32_e32 v38, v38
    v_exp_f32_e32 v33, v33
    v_exp_f32_e32 v35, v35
    v_exp_f32_e32 v37, v37
    v_exp_f32_e32 v39, v39
    v_pk_fma_f32 v[32:33], v[32:33], v[78:79], v[78:79] op_sel:[0,1,1] op_sel_hi:[1,1,1]
    v_pk_fma_f32 v[34:35], v[34:35], v[78:79], v[78:79] op_sel:[0,1,1] op_sel_hi:[1,1,1]
    v_pk_fma_f32 v[36:37], v[36:37], v[78:79], v[78:79] op_sel:[0,1,1] op_sel_hi:[1,1,1]
    v_pk_fma_f32 v[38:39], v[38:39], v[78:79], v[78:79] op_sel:[0,1,1] op_sel_hi:[1,1,1]
    v_rcp_f32_e32 v32, v32
    v_rcp_f32_e32 v34, v34
    v_rcp_f32_e32 v36, v36
    v_rcp_f32_e32 v38, v38
    v_rcp_f32_e32 v33, v33
    v_rcp_f32_e32 v35, v35
    v_rcp_f32_e32 v37, v37
    v_rcp_f32_e32 v39, v39
    v_pk_mul_f32 v[32:33], v[32:33], v[212:213]
    v_pk_mul_f32 v[34:35], v[34:35], v[214:215]
    v_pk_mul_f32 v[36:37], v[36:37], v[228:229]
    v_pk_mul_f32 v[38:39], v[38:39], v[230:231]
    v_cvt_pk_bf16_f32 v212, v32, v33
    v_cvt_pk_bf16_f32 v213, v34, v35
    v_cvt_pk_bf16_f32 v214, v36, v37
    v_cvt_pk_bf16_f32 v215, v38, v39
    buffer_store_dwordx4 v[212:215], v1, s[4:7], s63 offen offset:1024 sc1
    v_pk_mul_f32 v[32:33], v[216:217], v[216:217]
    v_pk_mul_f32 v[34:35], v[218:219], v[218:219]
    v_pk_mul_f32 v[36:37], v[232:233], v[232:233]
    v_pk_mul_f32 v[38:39], v[234:235], v[234:235]
    v_pk_fma_f32 v[32:33], v[32:33], s[94:95], s[94:95] op_sel:[0,0,1] op_sel_hi:[1,0,1]
    v_pk_fma_f32 v[34:35], v[34:35], s[94:95], s[94:95] op_sel:[0,0,1] op_sel_hi:[1,0,1]
    v_pk_fma_f32 v[36:37], v[36:37], s[94:95], s[94:95] op_sel:[0,0,1] op_sel_hi:[1,0,1]
    v_pk_fma_f32 v[38:39], v[38:39], s[94:95], s[94:95] op_sel:[0,0,1] op_sel_hi:[1,0,1]
    v_pk_mul_f32 v[32:33], v[32:33], v[216:217]
    v_pk_mul_f32 v[34:35], v[34:35], v[218:219]
    v_pk_mul_f32 v[36:37], v[36:37], v[232:233]
    v_pk_mul_f32 v[38:39], v[38:39], v[234:235]
    v_exp_f32_e32 v32, v32
    v_exp_f32_e32 v34, v34
    v_exp_f32_e32 v36, v36
    v_exp_f32_e32 v38, v38
    v_exp_f32_e32 v33, v33
    v_exp_f32_e32 v35, v35
    v_exp_f32_e32 v37, v37
    v_exp_f32_e32 v39, v39
    v_pk_fma_f32 v[32:33], v[32:33], v[40:41], v[40:41] op_sel:[0,0,0] op_sel_hi:[1,0,0]
    v_pk_fma_f32 v[34:35], v[34:35], v[40:41], v[40:41] op_sel:[0,0,0] op_sel_hi:[1,0,0]
    v_pk_fma_f32 v[36:37], v[36:37], v[40:41], v[40:41] op_sel:[0,0,0] op_sel_hi:[1,0,0]
    v_pk_fma_f32 v[38:39], v[38:39], v[40:41], v[40:41] op_sel:[0,0,0] op_sel_hi:[1,0,0]
    v_rcp_f32_e32 v32, v32
    v_rcp_f32_e32 v34, v34
    v_rcp_f32_e32 v36, v36
    v_rcp_f32_e32 v38, v38
    v_rcp_f32_e32 v33, v33
    v_rcp_f32_e32 v35, v35
    v_rcp_f32_e32 v37, v37
    v_rcp_f32_e32 v39, v39
    v_pk_mul_f32 v[32:33], v[32:33], v[216:217]
    v_pk_mul_f32 v[34:35], v[34:35], v[218:219]
    v_pk_mul_f32 v[36:37], v[36:37], v[232:233]
    v_pk_mul_f32 v[38:39], v[38:39], v[234:235]
    v_cvt_pk_bf16_f32 v216, v32, v33
    v_cvt_pk_bf16_f32 v217, v34, v35
    v_cvt_pk_bf16_f32 v218, v36, v37
    v_cvt_pk_bf16_f32 v219, v38, v39
    buffer_store_dwordx4 v[216:219], v1, s[4:7], s63 offen offset:2048 sc1
    v_pk_mul_f32 v[32:33], v[220:221], v[220:221]
    v_pk_mul_f32 v[34:35], v[222:223], v[222:223]
    v_pk_mul_f32 v[36:37], v[236:237], v[236:237]
    v_pk_mul_f32 v[38:39], v[238:239], v[238:239]
    v_pk_fma_f32 v[32:33], v[32:33], s[94:95], s[94:95] op_sel:[0,0,1] op_sel_hi:[1,0,1]
    v_pk_fma_f32 v[34:35], v[34:35], s[94:95], s[94:95] op_sel:[0,0,1] op_sel_hi:[1,0,1]
    v_pk_fma_f32 v[36:37], v[36:37], s[94:95], s[94:95] op_sel:[0,0,1] op_sel_hi:[1,0,1]
    v_pk_fma_f32 v[38:39], v[38:39], s[94:95], s[94:95] op_sel:[0,0,1] op_sel_hi:[1,0,1]
    v_pk_mul_f32 v[32:33], v[32:33], v[220:221]
    v_pk_mul_f32 v[34:35], v[34:35], v[222:223]
    v_pk_mul_f32 v[36:37], v[36:37], v[236:237]
    v_pk_mul_f32 v[38:39], v[38:39], v[238:239]
    v_exp_f32_e32 v32, v32
    v_exp_f32_e32 v34, v34
    v_exp_f32_e32 v36, v36
    v_exp_f32_e32 v38, v38
    v_exp_f32_e32 v33, v33
    v_exp_f32_e32 v35, v35
    v_exp_f32_e32 v37, v37
    v_exp_f32_e32 v39, v39
    v_pk_fma_f32 v[32:33], v[32:33], v[40:41], v[40:41] op_sel:[0,1,1] op_sel_hi:[1,1,1]
    v_pk_fma_f32 v[34:35], v[34:35], v[40:41], v[40:41] op_sel:[0,1,1] op_sel_hi:[1,1,1]
    v_pk_fma_f32 v[36:37], v[36:37], v[40:41], v[40:41] op_sel:[0,1,1] op_sel_hi:[1,1,1]
    v_pk_fma_f32 v[38:39], v[38:39], v[40:41], v[40:41] op_sel:[0,1,1] op_sel_hi:[1,1,1]
    v_rcp_f32_e32 v32, v32
    v_rcp_f32_e32 v34, v34
    v_rcp_f32_e32 v36, v36
    v_rcp_f32_e32 v38, v38
    v_rcp_f32_e32 v33, v33
    v_rcp_f32_e32 v35, v35
    v_rcp_f32_e32 v37, v37
    v_rcp_f32_e32 v39, v39
    v_pk_mul_f32 v[32:33], v[32:33], v[220:221]
    v_pk_mul_f32 v[34:35], v[34:35], v[222:223]
    v_pk_mul_f32 v[36:37], v[36:37], v[236:237]
    v_pk_mul_f32 v[38:39], v[38:39], v[238:239]
    v_cvt_pk_bf16_f32 v220, v32, v33
    v_cvt_pk_bf16_f32 v221, v34, v35
    v_cvt_pk_bf16_f32 v222, v36, v37
    v_cvt_pk_bf16_f32 v223, v38, v39
    buffer_store_dwordx4 v[220:223], v1, s[4:7], s63 offen offset:3072 sc1
    s_add_u32 s63, s91, 0x103000
    v_pk_mul_f32 v[32:33], v[240:241], v[240:241]
    v_pk_mul_f32 v[34:35], v[242:243], v[242:243]
    v_pk_mul_f32 v[36:37], v[244:245], v[244:245]
    v_pk_mul_f32 v[38:39], v[246:247], v[246:247]
    v_pk_fma_f32 v[32:33], v[32:33], s[94:95], s[94:95] op_sel:[0,0,1] op_sel_hi:[1,0,1]
    v_pk_fma_f32 v[34:35], v[34:35], s[94:95], s[94:95] op_sel:[0,0,1] op_sel_hi:[1,0,1]
    v_pk_fma_f32 v[36:37], v[36:37], s[94:95], s[94:95] op_sel:[0,0,1] op_sel_hi:[1,0,1]
    v_pk_fma_f32 v[38:39], v[38:39], s[94:95], s[94:95] op_sel:[0,0,1] op_sel_hi:[1,0,1]
    v_pk_mul_f32 v[32:33], v[32:33], v[240:241]
    v_pk_mul_f32 v[34:35], v[34:35], v[242:243]
    v_pk_mul_f32 v[36:37], v[36:37], v[244:245]
    v_pk_mul_f32 v[38:39], v[38:39], v[246:247]
    v_exp_f32_e32 v32, v32
    v_exp_f32_e32 v34, v34
    v_exp_f32_e32 v36, v36
    v_exp_f32_e32 v38, v38
    v_exp_f32_e32 v33, v33
    v_exp_f32_e32 v35, v35
    v_exp_f32_e32 v37, v37
    v_exp_f32_e32 v39, v39
    v_pk_fma_f32 v[32:33], v[32:33], v[78:79], v[78:79] op_sel:[0,0,0] op_sel_hi:[1,0,0]
    v_pk_fma_f32 v[34:35], v[34:35], v[78:79], v[78:79] op_sel:[0,0,0] op_sel_hi:[1,0,0]
    v_pk_fma_f32 v[36:37], v[36:37], v[78:79], v[78:79] op_sel:[0,1,1] op_sel_hi:[1,1,1]
    v_pk_fma_f32 v[38:39], v[38:39], v[78:79], v[78:79] op_sel:[0,1,1] op_sel_hi:[1,1,1]
    v_rcp_f32_e32 v32, v32
    v_rcp_f32_e32 v34, v34
    v_rcp_f32_e32 v36, v36
    v_rcp_f32_e32 v38, v38
    v_rcp_f32_e32 v33, v33
    v_rcp_f32_e32 v35, v35
    v_rcp_f32_e32 v37, v37
    v_rcp_f32_e32 v39, v39
    v_pk_mul_f32 v[32:33], v[32:33], v[240:241]
    v_pk_mul_f32 v[34:35], v[34:35], v[242:243]
    v_pk_mul_f32 v[36:37], v[36:37], v[244:245]
    v_pk_mul_f32 v[38:39], v[38:39], v[246:247]
    v_cvt_pk_bf16_f32 v240, v32, v33
    v_cvt_pk_bf16_f32 v241, v34, v35
    v_cvt_pk_bf16_f32 v242, v36, v37
    v_cvt_pk_bf16_f32 v243, v38, v39
    s_nop 0
    s_nop 0
    v_permlane16_swap_b32 v240, v242
    v_permlane16_swap_b32 v241, v243
    buffer_store_dwordx4 v[240:243], v6, s[4:7], s63 offen offset:0 sc1
    v_pk_mul_f32 v[32:33], v[248:249], v[248:249]
    v_pk_mul_f32 v[34:35], v[250:251], v[250:251]
    v_pk_mul_f32 v[36:37], v[252:253], v[252:253]
    v_pk_mul_f32 v[38:39], v[254:255], v[254:255]
    v_pk_fma_f32 v[32:33], v[32:33], s[94:95], s[94:95] op_sel:[0,0,1] op_sel_hi:[1,0,1]
    v_pk_fma_f32 v[34:35], v[34:35], s[94:95], s[94:95] op_sel:[0,0,1] op_sel_hi:[1,0,1]
    v_pk_fma_f32 v[36:37], v[36:37], s[94:95], s[94:95] op_sel:[0,0,1] op_sel_hi:[1,0,1]
    v_pk_fma_f32 v[38:39], v[38:39], s[94:95], s[94:95] op_sel:[0,0,1] op_sel_hi:[1,0,1]
    v_pk_mul_f32 v[32:33], v[32:33], v[248:249]
    v_pk_mul_f32 v[34:35], v[34:35], v[250:251]
    v_pk_mul_f32 v[36:37], v[36:37], v[252:253]
    v_pk_mul_f32 v[38:39], v[38:39], v[254:255]
    v_exp_f32_e32 v32, v32
    v_exp_f32_e32 v34, v34
    v_exp_f32_e32 v36, v36
    v_exp_f32_e32 v38, v38
    v_exp_f32_e32 v33, v33
    v_exp_f32_e32 v35, v35
    v_exp_f32_e32 v37, v37
    v_exp_f32_e32 v39, v39
    v_pk_fma_f32 v[32:33], v[32:33], v[40:41], v[40:41] op_sel:[0,0,0] op_sel_hi:[1,0,0]
    v_pk_fma_f32 v[34:35], v[34:35], v[40:41], v[40:41] op_sel:[0,0,0] op_sel_hi:[1,0,0]
    v_pk_fma_f32 v[36:37], v[36:37], v[40:41], v[40:41] op_sel:[0,1,1] op_sel_hi:[1,1,1]
    v_pk_fma_f32 v[38:39], v[38:39], v[40:41], v[40:41] op_sel:[0,1,1] op_sel_hi:[1,1,1]
    v_rcp_f32_e32 v32, v32
    v_rcp_f32_e32 v34, v34
    v_rcp_f32_e32 v36, v36
    v_rcp_f32_e32 v38, v38
    v_rcp_f32_e32 v33, v33
    v_rcp_f32_e32 v35, v35
    v_rcp_f32_e32 v37, v37
    v_rcp_f32_e32 v39, v39
    v_pk_mul_f32 v[32:33], v[32:33], v[248:249]
    v_pk_mul_f32 v[34:35], v[34:35], v[250:251]
    v_pk_mul_f32 v[36:37], v[36:37], v[252:253]
    v_pk_mul_f32 v[38:39], v[38:39], v[254:255]
    v_cvt_pk_bf16_f32 v248, v32, v33
    v_cvt_pk_bf16_f32 v249, v34, v35
    v_cvt_pk_bf16_f32 v250, v36, v37
    v_cvt_pk_bf16_f32 v251, v38, v39
    s_nop 0
    s_nop 0
    v_permlane16_swap_b32 v248, v250
    v_permlane16_swap_b32 v249, v251
    buffer_store_dwordx4 v[248:251], v6, s[4:7], s63 offen offset:2048 sc1
    s_waitcnt vmcnt(6) lgkmcnt(0)
    s_barrier
    v_max3_u32 v32, v160, v161, v162
    v_max3_u32 v33, v163, v164, v165
    v_max3_u32 v32, v32, v166, v167
    v_max3_u32 v33, v33, v168, v169
    v_max3_u32 v32, v32, v170, v171
    v_max3_u32 v33, v33, v172, v173
    v_max3_u32 v32, v32, v174, v175
    v_max3_u32 v33, v33, v192, v193
L_hop_6:
    s_cbranch_execz L_hop_10
    s_nop 0
    v_max3_u32 v32, v32, v194, v195
    v_max3_u32 v33, v33, v196, v197
    v_max3_u32 v32, v32, v198, v199
    v_max3_u32 v33, v33, v200, v201
    v_max3_u32 v32, v32, v202, v203
    v_max3_u32 v33, v33, v204, v205
    v_max3_u32 v32, v32, v206, v207
    v_max_u32 v32, v32, v33
    v_cmp_eq_u32 vcc, -1, v32
    s_cmp_eq_u64 vcc, 0
    s_cbranch_scc0 L_slow_car
L_back_car:
    v_pk_fma_f32 v[200:201], v[204:205], v[62:63], v[200:201] op_sel:[0,0,0] op_sel_hi:[1,0,1]
    v_pk_fma_f32 v[202:203], v[206:207], v[64:65], v[202:203] op_sel:[0,0,0] op_sel_hi:[1,0,1]
    v_pk_fma_f32 v[200:201], v[204:205], v[62:63], v[200:201] op_sel:[1,1,0] op_sel_hi:[0,1,1] neg_lo:[0,1,0]
    v_pk_fma_f32 v[202:203], v[206:207], v[64:65], v[202:203] op_sel:[1,1,0] op_sel_hi:[0,1,1] neg_lo:[0,1,0]
    v_pk_fma_f32 v[196:197], v[200:201], v[62:63], v[196:197] op_sel:[0,0,0] op_sel_hi:[1,0,1]
    v_pk_fma_f32 v[198:199], v[202:203], v[64:65], v[198:199] op_sel:[0,0,0] op_sel_hi:[1,0,1]
    v_pk_fma_f32 v[196:197], v[200:201], v[62:63], v[196:197] op_sel:[1,1,0] op_sel_hi:[0,1,1] neg_lo:[0,1,0]
    v_pk_fma_f32 v[198:199], v[202:203], v[64:65], v[198:199] op_sel:[1,1,0] op_sel_hi:[0,1,1] neg_lo:[0,1,0]
    v_pk_fma_f32 v[192:193], v[196:197], v[62:63], v[192:193] op_sel:[0,0,0] op_sel_hi:[1,0,1]
    v_pk_fma_f32 v[194:195], v[198:199], v[64:65], v[194:195] op_sel:[0,0,0] op_sel_hi:[1,0,1]
    v_pk_fma_f32 v[192:193], v[196:197], v[62:63], v[192:193] op_sel:[1,1,0] op_sel_hi:[0,1,1] neg_lo:[0,1,0]
    v_pk_fma_f32 v[194:195], v[198:199], v[64:65], v[194:195] op_sel:[1,1,0] op_sel_hi:[0,1,1] neg_lo:[0,1,0]
    v_pk_fma_f32 v[172:173], v[192:193], v[62:63], v[172:173] op_sel:[0,0,0] op_sel_hi:[1,0,1]
    v_pk_fma_f32 v[174:175], v[194:195], v[64:65], v[174:175] op_sel:[0,0,0] op_sel_hi:[1,0,1]
    v_pk_fma_f32 v[172:173], v[192:193], v[62:63], v[172:173] op_sel:[1,1,0] op_sel_hi:[0,1,1] neg_lo:[0,1,0]
    v_pk_fma_f32 v[174:175], v[194:195], v[64:65], v[174:175] op_sel:[1,1,0] op_sel_hi:[0,1,1] neg_lo:[0,1,0]
    v_pk_fma_f32 v[168:169], v[172:173], v[62:63], v[168:169] op_sel:[0,0,0] op_sel_hi:[1,0,1]
    v_pk_fma_f32 v[170:171], v[174:175], v[64:65], v[170:171] op_sel:[0,0,0] op_sel_hi:[1,0,1]
    v_pk_fma_f32 v[168:169], v[172:173], v[62:63], v[168:169] op_sel:[1,1,0] op_sel_hi:[0,1,1] neg_lo:[0,1,0]
    v_pk_fma_f32 v[170:171], v[174:175], v[64:65], v[170:171] op_sel:[1,1,0] op_sel_hi:[0,1,1] neg_lo:[0,1,0]
    v_pk_fma_f32 v[164:165], v[168:169], v[62:63], v[164:165] op_sel:[0,0,0] op_sel_hi:[1,0,1]
    v_pk_fma_f32 v[166:167], v[170:171], v[64:65], v[166:167] op_sel:[0,0,0] op_sel_hi:[1,0,1]
    v_pk_fma_f32 v[164:165], v[168:169], v[62:63], v[164:165] op_sel:[1,1,0] op_sel_hi:[0,1,1] neg_lo:[0,1,0]
    v_pk_fma_f32 v[166:167], v[170:171], v[64:65], v[166:167] op_sel:[1,1,0] op_sel_hi:[0,1,1] neg_lo:[0,1,0]
    v_pk_fma_f32 v[160:161], v[164:165], v[62:63], v[160:161] op_sel:[0,0,0] op_sel_hi:[1,0,1]
    v_pk_fma_f32 v[162:163], v[166:167], v[64:65], v[162:163] op_sel:[0,0,0] op_sel_hi:[1,0,1]
    v_pk_fma_f32 v[160:161], v[164:165], v[62:63], v[160:161] op_sel:[1,1,0] op_sel_hi:[0,1,1] neg_lo:[0,1,0]
    v_pk_fma_f32 v[162:163], v[166:167], v[64:65], v[162:163] op_sel:[1,1,0] op_sel_hi:[0,1,1] neg_lo:[0,1,0]
    v_pk_mul_f32 v[32:33], v[160:161], v[66:67] op_sel:[0,0] op_sel_hi:[1,0]
    v_pk_mul_f32 v[34:35], v[162:163], v[68:69] op_sel:[0,0] op_sel_hi:[1,0]
    v_pk_fma_f32 v[32:33], v[160:161], v[66:67], v[32:33] op_sel:[1,1,0] op_sel_hi:[0,1,1] neg_lo:[0,1,0]
    v_pk_fma_f32 v[34:35], v[162:163], v[68:69], v[34:35] op_sel:[1,1,0] op_sel_hi:[0,1,1] neg_lo:[0,1,0]
    v_mov_b64 v[36:37], v[32:33]
    v_mov_b64 v[38:39], v[34:35]
    v_accvgpr_read_b32 v62, a142
    v_permlane16_swap_b32 v32, v36
    v_permlane16_swap_b32 v33, v37
    v_permlane16_swap_b32 v34, v38
    v_permlane16_swap_b32 v35, v39
    v_pk_add_f32 v[32:33], v[32:33], v[36:37]
    v_pk_add_f32 v[34:35], v[34:35], v[38:39]
    v_mov_b64 v[36:37], v[32:33]
    v_mov_b64 v[38:39], v[34:35]
    v_accvgpr_read_b32 v6, a139
    v_permlane32_swap_b32 v32, v36
    v_permlane32_swap_b32 v33, v37
    v_permlane32_swap_b32 v34, v38
    v_permlane32_swap_b32 v35, v39
    v_pk_add_f32 v[32:33], v[32:33], v[36:37]
    v_pk_add_f32 v[34:35], v[34:35], v[38:39]
    v_pk_fma_f32 v[2:3], v[32:33], v[70:71], v[2:3] op_sel:[0,0,0] op_sel_hi:[1,0,1]
    v_pk_fma_f32 v[4:5], v[34:35], v[72:73], v[4:5] op_sel:[0,0,0] op_sel_hi:[1,0,1]
    v_pk_fma_f32 v[2:3], v[32:33], v[70:71], v[2:3] op_sel:[1,1,0] op_sel_hi:[0,1,1] neg_lo:[0,1,0]
    v_pk_fma_f32 v[4:5], v[34:35], v[72:73], v[4:5] op_sel:[1,1,0] op_sel_hi:[0,1,1] neg_lo:[0,1,0]
    v_pk_mul_f32 v[36:37], v[2:3], v[74:75] op_sel:[0,0] op_sel_hi:[1,0]
    v_pk_mul_f32 v[38:39], v[4:5], v[76:77] op_sel:[0,0] op_sel_hi:[1,0]
    v_pk_fma_f32 v[36:37], v[2:3], v[74:75], v[36:37] op_sel:[1,1,0] op_sel_hi:[0,1,1] neg_lo:[0,1,0]
    v_pk_fma_f32 v[38:39], v[4:5], v[76:77], v[38:39] op_sel:[1,1,0] op_sel_hi:[0,1,1] neg_lo:[0,1,0]
    v_mul_f32 v224, v50, v36
    v_mul_f32 v232, v52, v38
    v_mul_f32 v226, v50, v37
    v_mul_f32 v234, v52, v39
    v_fma_f32 v224, -v51, v37, v224
    v_fma_f32 v232, -v53, v39, v232
    v_fmac_f32 v226, v51, v36
    v_fmac_f32 v234, v53, v38
    v_mul_f32 v225, v54, v36
    v_mul_f32 v233, v56, v38
    v_mul_f32 v227, v54, v37
    v_mul_f32 v235, v56, v39
    v_fma_f32 v225, -v55, v37, v225
    v_fma_f32 v233, -v57, v39, v233
    v_fmac_f32 v227, v55, v36
    v_fmac_f32 v235, v57, v38
    v_accvgpr_read_b32 v4, a141
    v_xor_b32 v7, 16, v6
    v_mov_b32 v58, 0
    .p2align 3
    v_pk_fma_f32 v[228:229], v[80:81], v[74:75], v[224:225] op_sel:[0,0,0] op_sel_hi:[1,0,1]
    v_pk_fma_f32 v[236:237], v[96:97], v[76:77], v[232:233] op_sel:[0,0,0] op_sel_hi:[1,0,1]
    v_pk_fma_f32 v[230:231], v[112:113], v[74:75], v[226:227] op_sel:[0,0,0] op_sel_hi:[1,0,1]
    v_pk_fma_f32 v[238:239], v[128:129], v[76:77], v[234:235] op_sel:[0,0,0] op_sel_hi:[1,0,1]
    v_pk_mul_f32 v[32:33], v[224:225], v[54:55] op_sel:[0,0] op_sel_hi:[1,0]
    v_pk_mul_f32 v[34:35], v[232:233], v[56:57] op_sel:[0,0] op_sel_hi:[1,0]
    v_pk_mul_f32 v[36:37], v[226:227], v[54:55] op_sel:[0,0] op_sel_hi:[1,0]
    v_pk_mul_f32 v[38:39], v[234:235], v[56:57] op_sel:[0,0] op_sel_hi:[1,0]
    v_pk_fma_f32 v[228:229], v[112:113], v[74:75], v[228:229] op_sel:[0,1,0] op_sel_hi:[1,1,1] neg_lo:[0,1,0] neg_hi:[0,1,0]
    v_pk_fma_f32 v[236:237], v[128:129], v[76:77], v[236:237] op_sel:[0,1,0] op_sel_hi:[1,1,1] neg_lo:[0,1,0] neg_hi:[0,1,0]
    v_pk_fma_f32 v[230:231], v[80:81], v[74:75], v[230:231] op_sel:[0,1,0] op_sel_hi:[1,1,1]
    v_pk_fma_f32 v[238:239], v[96:97], v[76:77], v[238:239] op_sel:[0,1,0] op_sel_hi:[1,1,1]
    v_pk_fma_f32 v[32:33], v[226:227], v[54:55], v[32:33] op_sel:[0,1,0] op_sel_hi:[1,1,1] neg_lo:[0,1,0] neg_hi:[0,1,0]
    v_pk_fma_f32 v[34:35], v[234:235], v[56:57], v[34:35] op_sel:[0,1,0] op_sel_hi:[1,1,1] neg_lo:[0,1,0] neg_hi:[0,1,0]
    v_pk_fma_f32 v[36:37], v[224:225], v[54:55], v[36:37] op_sel:[0,1,0] op_sel_hi:[1,1,1]
    v_pk_fma_f32 v[38:39], v[232:233], v[56:57], v[38:39] op_sel:[0,1,0] op_sel_hi:[1,1,1]
    v_pk_mul_f32 v[228:229], v[228:229], v[8:9]
    v_pk_mul_f32 v[236:237], v[236:237], v[8:9]
    v_pk_mul_f32 v[230:231], v[230:231], v[8:9] neg_lo:[0,1] neg_hi:[0,1]
    v_pk_mul_f32 v[238:239], v[238:239], v[8:9] neg_lo:[0,1] neg_hi:[0,1]
    v_cvt_pk_bf16_f32 v80, v228, v229
    v_cvt_pk_bf16_f32 v96, v236, v237
    v_cvt_pk_bf16_f32 v112, v230, v231
    v_cvt_pk_bf16_f32 v128, v238, v239
    v_pk_fma_f32 v[228:229], v[82:83], v[74:75], v[32:33] op_sel:[0,0,0] op_sel_hi:[1,0,1]
    v_pk_fma_f32 v[236:237], v[98:99], v[76:77], v[34:35] op_sel:[0,0,0] op_sel_hi:[1,0,1]
    v_pk_fma_f32 v[230:231], v[114:115], v[74:75], v[36:37] op_sel:[0,0,0] op_sel_hi:[1,0,1]
    v_pk_fma_f32 v[238:239], v[130:131], v[76:77], v[38:39] op_sel:[0,0,0] op_sel_hi:[1,0,1]
    v_pk_mul_f32 v[224:225], v[32:33], v[54:55] op_sel:[0,0] op_sel_hi:[1,0]
    v_pk_mul_f32 v[232:233], v[34:35], v[56:57] op_sel:[0,0] op_sel_hi:[1,0]
    v_pk_mul_f32 v[226:227], v[36:37], v[54:55] op_sel:[0,0] op_sel_hi:[1,0]
    v_pk_mul_f32 v[234:235], v[38:39], v[56:57] op_sel:[0,0] op_sel_hi:[1,0]
    v_pk_fma_f32 v[228:229], v[114:115], v[74:75], v[228:229] op_sel:[0,1,0] op_sel_hi:[1,1,1] neg_lo:[0,1,0] neg_hi:[0,1,0]
    v_pk_fma_f32 v[236:237], v[130:131], v[76:77], v[236:237] op_sel:[0,1,0] op_sel_hi:[1,1,1] neg_lo:[0,1,0] neg_hi:[0,1,0]
    v_pk_fma_f32 v[230:231], v[82:83], v[74:75], v[230:231] op_sel:[0,1,0] op_sel_hi:[1,1,1]
    v_pk_fma_f32 v[238:239], v[98:99], v[76:77], v[238:239] op_sel:[0,1,0] op_sel_hi:[1,1,1]
    v_pk_fma_f32 v[224:225], v[36:37], v[54:55], v[224:225] op_sel:[0,1,0] op_sel_hi:[1,1,1] neg_lo:[0,1,0] neg_hi:[0,1,0]
    v_pk_fma_f32 v[232:233], v[38:39], v[56:57], v[232:233] op_sel:[0,1,0] op_sel_hi:[1,1,1] neg_lo:[0,1,0] neg_hi:[0,1,0]
    v_pk_fma_f32 v[226:227], v[32:33], v[54:55], v[226:227] op_sel:[0,1,0] op_sel_hi:[1,1,1]
    v_pk_fma_f32 v[234:235], v[34:35], v[56:57], v[234:235] op_sel:[0,1,0] op_sel_hi:[1,1,1]
    v_pk_mul_f32 v[228:229], v[228:229], v[10:11]
    v_pk_mul_f32 v[236:237], v[236:237], v[10:11]
    v_pk_mul_f32 v[230:231], v[230:231], v[10:11] neg_lo:[0,1] neg_hi:[0,1]
    v_pk_mul_f32 v[238:239], v[238:239], v[10:11] neg_lo:[0,1] neg_hi:[0,1]
    v_cvt_pk_bf16_f32 v81, v228, v229
    v_cvt_pk_bf16_f32 v97, v236, v237
    v_cvt_pk_bf16_f32 v113, v230, v231
    v_cvt_pk_bf16_f32 v129, v238, v239
    v_pk_fma_f32 v[228:229], v[84:85], v[74:75], v[224:225] op_sel:[0,0,0] op_sel_hi:[1,0,1]
    v_pk_fma_f32 v[236:237], v[100:101], v[76:77], v[232:233] op_sel:[0,0,0] op_sel_hi:[1,0,1]
    v_pk_fma_f32 v[230:231], v[116:117], v[74:75], v[226:227] op_sel:[0,0,0] op_sel_hi:[1,0,1]
    v_pk_fma_f32 v[238:239], v[132:133], v[76:77], v[234:235] op_sel:[0,0,0] op_sel_hi:[1,0,1]
    v_pk_mul_f32 v[32:33], v[224:225], v[54:55] op_sel:[0,0] op_sel_hi:[1,0]
    v_pk_mul_f32 v[34:35], v[232:233], v[56:57] op_sel:[0,0] op_sel_hi:[1,0]
    v_pk_mul_f32 v[36:37], v[226:227], v[54:55] op_sel:[0,0] op_sel_hi:[1,0]
    v_pk_mul_f32 v[38:39], v[234:235], v[56:57] op_sel:[0,0] op_sel_hi:[1,0]
    v_pk_fma_f32 v[228:229], v[116:117], v[74:75], v[228:229] op_sel:[0,1,0] op_sel_hi:[1,1,1] neg_lo:[0,1,0] neg_hi:[0,1,0]
    v_pk_fma_f32 v[236:237], v[132:133], v[76:77], v[236:237] op_sel:[0,1,0] op_sel_hi:[1,1,1] neg_lo:[0,1,0] neg_hi:[0,1,0]
    v_pk_fma_f32 v[230:231], v[84:85], v[74:75], v[230:231] op_sel:[0,1,0] op_sel_hi:[1,1,1]
    v_pk_fma_f32 v[238:239], v[100:101], v[76:77], v[238:239] op_sel:[0,1,0] op_sel_hi:[1,1,1]
    v_pk_fma_f32 v[32:33], v[226:227], v[54:55], v[32:33] op_sel:[0,1,0] op_sel_hi:[1,1,1] neg_lo:[0,1,0] neg_hi:[0,1,0]
    v_pk_fma_f32 v[34:35], v[234:235], v[56:57], v[34:35] op_sel:[0,1,0] op_sel_hi:[1,1,1] neg_lo:[0,1,0] neg_hi:[0,1,0]
    v_pk_fma_f32 v[36:37], v[224:225], v[54:55], v[36:37] op_sel:[0,1,0] op_sel_hi:[1,1,1]
    v_pk_fma_f32 v[38:39], v[232:233], v[56:57], v[38:39] op_sel:[0,1,0] op_sel_hi:[1,1,1]
    v_pk_mul_f32 v[228:229], v[228:229], v[12:13]
    v_pk_mul_f32 v[236:237], v[236:237], v[12:13]
    v_pk_mul_f32 v[230:231], v[230:231], v[12:13] neg_lo:[0,1] neg_hi:[0,1]
    v_pk_mul_f32 v[238:239], v[238:239], v[12:13] neg_lo:[0,1] neg_hi:[0,1]
    v_cvt_pk_bf16_f32 v82, v228, v229
    v_cvt_pk_bf16_f32 v98, v236, v237
    v_cvt_pk_bf16_f32 v114, v230, v231
    v_cvt_pk_bf16_f32 v130, v238, v239
    v_pk_fma_f32 v[228:229], v[86:87], v[74:75], v[32:33] op_sel:[0,0,0] op_sel_hi:[1,0,1]
    v_pk_fma_f32 v[236:237], v[102:103], v[76:77], v[34:35] op_sel:[0,0,0] op_sel_hi:[1,0,1]
    v_pk_fma_f32 v[230:231], v[118:119], v[74:75], v[36:37] op_sel:[0,0,0] op_sel_hi:[1,0,1]
    v_pk_fma_f32 v[238:239], v[134:135], v[76:77], v[38:39] op_sel:[0,0,0] op_sel_hi:[1,0,1]
    v_pk_mul_f32 v[224:225], v[32:33], v[54:55] op_sel:[0,0] op_sel_hi:[1,0]
    v_pk_mul_f32 v[232:233], v[34:35], v[56:57] op_sel:[0,0] op_sel_hi:[1,0]
    v_pk_mul_f32 v[226:227], v[36:37], v[54:55] op_sel:[0,0] op_sel_hi:[1,0]
    v_pk_mul_f32 v[234:235], v[38:39], v[56:57] op_sel:[0,0] op_sel_hi:[1,0]
    v_pk_fma_f32 v[228:229], v[118:119], v[74:75], v[228:229] op_sel:[0,1,0] op_sel_hi:[1,1,1] neg_lo:[0,1,0] neg_hi:[0,1,0]
    v_pk_fma_f32 v[236:237], v[134:135], v[76:77], v[236:237] op_sel:[0,1,0] op_sel_hi:[1,1,1] neg_lo:[0,1,0] neg_hi:[0,1,0]
    v_pk_fma_f32 v[230:231], v[86:87], v[74:75], v[230:231] op_sel:[0,1,0] op_sel_hi:[1,1,1]
    v_pk_fma_f32 v[238:239], v[102:103], v[76:77], v[238:239] op_sel:[0,1,0] op_sel_hi:[1,1,1]
    v_pk_fma_f32 v[224:225], v[36:37], v[54:55], v[224:225] op_sel:[0,1,0] op_sel_hi:[1,1,1] neg_lo:[0,1,0] neg_hi:[0,1,0]
    v_pk_fma_f32 v[232:233], v[38:39], v[56:57], v[232:233] op_sel:[0,1,0] op_sel_hi:[1,1,1] neg_lo:[0,1,0] neg_hi:[0,1,0]
    v_pk_fma_f32 v[226:227], v[32:33], v[54:55], v[226:227] op_sel:[0,1,0] op_sel_hi:[1,1,1]
    v_pk_fma_f32 v[234:235], v[34:35], v[56:57], v[234:235] op_sel:[0,1,0] op_sel_hi:[1,1,1]
    v_pk_mul_f32 v[228:229], v[228:229], v[14:15]
    v_pk_mul_f32 v[236:237], v[236:237], v[14:15]
    v_pk_mul_f32 v[230:231], v[230:231], v[14:15] neg_lo:[0,1] neg_hi:[0,1]
    v_pk_mul_f32 v[238:239], v[238:239], v[14:15] neg_lo:[0,1] neg_hi:[0,1]
    v_cvt_pk_bf16_f32 v83, v228, v229
    v_cvt_pk_bf16_f32 v99, v236, v237
    v_cvt_pk_bf16_f32 v115, v230, v231
    v_cvt_pk_bf16_f32 v131, v238, v239
    s_waitcnt vmcnt(0)
    s_nop 0
    buffer_store_dword v58, v4, s[4:7], s56 offen sc1
    v_pk_fma_f32 v[228:229], v[88:89], v[74:75], v[224:225] op_sel:[0,0,0] op_sel_hi:[1,0,1]
    v_pk_fma_f32 v[236:237], v[104:105], v[76:77], v[232:233] op_sel:[0,0,0] op_sel_hi:[1,0,1]
    v_pk_fma_f32 v[230:231], v[120:121], v[74:75], v[226:227] op_sel:[0,0,0] op_sel_hi:[1,0,1]
    v_pk_fma_f32 v[238:239], v[136:137], v[76:77], v[234:235] op_sel:[0,0,0] op_sel_hi:[1,0,1]
    v_pk_mul_f32 v[32:33], v[224:225], v[54:55] op_sel:[0,0] op_sel_hi:[1,0]
    ds_write_b128 v6, v[80:83] offset:0
    v_pk_mul_f32 v[34:35], v[232:233], v[56:57] op_sel:[0,0] op_sel_hi:[1,0]
    v_pk_mul_f32 v[36:37], v[226:227], v[54:55] op_sel:[0,0] op_sel_hi:[1,0]
    v_pk_mul_f32 v[38:39], v[234:235], v[56:57] op_sel:[0,0] op_sel_hi:[1,0]
    v_pk_fma_f32 v[228:229], v[120:121], v[74:75], v[228:229] op_sel:[0,1,0] op_sel_hi:[1,1,1] neg_lo:[0,1,0] neg_hi:[0,1,0]
    v_pk_fma_f32 v[236:237], v[136:137], v[76:77], v[236:237] op_sel:[0,1,0] op_sel_hi:[1,1,1] neg_lo:[0,1,0] neg_hi:[0,1,0]
    v_pk_fma_f32 v[230:231], v[88:89], v[74:75], v[230:231] op_sel:[0,1,0] op_sel_hi:[1,1,1]
    v_pk_fma_f32 v[238:239], v[104:105], v[76:77], v[238:239] op_sel:[0,1,0] op_sel_hi:[1,1,1]
    v_pk_fma_f32 v[32:33], v[226:227], v[54:55], v[32:33] op_sel:[0,1,0] op_sel_hi:[1,1,1] neg_lo:[0,1,0] neg_hi:[0,1,0]
    v_pk_fma_f32 v[34:35], v[234:235], v[56:57], v[34:35] op_sel:[0,1,0] op_sel_hi:[1,1,1] neg_lo:[0,1,0] neg_hi:[0,1,0]
    v_pk_fma_f32 v[36:37], v[224:225], v[54:55], v[36:37] op_sel:[0,1,0] op_sel_hi:[1,1,1]
    ds_write_b128 v6, v[96:99] offset:2048
    v_pk_fma_f32 v[38:39], v[232:233], v[56:57], v[38:39] op_sel:[0,1,0] op_sel_hi:[1,1,1]
    v_pk_mul_f32 v[228:229], v[228:229], v[16:17]
    v_pk_mul_f32 v[236:237], v[236:237], v[16:17]
    v_pk_mul_f32 v[230:231], v[230:231], v[16:17] neg_lo:[0,1] neg_hi:[0,1]
    v_pk_mul_f32 v[238:239], v[238:239], v[16:17] neg_lo:[0,1] neg_hi:[0,1]
    v_cvt_pk_bf16_f32 v84, v228, v229
    v_cvt_pk_bf16_f32 v100, v236, v237
    v_cvt_pk_bf16_f32 v116, v230, v231
    v_cvt_pk_bf16_f32 v132, v238, v239
    v_pk_fma_f32 v[228:229], v[90:91], v[74:75], v[32:33] op_sel:[0,0,0] op_sel_hi:[1,0,1]
    v_pk_fma_f32 v[236:237], v[106:107], v[76:77], v[34:35] op_sel:[0,0,0] op_sel_hi:[1,0,1]
    v_pk_fma_f32 v[230:231], v[122:123], v[74:75], v[36:37] op_sel:[0,0,0] op_sel_hi:[1,0,1]
    v_pk_fma_f32 v[238:239], v[138:139], v[76:77], v[38:39] op_sel:[0,0,0] op_sel_hi:[1,0,1]
    v_pk_mul_f32 v[224:225], v[32:33], v[54:55] op_sel:[0,0] op_sel_hi:[1,0]
    ds_write_b128 v6, v[112:115] offset:4096
    v_pk_mul_f32 v[232:233], v[34:35], v[56:57] op_sel:[0,0] op_sel_hi:[1,0]
    v_pk_mul_f32 v[226:227], v[36:37], v[54:55] op_sel:[0,0] op_sel_hi:[1,0]
    v_pk_mul_f32 v[234:235], v[38:39], v[56:57] op_sel:[0,0] op_sel_hi:[1,0]
    v_pk_fma_f32 v[228:229], v[122:123], v[74:75], v[228:229] op_sel:[0,1,0] op_sel_hi:[1,1,1] neg_lo:[0,1,0] neg_hi:[0,1,0]
    v_pk_fma_f32 v[236:237], v[138:139], v[76:77], v[236:237] op_sel:[0,1,0] op_sel_hi:[1,1,1] neg_lo:[0,1,0] neg_hi:[0,1,0]
    v_pk_fma_f32 v[230:231], v[90:91], v[74:75], v[230:231] op_sel:[0,1,0] op_sel_hi:[1,1,1]
    v_pk_fma_f32 v[238:239], v[106:107], v[76:77], v[238:239] op_sel:[0,1,0] op_sel_hi:[1,1,1]
    v_pk_fma_f32 v[224:225], v[36:37], v[54:55], v[224:225] op_sel:[0,1,0] op_sel_hi:[1,1,1] neg_lo:[0,1,0] neg_hi:[0,1,0]
    v_pk_fma_f32 v[232:233], v[38:39], v[56:57], v[232:233] op_sel:[0,1,0] op_sel_hi:[1,1,1] neg_lo:[0,1,0] neg_hi:[0,1,0]
    v_pk_fma_f32 v[226:227], v[32:33], v[54:55], v[226:227] op_sel:[0,1,0] op_sel_hi:[1,1,1]
    ds_write_b128 v6, v[128:131] offset:6144
    v_pk_fma_f32 v[234:235], v[34:35], v[56:57], v[234:235] op_sel:[0,1,0] op_sel_hi:[1,1,1]
    v_pk_mul_f32 v[228:229], v[228:229], v[18:19]
    v_pk_mul_f32 v[236:237], v[236:237], v[18:19]
    v_pk_mul_f32 v[230:231], v[230:231], v[18:19] neg_lo:[0,1] neg_hi:[0,1]
    v_pk_mul_f32 v[238:239], v[238:239], v[18:19] neg_lo:[0,1] neg_hi:[0,1]
    v_cvt_pk_bf16_f32 v85, v228, v229
    v_cvt_pk_bf16_f32 v101, v236, v237
    v_cvt_pk_bf16_f32 v117, v230, v231
    v_cvt_pk_bf16_f32 v133, v238, v239
    v_pk_fma_f32 v[228:229], v[92:93], v[74:75], v[224:225] op_sel:[0,0,0] op_sel_hi:[1,0,1]
    v_pk_fma_f32 v[236:237], v[108:109], v[76:77], v[232:233] op_sel:[0,0,0] op_sel_hi:[1,0,1]
    v_pk_fma_f32 v[230:231], v[124:125], v[74:75], v[226:227] op_sel:[0,0,0] op_sel_hi:[1,0,1]
    v_pk_fma_f32 v[238:239], v[140:141], v[76:77], v[234:235] op_sel:[0,0,0] op_sel_hi:[1,0,1]
    v_pk_mul_f32 v[32:33], v[224:225], v[54:55] op_sel:[0,0] op_sel_hi:[1,0]
    v_pk_mul_f32 v[34:35], v[232:233], v[56:57] op_sel:[0,0] op_sel_hi:[1,0]
    v_pk_mul_f32 v[36:37], v[226:227], v[54:55] op_sel:[0,0] op_sel_hi:[1,0]
    v_pk_mul_f32 v[38:39], v[234:235], v[56:57] op_sel:[0,0] op_sel_hi:[1,0]
    v_pk_fma_f32 v[228:229], v[124:125], v[74:75], v[228:229] op_sel:[0,1,0] op_sel_hi:[1,1,1] neg_lo:[0,1,0] neg_hi:[0,1,0]
    v_pk_fma_f32 v[236:237], v[140:141], v[76:77], v[236:237] op_sel:[0,1,0] op_sel_hi:[1,1,1] neg_lo:[0,1,0] neg_hi:[0,1,0]
    v_pk_fma_f32 v[230:231], v[92:93], v[74:75], v[230:231] op_sel:[0,1,0] op_sel_hi:[1,1,1]
    v_pk_fma_f32 v[238:239], v[108:109], v[76:77], v[238:239] op_sel:[0,1,0] op_sel_hi:[1,1,1]
    v_pk_fma_f32 v[32:33], v[226:227], v[54:55], v[32:33] op_sel:[0,1,0] op_sel_hi:[1,1,1] neg_lo:[0,1,0] neg_hi:[0,1,0]
    v_pk_fma_f32 v[34:35], v[234:235], v[56:57], v[34:35] op_sel:[0,1,0] op_sel_hi:[1,1,1] neg_lo:[0,1,0] neg_hi:[0,1,0]
    v_pk_fma_f32 v[36:37], v[224:225], v[54:55], v[36:37] op_sel:[0,1,0] op_sel_hi:[1,1,1]
    v_pk_fma_f32 v[38:39], v[232:233], v[56:57], v[38:39] op_sel:[0,1,0] op_sel_hi:[1,1,1]
    v_pk_mul_f32 v[228:229], v[228:229], v[20:21]
    v_pk_mul_f32 v[236:237], v[236:237], v[20:21]
    v_pk_mul_f32 v[230:231], v[230:231], v[20:21] neg_lo:[0,1] neg_hi:[0,1]
    v_pk_mul_f32 v[238:239], v[238:239], v[20:21] neg_lo:[0,1] neg_hi:[0,1]
    v_cvt_pk_bf16_f32 v86, v228, v229
    v_cvt_pk_bf16_f32 v102, v236, v237
    v_cvt_pk_bf16_f32 v118, v230, v231
    v_cvt_pk_bf16_f32 v134, v238, v239
    v_pk_fma_f32 v[228:229], v[94:95], v[74:75], v[32:33] op_sel:[0,0,0] op_sel_hi:[1,0,1]
    v_pk_fma_f32 v[236:237], v[110:111], v[76:77], v[34:35] op_sel:[0,0,0] op_sel_hi:[1,0,1]
    v_pk_fma_f32 v[230:231], v[126:127], v[74:75], v[36:37] op_sel:[0,0,0] op_sel_hi:[1,0,1]
    v_pk_fma_f32 v[238:239], v[142:143], v[76:77], v[38:39] op_sel:[0,0,0] op_sel_hi:[1,0,1]
    v_pk_fma_f32 v[228:229], v[126:127], v[74:75], v[228:229] op_sel:[0,1,0] op_sel_hi:[1,1,1] neg_lo:[0,1,0] neg_hi:[0,1,0]
    v_pk_fma_f32 v[236:237], v[142:143], v[76:77], v[236:237] op_sel:[0,1,0] op_sel_hi:[1,1,1] neg_lo:[0,1,0] neg_hi:[0,1,0]
    v_pk_fma_f32 v[230:231], v[94:95], v[74:75], v[230:231] op_sel:[0,1,0] op_sel_hi:[1,1,1]
    v_pk_fma_f32 v[238:239], v[110:111], v[76:77], v[238:239] op_sel:[0,1,0] op_sel_hi:[1,1,1]
    v_pk_mul_f32 v[228:229], v[228:229], v[22:23]
    v_pk_mul_f32 v[236:237], v[236:237], v[22:23]
    v_pk_mul_f32 v[230:231], v[230:231], v[22:23] neg_lo:[0,1] neg_hi:[0,1]
    v_pk_mul_f32 v[238:239], v[238:239], v[22:23] neg_lo:[0,1] neg_hi:[0,1]
    v_cvt_pk_bf16_f32 v87, v228, v229
    v_cvt_pk_bf16_f32 v103, v236, v237
    v_cvt_pk_bf16_f32 v119, v230, v231
    v_cvt_pk_bf16_f32 v135, v238, v239
    ds_write_b128 v7, v[84:87] offset:0
    v_accvgpr_read_b32 v32, a143
    v_accvgpr_read_b32 v40, a140
    v_xor_b32 v33, 32, v32
    v_xor_b32 v34, 64, v32
    ds_write_b128 v7, v[100:103] offset:2048
    v_xor_b32 v35, 96, v32
    v_xor_b32 v36, 128, v32
    v_xor_b32 v37, 160, v32
    v_xor_b32 v38, 192, v32
    ds_write_b128 v7, v[116:119] offset:4096
    v_xor_b32 v39, 224, v32
    v_xor_b32 v41, 16, v40
    v_xor_b32 v78, 32, v40
    v_xor_b32 v79, 48, v40
    ds_write_b128 v7, v[132:135] offset:6144
    v_lshlrev_b32 v5, 2, v0
    ds_read_b64_tr_b16 a[64:65], v32 offset:40960
    ds_read_b64_tr_b16 a[66:67], v32 offset:45056
    ds_read_b64_tr_b16 a[68:69], v32 offset:49152
    ds_read_b64_tr_b16 a[70:71], v32 offset:53248
    ds_read_b64_tr_b16 a[72:73], v33 offset:40960
    ds_read_b64_tr_b16 a[74:75], v33 offset:45056
    ds_read_b64_tr_b16 a[76:77], v33 offset:49152
    ds_read_b64_tr_b16 a[78:79], v33 offset:53248
    ds_read_b64_tr_b16 a[80:81], v34 offset:40960
    ds_read_b64_tr_b16 a[82:83], v34 offset:45056
    ds_read_b64_tr_b16 a[84:85], v34 offset:49152
    ds_read_b64_tr_b16 a[86:87], v34 offset:53248
    .p2align 3
    s_waitcnt lgkmcnt(8)
    v_mfma_f32_16x16x32_bf16 v[80:83], a[64:67], v[144:147], 0
    ds_read_b64_tr_b16 a[88:89], v35 offset:40960
    v_and_b32 v5, 28, v5
    v_mfma_f32_16x16x32_bf16 v[80:83], a[68:71], v[176:179], v[80:83]
    ds_read_b64_tr_b16 a[90:91], v35 offset:45056
    ds_read_b64_tr_b16 a[96:97], v40 offset:0
    v_mfma_f32_16x16x32_bf16 v[84:87], a[68:71], v[180:183], 0
    s_add_u32 s62, s72, 0x110000
    v_bfrev_b32 v59, 1
    ds_read_b64_tr_b16 a[98:99], v78 offset:512
    v_mfma_f32_16x16x32_bf16 v[84:87], a[64:67], v[148:151], v[84:87]
    ds_read_b64_tr_b16 a[92:93], v35 offset:49152
    ds_read_b64_tr_b16 a[100:101], v40 offset:8
    v_mfma_f32_16x16x32_bf16 v[88:91], a[64:67], v[152:155], 0
    s_add_u32 m0, s59, 0x100000
    ds_read_b64_tr_b16 a[102:103], v78 offset:520
    v_mfma_f32_16x16x32_bf16 v[88:91], a[68:71], v[184:187], v[88:91]
    ds_read_b64_tr_b16 a[94:95], v35 offset:53248
    ds_read_b64_tr_b16 a[104:105], v41 offset:0
    v_mfma_f32_16x16x32_bf16 v[92:95], a[68:71], v[188:191], 0
    buffer_load_dwordx4 v24, s[32:35], s62 offen offset:0  lds
    ds_read_b64_tr_b16 a[106:107], v79 offset:512
    v_mfma_f32_16x16x32_bf16 v[92:95], a[64:67], v[156:159], v[92:95]
    buffer_load_dwordx4 v25, s[32:35], s62 offen offset:1024  lds
    s_waitcnt lgkmcnt(14)
    v_mfma_f32_16x16x32_bf16 v[108:111], a[72:75], v[156:159], 0
    ds_read_b64_tr_b16 a[64:65], v36 offset:40960
    ds_read_b64_tr_b16 a[108:109], v41 offset:8
    v_mfma_f32_16x16x32_bf16 v[108:111], a[76:79], v[188:191], v[108:111]
    ds_read_b64_tr_b16 a[66:67], v36 offset:45056
    ds_read_b64_tr_b16 a[110:111], v79 offset:520
    v_mfma_f32_16x16x32_bf16 v[104:107], a[76:79], v[184:187], 0
    s_add_u32 m0, s60, 0x110000
    v_mfma_f32_16x16x32_bf16 v[104:107], a[72:75], v[152:155], v[104:107]
    ds_read_b64_tr_b16 a[68:69], v36 offset:49152
    ds_read_b64_tr_b16 a[112:113], v40 offset:4096
    v_mfma_f32_16x16x32_bf16 v[100:103], a[72:75], v[148:151], 0
    buffer_load_dwordx4 v28, s[36:39], s81 offen offset:0  lds
    ds_read_b64_tr_b16 a[114:115], v78 offset:4608
    v_mfma_f32_16x16x32_bf16 v[100:103], a[76:79], v[180:183], v[100:103]
    ds_read_b64_tr_b16 a[70:71], v36 offset:53248
    v_mfma_f32_16x16x32_bf16 v[96:99], a[76:79], v[176:179], 0
    ds_read_b64_tr_b16 a[116:117], v40 offset:4104
    v_mfma_f32_16x16x32_bf16 v[96:99], a[72:75], v[144:147], v[96:99]
    ds_read_b64_tr_b16 a[118:119], v78 offset:4616
    s_waitcnt lgkmcnt(14)
    v_mfma_f32_16x16x32_bf16 v[112:115], a[80:83], v[144:147], 0
    ds_read_b64_tr_b16 a[72:73], v37 offset:40960
    ds_read_b64_tr_b16 a[120:121], v41 offset:4096
    v_mfma_f32_16x16x32_bf16 v[112:115], a[84:87], v[176:179], v[112:115]
    ds_read_b64_tr_b16 a[74:75], v37 offset:45056
    ds_read_b64_tr_b16 a[122:123], v79 offset:4608
    v_mfma_f32_16x16x32_bf16 v[116:119], a[84:87], v[180:183], 0
    buffer_load_dwordx4 v29, s[36:39], s81 offen offset:1024  lds
    v_mfma_f32_16x16x32_bf16 v[116:119], a[80:83], v[148:151], v[116:119]
    ds_read_b64_tr_b16 a[76:77], v37 offset:49152
    ds_read_b64_tr_b16 a[124:125], v41 offset:4104
    v_mfma_f32_16x16x32_bf16 v[120:123], a[80:83], v[152:155], 0
    s_add_u32 m0, s60, 0x110000
    ds_read_b64_tr_b16 a[126:127], v79 offset:4616
    v_mfma_f32_16x16x32_bf16 v[120:123], a[84:87], v[184:187], v[120:123]
    ds_read_b64_tr_b16 a[78:79], v37 offset:53248
    v_mfma_f32_16x16x32_bf16 v[124:127], a[84:87], v[188:191], 0
    buffer_load_dwordx4 v30, s[36:39], s81 offen offset:2048  lds
    v_accvgpr_read_b32 v3, a144
    v_mfma_f32_16x16x32_bf16 v[124:127], a[80:83], v[156:159], v[124:127]
    s_waitcnt lgkmcnt(14)
    v_mfma_f32_16x16x32_bf16 v[140:143], a[88:91], v[156:159], 0
    ds_read_b64_tr_b16 a[80:81], v38 offset:40960
    s_lshl_b32 s19, s17, 6
    v_mfma_f32_16x16x32_bf16 v[140:143], a[92:95], v[188:191], v[140:143]
    ds_read_b64_tr_b16 a[82:83], v38 offset:45056
    v_mfma_f32_16x16x32_bf16 v[136:139], a[92:95], v[184:187], 0
    buffer_load_dwordx4 v31, s[36:39], s81 offen offset:3072  lds
    v_mfma_f32_16x16x32_bf16 v[136:139], a[88:91], v[152:155], v[136:139]
    ds_read_b64_tr_b16 a[84:85], v38 offset:49152
    v_add_u32 v40, 0x8000, v3
    v_mfma_f32_16x16x32_bf16 v[132:135], a[88:91], v[148:151], 0
    buffer_load_dword v7, v5, s[4:7], s56 offen offset:0 sc1
    v_mfma_f32_16x16x32_bf16 v[132:135], a[92:95], v[180:183], v[132:135]
    ds_read_b64_tr_b16 a[86:87], v38 offset:53248
    v_mfma_f32_16x16x32_bf16 v[128:131], a[92:95], v[176:179], 0
    s_add_u32 m0, s60, 0x114000
    v_xor_b32 v41, 64, v40
    v_mfma_f32_16x16x32_bf16 v[128:131], a[88:91], v[144:147], v[128:131]
    s_waitcnt lgkmcnt(14)
    v_mfma_f32_16x16x32_bf16 v[160:163], a[64:67], v[144:147], 0
    ds_read_b64_tr_b16 a[88:89], v39 offset:40960
    v_xor_b32 v2, s19, v3
    v_mfma_f32_16x16x32_bf16 v[160:163], a[68:71], v[176:179], v[160:163]
    ds_read_b64_tr_b16 a[90:91], v39 offset:45056
    v_mfma_f32_16x16x32_bf16 v[164:167], a[68:71], v[180:183], 0
    buffer_load_dwordx4 v28, s[40:43], s81 offen offset:0  lds
    v_mfma_f32_16x16x32_bf16 v[164:167], a[64:67], v[148:151], v[164:167]
    ds_read_b64_tr_b16 a[92:93], v39 offset:49152
    v_xor_b32 v3, 64, v2
    v_mfma_f32_16x16x32_bf16 v[168:171], a[64:67], v[152:155], 0
    buffer_load_dwordx4 v29, s[40:43], s81 offen offset:1024  lds
    v_mfma_f32_16x16x32_bf16 v[168:171], a[68:71], v[184:187], v[168:171]
    ds_read_b64_tr_b16 a[94:95], v39 offset:53248
    v_mfma_f32_16x16x32_bf16 v[172:175], a[68:71], v[188:191], 0
    v_mfma_f32_16x16x32_bf16 v[172:175], a[64:67], v[156:159], v[172:175]
    s_waitcnt lgkmcnt(9)
    s_barrier
    s_waitcnt lgkmcnt(8)
    v_mfma_f32_16x16x32_bf16 v[204:207], a[72:75], v[156:159], 0
    ds_read_b64_tr_b16 a[64:65], v32 offset:57344
    v_mfma_f32_16x16x32_bf16 v[204:207], a[76:79], v[188:191], v[204:207]
    s_add_u32 m0, s60, 0x114000
    v_mfma_f32_16x16x32_bf16 v[200:203], a[76:79], v[184:187], 0
    ds_read_b64_tr_b16 a[66:67], v32 offset:61440
    v_accvgpr_read_b32 v50, a128
    v_mfma_f32_16x16x32_bf16 v[200:203], a[72:75], v[152:155], v[200:203]
    buffer_load_dwordx4 v30, s[40:43], s81 offen offset:2048  lds
    v_mfma_f32_16x16x32_bf16 v[196:199], a[72:75], v[148:151], 0
    ds_read_b128 a[68:71], v2 offset:0
    v_mfma_f32_16x16x32_bf16 v[196:199], a[76:79], v[180:183], v[196:199]
    buffer_load_dwordx4 v31, s[40:43], s81 offen offset:3072  lds
    v_mfma_f32_16x16x32_bf16 v[192:195], a[76:79], v[176:179], 0
    v_accvgpr_read_b32 v51, a129
    v_mfma_f32_16x16x32_bf16 v[192:195], a[72:75], v[144:147], v[192:195]
    v_accvgpr_read_b32 v52, a130
    s_waitcnt lgkmcnt(7)
    v_mfma_f32_16x16x32_bf16 v[224:227], a[80:83], v[144:147], 0
    ds_read_b64_tr_b16 a[72:73], v33 offset:57344
    v_mfma_f32_16x16x32_bf16 v[224:227], a[84:87], v[176:179], v[224:227]
    s_add_u32 m0, s60, 0x108000
    v_accvgpr_read_b32 v53, a131
    v_mfma_f32_16x16x32_bf16 v[228:231], a[84:87], v[180:183], 0
    ds_read_b64_tr_b16 a[74:75], v33 offset:61440
    v_mfma_f32_16x16x32_bf16 v[228:231], a[80:83], v[148:151], v[228:231]
    buffer_load_dwordx4 v28, s[36:39], s82 offen offset:0  lds
    v_mfma_f32_16x16x32_bf16 v[232:235], a[80:83], v[152:155], 0
    ds_read_b128 a[76:79], v2 offset:2048
    v_mfma_f32_16x16x32_bf16 v[232:235], a[84:87], v[184:187], v[232:235]
    v_accvgpr_read_b32 v54, a132
    v_mfma_f32_16x16x32_bf16 v[236:239], a[84:87], v[188:191], 0
    buffer_load_dwordx4 v29, s[36:39], s82 offen offset:1024  lds
    v_mfma_f32_16x16x32_bf16 v[236:239], a[80:83], v[156:159], v[236:239]
    s_waitcnt lgkmcnt(6)
    v_mfma_f32_16x16x32_bf16 v[252:255], a[88:91], v[156:159], 0
    ds_read_b64_tr_b16 a[80:81], v34 offset:57344
    v_mfma_f32_16x16x32_bf16 v[252:255], a[92:95], v[188:191], v[252:255]
    v_accvgpr_read_b32 v55, a133
    v_mfma_f32_16x16x32_bf16 v[248:251], a[92:95], v[184:187], 0
    ds_read_b64_tr_b16 a[82:83], v34 offset:61440
    v_accvgpr_read_b32 v56, a134
    v_mfma_f32_16x16x32_bf16 v[248:251], a[88:91], v[152:155], v[248:251]
    s_add_u32 m0, s60, 0x108000
    v_accvgpr_read_b32 v57, a135
    v_mfma_f32_16x16x32_bf16 v[244:247], a[88:91], v[148:151], 0
    ds_read_b128 a[84:87], v2 offset:4096
    v_mfma_f32_16x16x32_bf16 v[244:247], a[92:95], v[180:183], v[244:247]
    buffer_load_dwordx4 v30, s[36:39], s82 offen offset:2048  lds
    v_mfma_f32_16x16x32_bf16 v[240:243], a[92:95], v[176:179], 0
    v_mfma_f32_16x16x32_bf16 v[240:243], a[88:91], v[144:147], v[240:243]
    s_waitcnt lgkmcnt(6)
    v_mfma_f32_16x16x32_bf16 v[80:83], a[64:67], v[208:211], v[80:83]
    ds_read_b64_tr_b16 a[88:89], v35 offset:57344
    v_mfma_f32_16x16x32_bf16 v[80:83], a[68:71], a[96:99], v[80:83]
    buffer_load_dwordx4 v31, s[36:39], s82 offen offset:3072  lds
    v_mfma_f32_16x16x32_bf16 v[84:87], a[68:71], a[100:103], v[84:87]
    ds_read_b64_tr_b16 a[90:91], v35 offset:61440
    v_mfma_f32_16x16x32_bf16 v[84:87], a[64:67], v[212:215], v[84:87]
    s_waitcnt vmcnt(8)
    v_mfma_f32_16x16x32_bf16 v[88:91], a[64:67], v[216:219], v[88:91]
    ds_read_b128 a[92:95], v2 offset:6144
    v_cmp_ne_u32 vcc, 0, v7
    s_cmp_eq_u64 vcc, 0
    s_cbranch_scc0 L_slow_flF
L_back_flF:
    v_mfma_f32_16x16x32_bf16 v[88:91], a[68:71], a[104:107], v[88:91]
    s_add_u32 s63, s64, 0x100000
    v_mfma_f32_16x16x32_bf16 v[92:95], a[68:71], a[108:111], v[92:95]
    v_mfma_f32_16x16x32_bf16 v[92:95], a[64:67], v[220:223], v[92:95]
    s_waitcnt lgkmcnt(6)
    v_mfma_f32_16x16x32_bf16 v[108:111], a[72:75], v[220:223], v[108:111]
    ds_read_b64_tr_b16 a[64:65], v36 offset:57344
    v_mfma_f32_16x16x32_bf16 v[108:111], a[76:79], a[108:111], v[108:111]
    buffer_load_dwordx4 a[160:163], v1, s[4:7], s63 offen offset:0 sc1
    v_mfma_f32_16x16x32_bf16 v[104:107], a[76:79], a[104:107], v[104:107]
    ds_read_b64_tr_b16 a[66:67], v36 offset:61440
    v_mfma_f32_16x16x32_bf16 v[104:107], a[72:75], v[216:219], v[104:107]
    v_lshlrev_b32 v60, 1, v62
    v_mfma_f32_16x16x32_bf16 v[100:103], a[72:75], v[212:215], v[100:103]
    ds_read_b128 a[68:71], v2 offset:8192
    v_mfma_f32_16x16x32_bf16 v[100:103], a[76:79], a[100:103], v[100:103]
    buffer_load_dwordx4 a[164:167], v1, s[4:7], s63 offen offset:1024 sc1
    v_mfma_f32_16x16x32_bf16 v[96:99], a[76:79], a[96:99], v[96:99]
    v_accvgpr_read_b32 v8, a0
    v_mfma_f32_16x16x32_bf16 v[96:99], a[72:75], v[208:211], v[96:99]
    s_waitcnt lgkmcnt(6)
    v_mfma_f32_16x16x32_bf16 v[112:115], a[80:83], v[208:211], v[112:115]
    ds_read_b64_tr_b16 a[72:73], v37 offset:57344
    v_mfma_f32_16x16x32_bf16 v[112:115], a[84:87], a[96:99], v[112:115]
    buffer_load_dwordx4 a[168:171], v1, s[4:7], s63 offen offset:2048 sc1
    v_mfma_f32_16x16x32_bf16 v[116:119], a[84:87], a[100:103], v[116:119]
    ds_read_b64_tr_b16 a[74:75], v37 offset:61440
    v_mfma_f32_16x16x32_bf16 v[116:119], a[80:83], v[212:215], v[116:119]
    v_accvgpr_read_b32 v9, a1
    v_mfma_f32_16x16x32_bf16 v[120:123], a[80:83], v[216:219], v[120:123]
    ds_read_b128 a[76:79], v2 offset:10240
    v_mfma_f32_16x16x32_bf16 v[120:123], a[84:87], a[104:107], v[120:123]
    buffer_load_dwordx4 a[172:175], v1, s[4:7], s63 offen offset:3072 sc1
    v_mfma_f32_16x16x32_bf16 v[124:127], a[84:87], a[108:111], v[124:127]
    v_accvgpr_read_b32 v10, a2
    v_mfma_f32_16x16x32_bf16 v[124:127], a[80:83], v[220:223], v[124:127]
    v_accvgpr_read_b32 v11, a3
    s_waitcnt lgkmcnt(6)
    v_mfma_f32_16x16x32_bf16 v[140:143], a[88:91], v[220:223], v[140:143]
    ds_read_b64_tr_b16 a[80:81], v38 offset:57344
    v_mfma_f32_16x16x32_bf16 v[140:143], a[92:95], a[108:111], v[140:143]
    s_add_u32 s63, s64, 0x101000
    v_mfma_f32_16x16x32_bf16 v[136:139], a[92:95], a[104:107], v[136:139]
    ds_read_b64_tr_b16 a[82:83], v38 offset:61440
    v_mfma_f32_16x16x32_bf16 v[136:139], a[88:91], v[216:219], v[136:139]
    v_accvgpr_read_b32 v12, a4
    v_mfma_f32_16x16x32_bf16 v[132:135], a[88:91], v[212:215], v[132:135]
    ds_read_b128 a[84:87], v2 offset:12288
    v_mfma_f32_16x16x32_bf16 v[132:135], a[92:95], a[100:103], v[132:135]
    buffer_load_dwordx4 a[176:179], v1, s[4:7], s63 offen offset:0 sc1
    v_mfma_f32_16x16x32_bf16 v[128:131], a[92:95], a[96:99], v[128:131]
    v_accvgpr_read_b32 v13, a5
    v_mfma_f32_16x16x32_bf16 v[128:131], a[88:91], v[208:211], v[128:131]
    v_accvgpr_read_b32 v14, a6
    s_waitcnt lgkmcnt(6)
    v_mfma_f32_16x16x32_bf16 v[160:163], a[64:67], v[208:211], v[160:163]
    ds_read_b64_tr_b16 a[88:89], v39 offset:57344
    v_mfma_f32_16x16x32_bf16 v[160:163], a[68:71], a[96:99], v[160:163]
    buffer_load_dwordx4 a[180:183], v1, s[4:7], s63 offen offset:1024 sc1
    v_mfma_f32_16x16x32_bf16 v[164:167], a[68:71], a[100:103], v[164:167]
    ds_read_b64_tr_b16 a[90:91], v39 offset:61440
    v_mfma_f32_16x16x32_bf16 v[164:167], a[64:67], v[212:215], v[164:167]
    v_accvgpr_read_b32 v15, a7
    v_mfma_f32_16x16x32_bf16 v[168:171], a[64:67], v[216:219], v[168:171]
L_hop_7:
    s_cbranch_execz L_hop_11
    s_nop 0
    ds_read_b128 a[92:95], v2 offset:14336
    v_mfma_f32_16x16x32_bf16 v[168:171], a[68:71], a[104:107], v[168:171]
    buffer_load_dwordx4 a[184:187], v1, s[4:7], s63 offen offset:2048 sc1
    v_mfma_f32_16x16x32_bf16 v[172:175], a[68:71], a[108:111], v[172:175]
    v_accvgpr_read_b32 v16, a8
    v_mfma_f32_16x16x32_bf16 v[172:175], a[64:67], v[220:223], v[172:175]
    v_accvgpr_read_b32 v17, a9
    s_barrier
    s_waitcnt lgkmcnt(6)
    v_mfma_f32_16x16x32_bf16 v[204:207], a[72:75], v[220:223], v[204:207]
    ds_read_b128 a[64:67], v2 offset:16384
    v_mfma_f32_16x16x32_bf16 v[204:207], a[76:79], a[108:111], v[204:207]
    buffer_load_dwordx4 a[188:191], v1, s[4:7], s63 offen offset:3072 sc1
    v_mfma_f32_16x16x32_bf16 v[200:203], a[76:79], a[104:107], v[200:203]
    ds_read_b64_tr_b16 a[68:69], v32 offset:8192
    v_mfma_f32_16x16x32_bf16 v[200:203], a[72:75], v[216:219], v[200:203]
    v_accvgpr_read_b32 v18, a10
    v_mfma_f32_16x16x32_bf16 v[196:199], a[72:75], v[212:215], v[196:199]
    ds_read_b64_tr_b16 a[70:71], v32 offset:12288
    v_mfma_f32_16x16x32_bf16 v[196:199], a[76:79], a[100:103], v[196:199]
    s_add_u32 s63, s64, 0x102000
    v_mfma_f32_16x16x32_bf16 v[192:195], a[76:79], a[96:99], v[192:195]
    v_accvgpr_read_b32 v19, a11
    v_mfma_f32_16x16x32_bf16 v[192:195], a[72:75], v[208:211], v[192:195]
    s_waitcnt lgkmcnt(6)
    v_mfma_f32_16x16x32_bf16 v[224:227], a[80:83], v[208:211], v[224:227]
    ds_read_b128 a[72:75], v2 offset:18432
    v_accvgpr_read_b32 v20, a12
    v_mfma_f32_16x16x32_bf16 v[224:227], a[84:87], a[96:99], v[224:227]
    buffer_load_dwordx4 a[192:195], v1, s[4:7], s63 offen offset:0 sc1
    v_mfma_f32_16x16x32_bf16 v[228:231], a[84:87], a[100:103], v[228:231]
    ds_read_b64_tr_b16 a[76:77], v33 offset:8192
    v_mfma_f32_16x16x32_bf16 v[228:231], a[80:83], v[212:215], v[228:231]
    buffer_load_dwordx4 a[196:199], v1, s[4:7], s63 offen offset:1024 sc1
    v_mfma_f32_16x16x32_bf16 v[232:235], a[80:83], v[216:219], v[232:235]
    ds_read_b64_tr_b16 a[78:79], v33 offset:12288
    v_mfma_f32_16x16x32_bf16 v[232:235], a[84:87], a[104:107], v[232:235]
    v_accvgpr_read_b32 v21, a13
    v_mfma_f32_16x16x32_bf16 v[236:239], a[84:87], a[108:111], v[236:239]
    v_accvgpr_read_b32 v22, a14
    v_mfma_f32_16x16x32_bf16 v[236:239], a[80:83], v[220:223], v[236:239]
    s_waitcnt lgkmcnt(6)
    v_mfma_f32_16x16x32_bf16 v[252:255], a[88:91], v[220:223], v[252:255]
    ds_read_b128 a[80:83], v2 offset:20480
    v_mfma_f32_16x16x32_bf16 v[252:255], a[92:95], a[108:111], v[252:255]
    buffer_load_dwordx4 a[200:203], v1, s[4:7], s63 offen offset:2048 sc1
    v_accvgpr_read_b32 v23, a15
    v_mfma_f32_16x16x32_bf16 v[248:251], a[92:95], a[104:107], v[248:251]
    ds_read_b64_tr_b16 a[84:85], v34 offset:8192
    v_mfma_f32_16x16x32_bf16 v[248:251], a[88:91], v[216:219], v[248:251]
    buffer_load_dwordx4 a[204:207], v1, s[4:7], s63 offen offset:3072 sc1
    v_mfma_f32_16x16x32_bf16 v[244:247], a[88:91], v[212:215], v[244:247]
    ds_read_b64_tr_b16 a[86:87], v34 offset:12288
    v_mfma_f32_16x16x32_bf16 v[244:247], a[92:95], a[100:103], v[244:247]
    v_mfma_f32_16x16x32_bf16 v[240:243], a[92:95], a[96:99], v[240:243]
    v_mfma_f32_16x16x32_bf16 v[240:243], a[88:91], v[208:211], v[240:243]
    s_waitcnt vmcnt(8)
    s_waitcnt lgkmcnt(6)
    v_mfma_f32_16x16x32_bf16 v[80:83], a[64:67], a[112:115], v[80:83]
    ds_read_b128 a[88:91], v2 offset:22528
    v_mfma_f32_16x16x32_bf16 v[80:83], a[68:71], a[160:163], v[80:83]
    v_mfma_f32_16x16x32_bf16 v[84:87], a[68:71], a[164:167], v[84:87]
    ds_read_b64_tr_b16 a[92:93], v35 offset:8192
    v_mfma_f32_16x16x32_bf16 v[84:87], a[64:67], a[116:119], v[84:87]
    s_add_u32 s1, s87, 0x100000
    v_mfma_f32_16x16x32_bf16 v[88:91], a[64:67], a[120:123], v[88:91]
    ds_read_b64_tr_b16 a[94:95], v35 offset:12288
    buffer_store_dwordx4 a[96:99], v1, s[4:7], s1 offen offset:0 sc1
    v_mfma_f32_16x16x32_bf16 v[88:91], a[68:71], a[168:171], v[88:91]
    s_add_u32 s63, s65, 0x100000
    v_mfma_f32_16x16x32_bf16 v[92:95], a[68:71], a[172:175], v[92:95]
    v_mfma_f32_16x16x32_bf16 v[92:95], a[64:67], a[124:127], v[92:95]
    s_waitcnt lgkmcnt(6)
    v_mfma_f32_16x16x32_bf16 v[108:111], a[72:75], a[124:127], v[108:111]
    ds_read_b128 a[64:67], v2 offset:24576
    v_mfma_f32_16x16x32_bf16 v[108:111], a[76:79], a[172:175], v[108:111]
    buffer_load_dwordx4 a[208:211], v1, s[4:7], s63 offen offset:0 sc1
    v_mfma_f32_16x16x32_bf16 v[104:107], a[76:79], a[168:171], v[104:107]
    ds_read_b64_tr_b16 a[68:69], v36 offset:8192
    v_mfma_f32_16x16x32_bf16 v[104:107], a[72:75], a[120:123], v[104:107]
    v_mfma_f32_16x16x32_bf16 v[100:103], a[72:75], a[116:119], v[100:103]
    ds_read_b64_tr_b16 a[70:71], v36 offset:12288
    v_mfma_f32_16x16x32_bf16 v[100:103], a[76:79], a[164:167], v[100:103]
    buffer_load_dwordx4 a[212:215], v1, s[4:7], s63 offen offset:1024 sc1
    v_mfma_f32_16x16x32_bf16 v[96:99], a[76:79], a[160:163], v[96:99]
    v_mfma_f32_16x16x32_bf16 v[96:99], a[72:75], a[112:115], v[96:99]
    s_waitcnt lgkmcnt(6)
    v_mfma_f32_16x16x32_bf16 v[112:115], a[80:83], a[112:115], v[112:115]
    ds_read_b128 a[72:75], v2 offset:26624
    v_mfma_f32_16x16x32_bf16 v[112:115], a[84:87], a[160:163], v[112:115]
    buffer_load_dwordx4 a[216:219], v1, s[4:7], s63 offen offset:2048 sc1
    v_mfma_f32_16x16x32_bf16 v[116:119], a[84:87], a[164:167], v[116:119]
    ds_read_b64_tr_b16 a[76:77], v37 offset:8192
    v_mfma_f32_16x16x32_bf16 v[116:119], a[80:83], a[116:119], v[116:119]
    v_mfma_f32_16x16x32_bf16 v[120:123], a[80:83], a[120:123], v[120:123]
    ds_read_b64_tr_b16 a[78:79], v37 offset:12288
    v_mfma_f32_16x16x32_bf16 v[120:123], a[84:87], a[168:171], v[120:123]
    buffer_load_dwordx4 a[220:223], v1, s[4:7], s63 offen offset:3072 sc1
    v_mfma_f32_16x16x32_bf16 v[124:127], a[84:87], a[172:175], v[124:127]
    v_mfma_f32_16x16x32_bf16 v[124:127], a[80:83], a[124:127], v[124:127]
    s_waitcnt lgkmcnt(6)
    v_mfma_f32_16x16x32_bf16 v[140:143], a[88:91], a[124:127], v[140:143]
    ds_read_b128 a[80:83], v2 offset:28672
    v_mfma_f32_16x16x32_bf16 v[140:143], a[92:95], a[172:175], v[140:143]
    v_mfma_f32_16x16x32_bf16 v[136:139], a[92:95], a[168:171], v[136:139]
    ds_read_b64_tr_b16 a[84:85], v38 offset:8192
    v_mfma_f32_16x16x32_bf16 v[136:139], a[88:91], a[120:123], v[136:139]
    buffer_store_dwordx4 a[100:103], v1, s[4:7], s1 offen offset:1024 sc1
    v_mfma_f32_16x16x32_bf16 v[132:135], a[88:91], a[116:119], v[132:135]
    ds_read_b64_tr_b16 a[86:87], v38 offset:12288
    v_mfma_f32_16x16x32_bf16 v[132:135], a[92:95], a[164:167], v[132:135]
    v_mfma_f32_16x16x32_bf16 v[128:131], a[92:95], a[160:163], v[128:131]
    v_mfma_f32_16x16x32_bf16 v[128:131], a[88:91], a[112:115], v[128:131]
    s_waitcnt lgkmcnt(6)
    v_mfma_f32_16x16x32_bf16 v[160:163], a[64:67], a[112:115], v[160:163]
    ds_read_b128 a[88:91], v2 offset:30720
    v_mfma_f32_16x16x32_bf16 v[160:163], a[68:71], a[160:163], v[160:163]
    buffer_store_dwordx4 a[104:107], v1, s[4:7], s1 offen offset:2048 sc1
    v_mfma_f32_16x16x32_bf16 v[164:167], a[68:71], a[164:167], v[164:167]
    ds_read_b64_tr_b16 a[92:93], v39 offset:8192
    v_mfma_f32_16x16x32_bf16 v[164:167], a[64:67], a[116:119], v[164:167]
    v_mfma_f32_16x16x32_bf16 v[168:171], a[64:67], a[120:123], v[168:171]
    ds_read_b64_tr_b16 a[94:95], v39 offset:12288
    v_mfma_f32_16x16x32_bf16 v[168:171], a[68:71], a[168:171], v[168:171]
    s_add_u32 s63, s65, 0x101000
    v_mfma_f32_16x16x32_bf16 v[172:175], a[68:71], a[172:175], v[172:175]
    v_mfma_f32_16x16x32_bf16 v[172:175], a[64:67], a[124:127], v[172:175]
    s_barrier
    s_waitcnt lgkmcnt(6)
    v_mfma_f32_16x16x32_bf16 v[204:207], a[72:75], a[124:127], v[204:207]
    ds_read_b64_tr_b16 a[64:65], v32 offset:16384
    v_mfma_f32_16x16x32_bf16 v[204:207], a[76:79], a[172:175], v[204:207]
    ds_read_b64_tr_b16 a[66:67], v32 offset:20480
    v_mfma_f32_16x16x32_bf16 v[200:203], a[76:79], a[168:171], v[200:203]
    buffer_load_dwordx4 a[32:35], v1, s[4:7], s63 offen offset:0 sc1
    v_mfma_f32_16x16x32_bf16 v[200:203], a[72:75], a[120:123], v[200:203]
    ds_read_b64_tr_b16 a[68:69], v32 offset:24576
    v_mfma_f32_16x16x32_bf16 v[196:199], a[72:75], a[116:119], v[196:199]
    buffer_load_dwordx4 a[36:39], v1, s[4:7], s63 offen offset:1024 sc1
    v_mfma_f32_16x16x32_bf16 v[196:199], a[76:79], a[164:167], v[196:199]
    ds_read_b64_tr_b16 a[70:71], v32 offset:28672
    v_mfma_f32_16x16x32_bf16 v[192:195], a[76:79], a[160:163], v[192:195]
    v_mfma_f32_16x16x32_bf16 v[192:195], a[72:75], a[112:115], v[192:195]
    s_waitcnt lgkmcnt(7)
    v_mfma_f32_16x16x32_bf16 v[224:227], a[80:83], a[112:115], v[224:227]
    ds_read_b64_tr_b16 a[72:73], v33 offset:16384
    v_mfma_f32_16x16x32_bf16 v[224:227], a[84:87], a[160:163], v[224:227]
    ds_read_b64_tr_b16 a[74:75], v33 offset:20480
    v_mfma_f32_16x16x32_bf16 v[228:231], a[84:87], a[164:167], v[228:231]
    buffer_load_dwordx4 a[40:43], v1, s[4:7], s63 offen offset:2048 sc1
    v_mfma_f32_16x16x32_bf16 v[228:231], a[80:83], a[116:119], v[228:231]
    ds_read_b64_tr_b16 a[76:77], v33 offset:24576
    v_mfma_f32_16x16x32_bf16 v[232:235], a[80:83], a[120:123], v[232:235]
    buffer_load_dwordx4 a[44:47], v1, s[4:7], s63 offen offset:3072 sc1
    v_mfma_f32_16x16x32_bf16 v[232:235], a[84:87], a[168:171], v[232:235]
    ds_read_b64_tr_b16 a[78:79], v33 offset:28672
    v_mfma_f32_16x16x32_bf16 v[236:239], a[84:87], a[172:175], v[236:239]
    v_mfma_f32_16x16x32_bf16 v[236:239], a[80:83], a[124:127], v[236:239]
    s_waitcnt lgkmcnt(8)
    v_mfma_f32_16x16x32_bf16 v[252:255], a[88:91], a[124:127], v[252:255]
    ds_read_b64_tr_b16 a[80:81], v34 offset:16384
    v_mfma_f32_16x16x32_bf16 v[252:255], a[92:95], a[172:175], v[252:255]
    ds_read_b64_tr_b16 a[82:83], v34 offset:20480
    v_mfma_f32_16x16x32_bf16 v[248:251], a[92:95], a[168:171], v[248:251]
    v_mfma_f32_16x16x32_bf16 v[248:251], a[88:91], a[120:123], v[248:251]
    ds_read_b64_tr_b16 a[84:85], v34 offset:24576
    v_mfma_f32_16x16x32_bf16 v[244:247], a[88:91], a[116:119], v[244:247]
    buffer_store_dwordx4 a[108:111], v1, s[4:7], s1 offen offset:3072 sc1
    v_mfma_f32_16x16x32_bf16 v[244:247], a[92:95], a[164:167], v[244:247]
    ds_read_b64_tr_b16 a[86:87], v34 offset:28672
    v_mfma_f32_16x16x32_bf16 v[240:243], a[92:95], a[160:163], v[240:243]
    s_add_u32 s62, s72, 0x120000
    v_mfma_f32_16x16x32_bf16 v[240:243], a[88:91], a[112:115], v[240:243]
    s_add_u32 m0, s59, 0x10a000
    s_waitcnt vmcnt(12)
    s_waitcnt lgkmcnt(8)
    v_mfma_f32_16x16x32_bf16 v[80:83], a[64:67], a[176:179], v[80:83]
    ds_read_b64_tr_b16 a[88:89], v35 offset:16384
    v_mfma_f32_16x16x32_bf16 v[80:83], a[68:71], a[192:195], v[80:83]
    ds_read_b64_tr_b16 a[90:91], v35 offset:20480
    v_mfma_f32_16x16x32_bf16 v[84:87], a[68:71], a[196:199], v[84:87]
    buffer_load_dwordx4 v24, s[32:35], s62 offen offset:0  lds
    v_mfma_f32_16x16x32_bf16 v[84:87], a[64:67], a[180:183], v[84:87]
    ds_read_b64_tr_b16 a[92:93], v35 offset:24576
    v_mfma_f32_16x16x32_bf16 v[88:91], a[64:67], a[184:187], v[88:91]
    buffer_load_dwordx4 v25, s[32:35], s62 offen offset:1024  lds
    v_mfma_f32_16x16x32_bf16 v[88:91], a[68:71], a[200:203], v[88:91]
    ds_read_b64_tr_b16 a[94:95], v35 offset:28672
    v_mfma_f32_16x16x32_bf16 v[92:95], a[68:71], a[204:207], v[92:95]
    s_add_u32 s62, s85, 0x130000
    v_mfma_f32_16x16x32_bf16 v[92:95], a[64:67], a[188:191], v[92:95]
    s_waitcnt lgkmcnt(8)
    v_mfma_f32_16x16x32_bf16 v[108:111], a[72:75], a[188:191], v[108:111]
    ds_read_b64_tr_b16 a[64:65], v36 offset:16384
    v_mfma_f32_16x16x32_bf16 v[108:111], a[76:79], a[204:207], v[108:111]
    ds_read_b64_tr_b16 a[66:67], v36 offset:20480
    v_mfma_f32_16x16x32_bf16 v[104:107], a[76:79], a[200:203], v[104:107]
    s_add_u32 m0, s59, 0x10c000
    v_mfma_f32_16x16x32_bf16 v[104:107], a[72:75], a[184:187], v[104:107]
    ds_read_b64_tr_b16 a[68:69], v36 offset:24576
    v_mfma_f32_16x16x32_bf16 v[100:103], a[72:75], a[180:183], v[100:103]
    buffer_load_dwordx4 v26, s[32:35], s62 offen offset:0  lds
    v_mfma_f32_16x16x32_bf16 v[100:103], a[76:79], a[196:199], v[100:103]
    ds_read_b64_tr_b16 a[70:71], v36 offset:28672
    v_mfma_f32_16x16x32_bf16 v[96:99], a[76:79], a[192:195], v[96:99]
    buffer_load_dwordx4 v27, s[32:35], s62 offen offset:1024  lds
    v_mfma_f32_16x16x32_bf16 v[96:99], a[72:75], a[176:179], v[96:99]
    s_waitcnt lgkmcnt(8)
    v_mfma_f32_16x16x32_bf16 v[112:115], a[80:83], a[176:179], v[112:115]
    ds_read_b64_tr_b16 a[72:73], v37 offset:16384
    v_mfma_f32_16x16x32_bf16 v[112:115], a[84:87], a[192:195], v[112:115]
    ds_read_b64_tr_b16 a[74:75], v37 offset:20480
    v_mfma_f32_16x16x32_bf16 v[116:119], a[84:87], a[196:199], v[116:119]
    v_mfma_f32_16x16x32_bf16 v[116:119], a[80:83], a[180:183], v[116:119]
    ds_read_b64_tr_b16 a[76:77], v37 offset:24576
    v_mfma_f32_16x16x32_bf16 v[120:123], a[80:83], a[184:187], v[120:123]
    s_add_u32 s1, s87, 0x102000
    v_mfma_f32_16x16x32_bf16 v[120:123], a[84:87], a[200:203], v[120:123]
    ds_read_b64_tr_b16 a[78:79], v37 offset:28672
    buffer_store_dwordx4 a[112:115], v1, s[4:7], s1 offen offset:0 sc1
    v_mfma_f32_16x16x32_bf16 v[124:127], a[84:87], a[204:207], v[124:127]
    s_add_u32 s63, s65, 0x102000
    v_mfma_f32_16x16x32_bf16 v[124:127], a[80:83], a[188:191], v[124:127]
    s_waitcnt lgkmcnt(8)
    v_mfma_f32_16x16x32_bf16 v[140:143], a[88:91], a[188:191], v[140:143]
    ds_read_b64_tr_b16 a[80:81], v38 offset:16384
    v_mfma_f32_16x16x32_bf16 v[140:143], a[92:95], a[204:207], v[140:143]
    ds_read_b64_tr_b16 a[82:83], v38 offset:20480
    v_mfma_f32_16x16x32_bf16 v[136:139], a[92:95], a[200:203], v[136:139]
    buffer_load_dwordx4 a[48:51], v1, s[4:7], s63 offen offset:0 sc1
    v_mfma_f32_16x16x32_bf16 v[136:139], a[88:91], a[184:187], v[136:139]
    ds_read_b64_tr_b16 a[84:85], v38 offset:24576
    v_mfma_f32_16x16x32_bf16 v[132:135], a[88:91], a[180:183], v[132:135]
    v_mfma_f32_16x16x32_bf16 v[132:135], a[92:95], a[196:199], v[132:135]
    ds_read_b64_tr_b16 a[86:87], v38 offset:28672
    v_mfma_f32_16x16x32_bf16 v[128:131], a[92:95], a[192:195], v[128:131]
    buffer_load_dwordx4 a[52:55], v1, s[4:7], s63 offen offset:1024 sc1
    v_mfma_f32_16x16x32_bf16 v[128:131], a[88:91], a[176:179], v[128:131]
    s_waitcnt lgkmcnt(8)
    v_mfma_f32_16x16x32_bf16 v[160:163], a[64:67], a[176:179], v[160:163]
    ds_read_b64_tr_b16 a[88:89], v39 offset:16384
    v_mfma_f32_16x16x32_bf16 v[160:163], a[68:71], a[192:195], v[160:163]
    ds_read_b64_tr_b16 a[90:91], v39 offset:20480
    v_mfma_f32_16x16x32_bf16 v[164:167], a[68:71], a[196:199], v[164:167]
    buffer_load_dwordx4 a[56:59], v1, s[4:7], s63 offen offset:2048 sc1
    v_mfma_f32_16x16x32_bf16 v[164:167], a[64:67], a[180:183], v[164:167]
    ds_read_b64_tr_b16 a[92:93], v39 offset:24576
    v_mfma_f32_16x16x32_bf16 v[168:171], a[64:67], a[184:187], v[168:171]
    v_mfma_f32_16x16x32_bf16 v[168:171], a[68:71], a[200:203], v[168:171]
    ds_read_b64_tr_b16 a[94:95], v39 offset:28672
    v_mfma_f32_16x16x32_bf16 v[172:175], a[68:71], a[204:207], v[172:175]
    buffer_load_dwordx4 a[60:63], v1, s[4:7], s63 offen offset:3072 sc1
    v_mfma_f32_16x16x32_bf16 v[172:175], a[64:67], a[188:191], v[172:175]
    s_barrier
    s_waitcnt lgkmcnt(8)
    v_mfma_f32_16x16x32_bf16 v[204:207], a[72:75], a[188:191], v[204:207]
    ds_read_b64_tr_b16 a[64:65], v32 offset:32768
    v_mfma_f32_16x16x32_bf16 v[204:207], a[76:79], a[204:207], v[204:207]
    ds_read_b64_tr_b16 a[66:67], v32 offset:36864
    v_mfma_f32_16x16x32_bf16 v[200:203], a[76:79], a[200:203], v[200:203]
    v_mfma_f32_16x16x32_bf16 v[200:203], a[72:75], a[184:187], v[200:203]
    ds_read_b64_tr_b16 a[68:69], v32 offset:0
    v_mfma_f32_16x16x32_bf16 v[196:199], a[72:75], a[180:183], v[196:199]
    buffer_store_dwordx4 a[116:119], v1, s[4:7], s1 offen offset:1024 sc1
    v_mfma_f32_16x16x32_bf16 v[196:199], a[76:79], a[196:199], v[196:199]
    ds_read_b64_tr_b16 a[70:71], v32 offset:4096
    v_mfma_f32_16x16x32_bf16 v[192:195], a[76:79], a[192:195], v[192:195]
    v_mfma_f32_16x16x32_bf16 v[192:195], a[72:75], a[176:179], v[192:195]
    s_waitcnt lgkmcnt(8)
    v_mfma_f32_16x16x32_bf16 v[224:227], a[80:83], a[176:179], v[224:227]
    ds_read_b64_tr_b16 a[72:73], v33 offset:32768
    v_mfma_f32_16x16x32_bf16 v[224:227], a[84:87], a[192:195], v[224:227]
    ds_read_b64_tr_b16 a[74:75], v33 offset:36864
    v_mfma_f32_16x16x32_bf16 v[228:231], a[84:87], a[196:199], v[228:231]
    s_add_u32 s63, s84, 0x103000
    v_mfma_f32_16x16x32_bf16 v[228:231], a[80:83], a[180:183], v[228:231]
    ds_read_b64_tr_b16 a[76:77], v33 offset:0
    v_mfma_f32_16x16x32_bf16 v[232:235], a[80:83], a[184:187], v[232:235]
    buffer_load_dwordx4 a[128:131], v1, s[4:7], s63 offen offset:0 sc1
    v_mfma_f32_16x16x32_bf16 v[232:235], a[84:87], a[200:203], v[232:235]
    ds_read_b64_tr_b16 a[78:79], v33 offset:4096
    v_mfma_f32_16x16x32_bf16 v[236:239], a[84:87], a[204:207], v[236:239]
    buffer_load_dwordx4 a[132:135], v1, s[4:7], s63 offen offset:1024 sc1
    v_mfma_f32_16x16x32_bf16 v[236:239], a[80:83], a[188:191], v[236:239]
    s_waitcnt lgkmcnt(8)
    v_mfma_f32_16x16x32_bf16 v[252:255], a[88:91], a[188:191], v[252:255]
    ds_read_b64_tr_b16 a[80:81], v34 offset:32768
    v_mfma_f32_16x16x32_bf16 v[252:255], a[92:95], a[204:207], v[252:255]
    ds_read_b64_tr_b16 a[82:83], v34 offset:36864
    v_mfma_f32_16x16x32_bf16 v[248:251], a[92:95], a[200:203], v[248:251]
    buffer_load_dwordx4 a[136:139], v1, s[4:7], s63 offen offset:2048 sc1
    v_mfma_f32_16x16x32_bf16 v[248:251], a[88:91], a[184:187], v[248:251]
    ds_read_b64_tr_b16 a[84:85], v34 offset:0
    v_mfma_f32_16x16x32_bf16 v[244:247], a[88:91], a[180:183], v[244:247]
    v_mfma_f32_16x16x32_bf16 v[244:247], a[92:95], a[196:199], v[244:247]
    ds_read_b64_tr_b16 a[86:87], v34 offset:4096
    v_mfma_f32_16x16x32_bf16 v[240:243], a[92:95], a[192:195], v[240:243]
    buffer_load_dwordx4 a[140:143], v1, s[4:7], s63 offen offset:3072 sc1
    v_mfma_f32_16x16x32_bf16 v[240:243], a[88:91], a[176:179], v[240:243]
    s_waitcnt vmcnt(15)
    s_waitcnt lgkmcnt(8)
    v_mfma_f32_16x16x32_bf16 v[80:83], a[64:67], a[208:211], v[80:83]
    ds_read_b64_tr_b16 a[88:89], v35 offset:32768
    v_mfma_f32_16x16x32_bf16 v[80:83], a[68:71], a[32:35], v[80:83]
    ds_read_b64_tr_b16 a[90:91], v35 offset:36864
    v_mfma_f32_16x16x32_bf16 v[84:87], a[68:71], a[36:39], v[84:87]
    v_mfma_f32_16x16x32_bf16 v[84:87], a[64:67], a[212:215], v[84:87]
    ds_read_b64_tr_b16 a[92:93], v35 offset:0
    v_mfma_f32_16x16x32_bf16 v[88:91], a[64:67], a[216:219], v[88:91]
    v_mfma_f32_16x16x32_bf16 v[88:91], a[68:71], a[40:43], v[88:91]
    ds_read_b64_tr_b16 a[94:95], v35 offset:4096
    v_mfma_f32_16x16x32_bf16 v[92:95], a[68:71], a[44:47], v[92:95]
    buffer_store_dwordx4 a[120:123], v1, s[4:7], s1 offen offset:2048 sc1
    v_mfma_f32_16x16x32_bf16 v[92:95], a[64:67], a[220:223], v[92:95]
    s_waitcnt lgkmcnt(8)
    v_mfma_f32_16x16x32_bf16 v[108:111], a[72:75], a[220:223], v[108:111]
    ds_read_b64_tr_b16 a[64:65], v36 offset:32768
    v_mfma_f32_16x16x32_bf16 v[108:111], a[76:79], a[44:47], v[108:111]
    ds_read_b64_tr_b16 a[66:67], v36 offset:36864
    v_mfma_f32_16x16x32_bf16 v[104:107], a[76:79], a[40:43], v[104:107]
    s_add_u32 s62, s73, 0x100000
    v_mfma_f32_16x16x32_bf16 v[104:107], a[72:75], a[216:219], v[104:107]
    ds_read_b64_tr_b16 a[68:69], v36 offset:0
    v_mfma_f32_16x16x32_bf16 v[100:103], a[72:75], a[212:215], v[100:103]
    s_add_u32 m0, s59, 0x10e000
    v_mfma_f32_16x16x32_bf16 v[100:103], a[76:79], a[36:39], v[100:103]
    ds_read_b64_tr_b16 a[70:71], v36 offset:4096
    v_mfma_f32_16x16x32_bf16 v[96:99], a[76:79], a[32:35], v[96:99]
    buffer_load_dwordx4 v24, s[32:35], s62 offen offset:0  lds
    v_mfma_f32_16x16x32_bf16 v[96:99], a[72:75], a[208:211], v[96:99]
    buffer_load_dwordx4 v25, s[32:35], s62 offen offset:1024  lds
    s_waitcnt lgkmcnt(8)
    v_mfma_f32_16x16x32_bf16 v[112:115], a[80:83], a[208:211], v[112:115]
    ds_read_b64_tr_b16 a[72:73], v37 offset:32768
    v_mfma_f32_16x16x32_bf16 v[112:115], a[84:87], a[32:35], v[112:115]
    ds_read_b64_tr_b16 a[74:75], v37 offset:36864
    v_mfma_f32_16x16x32_bf16 v[116:119], a[84:87], a[36:39], v[116:119]
    s_add_u32 s62, s73, 0x110000
    v_mfma_f32_16x16x32_bf16 v[116:119], a[80:83], a[212:215], v[116:119]
    ds_read_b64_tr_b16 a[76:77], v37 offset:0
    v_mfma_f32_16x16x32_bf16 v[120:123], a[80:83], a[216:219], v[120:123]
    s_add_u32 m0, s59, 0x102000
    v_mfma_f32_16x16x32_bf16 v[120:123], a[84:87], a[40:43], v[120:123]
    ds_read_b64_tr_b16 a[78:79], v37 offset:4096
    v_mfma_f32_16x16x32_bf16 v[124:127], a[84:87], a[44:47], v[124:127]
    buffer_load_dwordx4 v24, s[32:35], s62 offen offset:0  lds
    v_mfma_f32_16x16x32_bf16 v[124:127], a[80:83], a[220:223], v[124:127]
    s_waitcnt lgkmcnt(8)
    v_mfma_f32_16x16x32_bf16 v[140:143], a[88:91], a[220:223], v[140:143]
    ds_read_b64_tr_b16 a[80:81], v38 offset:32768
    v_mfma_f32_16x16x32_bf16 v[140:143], a[92:95], a[44:47], v[140:143]
    ds_read_b64_tr_b16 a[82:83], v38 offset:36864
    v_mfma_f32_16x16x32_bf16 v[136:139], a[92:95], a[40:43], v[136:139]
    buffer_load_dwordx4 v25, s[32:35], s62 offen offset:1024  lds
    v_mfma_f32_16x16x32_bf16 v[136:139], a[88:91], a[216:219], v[136:139]
    ds_read_b64_tr_b16 a[84:85], v38 offset:0
    v_mfma_f32_16x16x32_bf16 v[132:135], a[88:91], a[212:215], v[132:135]
    v_mfma_f32_16x16x32_bf16 v[132:135], a[92:95], a[36:39], v[132:135]
    ds_read_b64_tr_b16 a[86:87], v38 offset:4096
    v_mfma_f32_16x16x32_bf16 v[128:131], a[92:95], a[32:35], v[128:131]
    buffer_store_dwordx4 a[124:127], v1, s[4:7], s1 offen offset:3072 sc1
    v_mfma_f32_16x16x32_bf16 v[128:131], a[88:91], a[208:211], v[128:131]
    s_waitcnt lgkmcnt(8)
    v_mfma_f32_16x16x32_bf16 v[160:163], a[64:67], a[208:211], v[160:163]
    ds_read_b64_tr_b16 a[88:89], v39 offset:32768
    v_mfma_f32_16x16x32_bf16 v[160:163], a[68:71], a[32:35], v[160:163]
    ds_read_b64_tr_b16 a[90:91], v39 offset:36864
    v_mfma_f32_16x16x32_bf16 v[164:167], a[68:71], a[36:39], v[164:167]
    s_add_u32 s63, s66, 0x100000
    v_mfma_f32_16x16x32_bf16 v[164:167], a[64:67], a[212:215], v[164:167]
    ds_read_b64_tr_b16 a[92:93], v39 offset:0
    v_mfma_f32_16x16x32_bf16 v[168:171], a[64:67], a[216:219], v[168:171]
    buffer_load_dwordx4 a[144:147], v1, s[4:7], s63 offen offset:0 sc1
    v_mfma_f32_16x16x32_bf16 v[168:171], a[68:71], a[40:43], v[168:171]
    ds_read_b64_tr_b16 a[94:95], v39 offset:4096
    v_mfma_f32_16x16x32_bf16 v[172:175], a[68:71], a[44:47], v[172:175]
    v_mfma_f32_16x16x32_bf16 v[172:175], a[64:67], a[220:223], v[172:175]
    s_waitcnt vmcnt(17)
    s_barrier
    s_waitcnt lgkmcnt(8)
    v_mfma_f32_16x16x32_bf16 v[204:207], a[72:75], a[220:223], v[204:207]
    ds_read_b64_tr_b16 a[64:65], v32 offset:40960
    v_mfma_f32_16x16x32_bf16 v[204:207], a[76:79], a[44:47], v[204:207]
    ds_read_b64_tr_b16 a[66:67], v32 offset:45056
    v_mfma_f32_16x16x32_bf16 v[200:203], a[76:79], a[40:43], v[200:203]
    buffer_load_dwordx4 a[148:151], v1, s[4:7], s63 offen offset:1024 sc1
    v_mfma_f32_16x16x32_bf16 v[200:203], a[72:75], a[216:219], v[200:203]
    ds_read_b64_tr_b16 a[68:69], v32 offset:49152
    v_mfma_f32_16x16x32_bf16 v[196:199], a[72:75], a[212:215], v[196:199]
    buffer_load_dwordx4 a[152:155], v1, s[4:7], s63 offen offset:2048 sc1
    v_mfma_f32_16x16x32_bf16 v[196:199], a[76:79], a[36:39], v[196:199]
    ds_read_b64_tr_b16 a[70:71], v32 offset:53248
    v_mfma_f32_16x16x32_bf16 v[192:195], a[76:79], a[32:35], v[192:195]
    v_mfma_f32_16x16x32_bf16 v[192:195], a[72:75], a[208:211], v[192:195]
    s_waitcnt lgkmcnt(8)
    v_mfma_f32_16x16x32_bf16 v[224:227], a[80:83], a[208:211], v[224:227]
    ds_read_b64_tr_b16 a[72:73], v33 offset:40960
    v_mfma_f32_16x16x32_bf16 v[224:227], a[84:87], a[32:35], v[224:227]
    ds_read_b64_tr_b16 a[74:75], v33 offset:45056
    v_mfma_f32_16x16x32_bf16 v[228:231], a[84:87], a[36:39], v[228:231]
    buffer_load_dwordx4 a[156:159], v1, s[4:7], s63 offen offset:3072 sc1
    v_mfma_f32_16x16x32_bf16 v[228:231], a[80:83], a[212:215], v[228:231]
    ds_read_b64_tr_b16 a[76:77], v33 offset:49152
    v_mfma_f32_16x16x32_bf16 v[232:235], a[80:83], a[216:219], v[232:235]
    s_add_u32 s63, s66, 0x101000
    v_mfma_f32_16x16x32_bf16 v[232:235], a[84:87], a[40:43], v[232:235]
    ds_read_b64_tr_b16 a[78:79], v33 offset:53248
    v_mfma_f32_16x16x32_bf16 v[236:239], a[84:87], a[44:47], v[236:239]
    v_mfma_f32_16x16x32_bf16 v[236:239], a[80:83], a[220:223], v[236:239]
    s_waitcnt lgkmcnt(8)
    v_mfma_f32_16x16x32_bf16 v[252:255], a[88:91], a[220:223], v[252:255]
    ds_read_b64_tr_b16 a[80:81], v34 offset:40960
    v_mfma_f32_16x16x32_bf16 v[252:255], a[92:95], a[44:47], v[252:255]
    ds_read_b64_tr_b16 a[82:83], v34 offset:45056
    v_mfma_f32_16x16x32_bf16 v[248:251], a[92:95], a[40:43], v[248:251]
    buffer_load_dwordx4 a[0:3], v1, s[4:7], s63 offen offset:0 sc1
    v_mfma_f32_16x16x32_bf16 v[248:251], a[88:91], a[216:219], v[248:251]
    ds_read_b64_tr_b16 a[84:85], v34 offset:49152
    v_mfma_f32_16x16x32_bf16 v[244:247], a[88:91], a[212:215], v[244:247]
    buffer_load_dwordx4 a[4:7], v1, s[4:7], s63 offen offset:1024 sc1
    v_mfma_f32_16x16x32_bf16 v[244:247], a[92:95], a[36:39], v[244:247]
    ds_read_b64_tr_b16 a[86:87], v34 offset:53248
    v_mfma_f32_16x16x32_bf16 v[240:243], a[92:95], a[32:35], v[240:243]
    v_mfma_f32_16x16x32_bf16 v[240:243], a[88:91], a[208:211], v[240:243]
    s_waitcnt vmcnt(12)
    s_waitcnt lgkmcnt(8)
    v_mfma_f32_16x16x32_bf16 v[80:83], a[64:67], a[48:51], v[80:83]
    ds_read_b64_tr_b16 a[88:89], v35 offset:40960
    v_mfma_f32_16x16x32_bf16 v[80:83], a[68:71], a[128:131], v[80:83]
    ds_read_b64_tr_b16 a[90:91], v35 offset:45056
    v_mfma_f32_16x16x32_bf16 v[84:87], a[68:71], a[132:135], v[84:87]
    buffer_load_dwordx4 a[8:11], v1, s[4:7], s63 offen offset:2048 sc1
    v_mfma_f32_16x16x32_bf16 v[84:87], a[64:67], a[52:55], v[84:87]
    ds_read_b64_tr_b16 a[92:93], v35 offset:49152
    v_mfma_f32_16x16x32_bf16 v[88:91], a[64:67], a[56:59], v[88:91]
    buffer_load_dwordx4 a[12:15], v1, s[4:7], s63 offen offset:3072 sc1
    v_mfma_f32_16x16x32_bf16 v[88:91], a[68:71], a[136:139], v[88:91]
    ds_read_b64_tr_b16 a[94:95], v35 offset:53248
    v_mfma_f32_16x16x32_bf16 v[92:95], a[68:71], a[140:143], v[92:95]
    v_mfma_f32_16x16x32_bf16 v[92:95], a[64:67], a[60:63], v[92:95]
    s_add_u32 s62, s73, 0x120000
    s_waitcnt lgkmcnt(8)
    v_mfma_f32_16x16x32_bf16 v[108:111], a[72:75], a[60:63], v[108:111]
    ds_read_b64_tr_b16 a[64:65], v36 offset:40960
    v_mfma_f32_16x16x32_bf16 v[108:111], a[76:79], a[140:143], v[108:111]
    ds_read_b64_tr_b16 a[66:67], v36 offset:45056
    v_mfma_f32_16x16x32_bf16 v[104:107], a[76:79], a[136:139], v[104:107]
    s_add_u32 m0, s59, 0x104000
    v_mfma_f32_16x16x32_bf16 v[104:107], a[72:75], a[56:59], v[104:107]
    ds_read_b64_tr_b16 a[68:69], v36 offset:49152
    v_mfma_f32_16x16x32_bf16 v[100:103], a[72:75], a[52:55], v[100:103]
    buffer_load_dwordx4 v24, s[32:35], s62 offen offset:0  lds
    v_mfma_f32_16x16x32_bf16 v[100:103], a[76:79], a[132:135], v[100:103]
    ds_read_b64_tr_b16 a[70:71], v36 offset:53248
    v_mfma_f32_16x16x32_bf16 v[96:99], a[76:79], a[128:131], v[96:99]
    buffer_load_dwordx4 v25, s[32:35], s62 offen offset:1024  lds
    v_mfma_f32_16x16x32_bf16 v[96:99], a[72:75], a[48:51], v[96:99]
    s_waitcnt lgkmcnt(8)
    v_mfma_f32_16x16x32_bf16 v[112:115], a[80:83], a[48:51], v[112:115]
    ds_read_b64_tr_b16 a[72:73], v37 offset:40960
    v_mfma_f32_16x16x32_bf16 v[112:115], a[84:87], a[128:131], v[112:115]
    ds_read_b64_tr_b16 a[74:75], v37 offset:45056
    v_mfma_f32_16x16x32_bf16 v[116:119], a[84:87], a[132:135], v[116:119]
    s_add_u32 s62, s74, 0x100000
    v_mfma_f32_16x16x32_bf16 v[116:119], a[80:83], a[52:55], v[116:119]
    ds_read_b64_tr_b16 a[76:77], v37 offset:49152
    v_mfma_f32_16x16x32_bf16 v[120:123], a[80:83], a[56:59], v[120:123]
    s_add_u32 m0, s59, 0x106000
    v_mfma_f32_16x16x32_bf16 v[120:123], a[84:87], a[136:139], v[120:123]
    ds_read_b64_tr_b16 a[78:79], v37 offset:53248
    v_mfma_f32_16x16x32_bf16 v[124:127], a[84:87], a[140:143], v[124:127]
    buffer_load_dwordx4 v24, s[32:35], s62 offen offset:0  lds
    v_mfma_f32_16x16x32_bf16 v[124:127], a[80:83], a[60:63], v[124:127]
    buffer_load_dwordx4 v25, s[32:35], s62 offen offset:1024  lds
    s_waitcnt lgkmcnt(8)
    v_mfma_f32_16x16x32_bf16 v[140:143], a[88:91], a[60:63], v[140:143]
    ds_read_b64_tr_b16 a[80:81], v38 offset:40960
    v_mfma_f32_16x16x32_bf16 v[140:143], a[92:95], a[140:143], v[140:143]
    ds_read_b64_tr_b16 a[82:83], v38 offset:45056
    v_mfma_f32_16x16x32_bf16 v[136:139], a[92:95], a[136:139], v[136:139]
    s_add_u32 s63, s66, 0x102000
    v_mfma_f32_16x16x32_bf16 v[136:139], a[88:91], a[56:59], v[136:139]
    ds_read_b64_tr_b16 a[84:85], v38 offset:49152
    v_mfma_f32_16x16x32_bf16 v[132:135], a[88:91], a[52:55], v[132:135]
    v_mfma_f32_16x16x32_bf16 v[132:135], a[92:95], a[132:135], v[132:135]
    ds_read_b64_tr_b16 a[86:87], v38 offset:53248
    v_mfma_f32_16x16x32_bf16 v[128:131], a[92:95], a[128:131], v[128:131]
    buffer_load_dwordx4 a[16:19], v1, s[4:7], s63 offen offset:0 sc1
    v_mfma_f32_16x16x32_bf16 v[128:131], a[88:91], a[48:51], v[128:131]
    s_waitcnt lgkmcnt(8)
    v_mfma_f32_16x16x32_bf16 v[160:163], a[64:67], a[48:51], v[160:163]
    ds_read_b64_tr_b16 a[88:89], v39 offset:40960
    v_mfma_f32_16x16x32_bf16 v[160:163], a[68:71], a[128:131], v[160:163]
    ds_read_b64_tr_b16 a[90:91], v39 offset:45056
    v_mfma_f32_16x16x32_bf16 v[164:167], a[68:71], a[132:135], v[164:167]
    buffer_load_dwordx4 a[20:23], v1, s[4:7], s63 offen offset:1024 sc1
    v_mfma_f32_16x16x32_bf16 v[164:167], a[64:67], a[52:55], v[164:167]
    ds_read_b64_tr_b16 a[92:93], v39 offset:49152
    v_mfma_f32_16x16x32_bf16 v[168:171], a[64:67], a[56:59], v[168:171]
    v_mfma_f32_16x16x32_bf16 v[168:171], a[68:71], a[136:139], v[168:171]
    ds_read_b64_tr_b16 a[94:95], v39 offset:53248
    v_mfma_f32_16x16x32_bf16 v[172:175], a[68:71], a[140:143], v[172:175]
    buffer_load_dwordx4 a[24:27], v1, s[4:7], s63 offen offset:2048 sc1
    v_mfma_f32_16x16x32_bf16 v[172:175], a[64:67], a[60:63], v[172:175]
    s_waitcnt vmcnt(16)
    s_barrier
    s_waitcnt lgkmcnt(8)
    v_mfma_f32_16x16x32_bf16 v[204:207], a[72:75], a[60:63], v[204:207]
    ds_read_b64_tr_b16 a[64:65], v32 offset:57344
    v_mfma_f32_16x16x32_bf16 v[204:207], a[76:79], a[140:143], v[204:207]
    ds_read_b64_tr_b16 a[66:67], v32 offset:61440
    v_mfma_f32_16x16x32_bf16 v[200:203], a[76:79], a[136:139], v[200:203]
    buffer_load_dwordx4 a[28:31], v1, s[4:7], s63 offen offset:3072 sc1
    v_mfma_f32_16x16x32_bf16 v[200:203], a[72:75], a[56:59], v[200:203]
    ds_read_b64_tr_b16 a[68:69], v32 offset:8192
    v_mfma_f32_16x16x32_bf16 v[196:199], a[72:75], a[52:55], v[196:199]
    v_mfma_f32_16x16x32_bf16 v[196:199], a[76:79], a[132:135], v[196:199]
    ds_read_b64_tr_b16 a[70:71], v32 offset:12288
    v_mfma_f32_16x16x32_bf16 v[192:195], a[76:79], a[128:131], v[192:195]
    s_add_u32 s63, s67, 0x100000
    v_mfma_f32_16x16x32_bf16 v[192:195], a[72:75], a[48:51], v[192:195]
    s_waitcnt lgkmcnt(8)
    v_mfma_f32_16x16x32_bf16 v[224:227], a[80:83], a[48:51], v[224:227]
    ds_read_b64_tr_b16 a[72:73], v33 offset:57344
    v_mfma_f32_16x16x32_bf16 v[224:227], a[84:87], a[128:131], v[224:227]
    ds_read_b64_tr_b16 a[74:75], v33 offset:61440
    v_mfma_f32_16x16x32_bf16 v[228:231], a[84:87], a[132:135], v[228:231]
    buffer_load_dwordx4 a[160:163], v1, s[4:7], s63 offen offset:0 sc1
    v_mfma_f32_16x16x32_bf16 v[228:231], a[80:83], a[52:55], v[228:231]
    ds_read_b64_tr_b16 a[76:77], v33 offset:8192
    v_mfma_f32_16x16x32_bf16 v[232:235], a[80:83], a[56:59], v[232:235]
    v_mfma_f32_16x16x32_bf16 v[232:235], a[84:87], a[136:139], v[232:235]
    ds_read_b64_tr_b16 a[78:79], v33 offset:12288
    v_mfma_f32_16x16x32_bf16 v[236:239], a[84:87], a[140:143], v[236:239]
L_hop_8:
    s_cbranch_execz L_hop_12
    s_nop 0
    buffer_load_dwordx4 a[164:167], v1, s[4:7], s63 offen offset:1024 sc1
    v_mfma_f32_16x16x32_bf16 v[236:239], a[80:83], a[60:63], v[236:239]
    s_waitcnt lgkmcnt(8)
    v_mfma_f32_16x16x32_bf16 v[252:255], a[88:91], a[60:63], v[252:255]
    ds_read_b64_tr_b16 a[80:81], v34 offset:57344
    v_mfma_f32_16x16x32_bf16 v[252:255], a[92:95], a[140:143], v[252:255]
    ds_read_b64_tr_b16 a[82:83], v34 offset:61440
    v_mfma_f32_16x16x32_bf16 v[248:251], a[92:95], a[136:139], v[248:251]
    buffer_load_dwordx4 a[168:171], v1, s[4:7], s63 offen offset:2048 sc1
    v_mfma_f32_16x16x32_bf16 v[248:251], a[88:91], a[56:59], v[248:251]
    ds_read_b64_tr_b16 a[84:85], v34 offset:8192
    v_mfma_f32_16x16x32_bf16 v[244:247], a[88:91], a[52:55], v[244:247]
    v_mfma_f32_16x16x32_bf16 v[244:247], a[92:95], a[132:135], v[244:247]
    ds_read_b64_tr_b16 a[86:87], v34 offset:12288
    v_mfma_f32_16x16x32_bf16 v[240:243], a[92:95], a[128:131], v[240:243]
    buffer_load_dwordx4 a[172:175], v1, s[4:7], s63 offen offset:3072 sc1
    v_mfma_f32_16x16x32_bf16 v[240:243], a[88:91], a[48:51], v[240:243]
    s_waitcnt vmcnt(12)
    s_waitcnt lgkmcnt(8)
    v_mfma_f32_16x16x32_bf16 v[80:83], a[64:67], a[144:147], v[80:83]
    ds_read_b64_tr_b16 a[88:89], v35 offset:57344
    v_mfma_f32_16x16x32_bf16 v[80:83], a[68:71], a[0:3], v[80:83]
    ds_read_b64_tr_b16 a[90:91], v35 offset:61440
    v_mfma_f32_16x16x32_bf16 v[84:87], a[68:71], a[4:7], v[84:87]
    buffer_store_dword v58, v4, s[4:7], s56 offen offset:32 sc1
    v_mfma_f32_16x16x32_bf16 v[84:87], a[64:67], a[148:151], v[84:87]
    ds_read_b64_tr_b16 a[92:93], v35 offset:8192
    v_mfma_f32_16x16x32_bf16 v[88:91], a[64:67], a[152:155], v[88:91]
    s_add_u32 s62, s74, 0x110000
    v_mfma_f32_16x16x32_bf16 v[88:91], a[68:71], a[8:11], v[88:91]
    ds_read_b64_tr_b16 a[94:95], v35 offset:12288
    v_mfma_f32_16x16x32_bf16 v[92:95], a[68:71], a[12:15], v[92:95]
    s_add_u32 m0, s59, 0x108000
    v_mfma_f32_16x16x32_bf16 v[92:95], a[64:67], a[156:159], v[92:95]
    buffer_load_dwordx4 v24, s[32:35], s62 offen offset:0  lds
    s_waitcnt lgkmcnt(8)
    v_mfma_f32_16x16x32_bf16 v[108:111], a[72:75], a[156:159], v[108:111]
    ds_read_b64_tr_b16 a[64:65], v36 offset:57344
    v_mfma_f32_16x16x32_bf16 v[108:111], a[76:79], a[12:15], v[108:111]
    ds_read_b64_tr_b16 a[66:67], v36 offset:61440
    v_mfma_f32_16x16x32_bf16 v[104:107], a[76:79], a[8:11], v[104:107]
    buffer_load_dwordx4 v25, s[32:35], s62 offen offset:1024  lds
    v_mfma_f32_16x16x32_bf16 v[104:107], a[72:75], a[152:155], v[104:107]
    ds_read_b64_tr_b16 a[68:69], v36 offset:8192
    v_mfma_f32_16x16x32_bf16 v[100:103], a[72:75], a[148:151], v[100:103]
    s_add_u32 s62, s74, 0x120000
    v_mfma_f32_16x16x32_bf16 v[100:103], a[76:79], a[4:7], v[100:103]
    ds_read_b64_tr_b16 a[70:71], v36 offset:12288
    v_mfma_f32_16x16x32_bf16 v[96:99], a[76:79], a[0:3], v[96:99]
    s_add_u32 m0, s59, 0x100000
    v_mfma_f32_16x16x32_bf16 v[96:99], a[72:75], a[144:147], v[96:99]
    s_waitcnt lgkmcnt(8)
    v_mfma_f32_16x16x32_bf16 v[112:115], a[80:83], a[144:147], v[112:115]
    ds_read_b64_tr_b16 a[72:73], v37 offset:57344
    v_mfma_f32_16x16x32_bf16 v[112:115], a[84:87], a[0:3], v[112:115]
    ds_read_b64_tr_b16 a[74:75], v37 offset:61440
    v_mfma_f32_16x16x32_bf16 v[116:119], a[84:87], a[4:7], v[116:119]
    buffer_load_dwordx4 v24, s[32:35], s62 offen offset:0  lds
    v_mfma_f32_16x16x32_bf16 v[116:119], a[80:83], a[148:151], v[116:119]
    ds_read_b64_tr_b16 a[76:77], v37 offset:8192
    v_mfma_f32_16x16x32_bf16 v[120:123], a[80:83], a[152:155], v[120:123]
    buffer_load_dwordx4 v25, s[32:35], s62 offen offset:1024  lds
    v_mfma_f32_16x16x32_bf16 v[120:123], a[84:87], a[8:11], v[120:123]
    ds_read_b64_tr_b16 a[78:79], v37 offset:12288
    v_mfma_f32_16x16x32_bf16 v[124:127], a[84:87], a[12:15], v[124:127]
    s_add_u32 s63, s67, 0x101000
    v_mfma_f32_16x16x32_bf16 v[124:127], a[80:83], a[156:159], v[124:127]
    s_waitcnt lgkmcnt(8)
    v_mfma_f32_16x16x32_bf16 v[140:143], a[88:91], a[156:159], v[140:143]
    ds_read_b64_tr_b16 a[80:81], v38 offset:57344
    v_mfma_f32_16x16x32_bf16 v[140:143], a[92:95], a[12:15], v[140:143]
    ds_read_b64_tr_b16 a[82:83], v38 offset:61440
    v_mfma_f32_16x16x32_bf16 v[136:139], a[92:95], a[8:11], v[136:139]
    buffer_load_dwordx4 a[96:99], v1, s[4:7], s63 offen offset:0 sc1
    v_mfma_f32_16x16x32_bf16 v[136:139], a[88:91], a[152:155], v[136:139]
    ds_read_b64_tr_b16 a[84:85], v38 offset:8192
    v_mfma_f32_16x16x32_bf16 v[132:135], a[88:91], a[148:151], v[132:135]
    v_mfma_f32_16x16x32_bf16 v[132:135], a[92:95], a[4:7], v[132:135]
    ds_read_b64_tr_b16 a[86:87], v38 offset:12288
    v_mfma_f32_16x16x32_bf16 v[128:131], a[92:95], a[0:3], v[128:131]
    buffer_load_dwordx4 a[100:103], v1, s[4:7], s63 offen offset:1024 sc1
    v_mfma_f32_16x16x32_bf16 v[128:131], a[88:91], a[144:147], v[128:131]
    s_waitcnt lgkmcnt(8)
    v_mfma_f32_16x16x32_bf16 v[160:163], a[64:67], a[144:147], v[160:163]
    ds_read_b64_tr_b16 a[88:89], v39 offset:57344
    v_mfma_f32_16x16x32_bf16 v[160:163], a[68:71], a[0:3], v[160:163]
    ds_read_b64_tr_b16 a[90:91], v39 offset:61440
    v_mfma_f32_16x16x32_bf16 v[164:167], a[68:71], a[4:7], v[164:167]
    buffer_load_dwordx4 a[104:107], v1, s[4:7], s63 offen offset:2048 sc1
    v_mfma_f32_16x16x32_bf16 v[164:167], a[64:67], a[148:151], v[164:167]
    ds_read_b64_tr_b16 a[92:93], v39 offset:8192
    v_mfma_f32_16x16x32_bf16 v[168:171], a[64:67], a[152:155], v[168:171]
    v_mfma_f32_16x16x32_bf16 v[168:171], a[68:71], a[8:11], v[168:171]
    ds_read_b64_tr_b16 a[94:95], v39 offset:12288
    v_mfma_f32_16x16x32_bf16 v[172:175], a[68:71], a[12:15], v[172:175]
    buffer_load_dwordx4 a[108:111], v1, s[4:7], s63 offen offset:3072 sc1
    v_mfma_f32_16x16x32_bf16 v[172:175], a[64:67], a[156:159], v[172:175]
    s_waitcnt vmcnt(17)
    s_barrier
    s_waitcnt lgkmcnt(8)
    v_mfma_f32_16x16x32_bf16 v[204:207], a[72:75], a[156:159], v[204:207]
    ds_read_b64_tr_b16 a[64:65], v32 offset:16384
    v_mfma_f32_16x16x32_bf16 v[204:207], a[76:79], a[12:15], v[204:207]
    ds_read_b64_tr_b16 a[66:67], v32 offset:20480
    v_mfma_f32_16x16x32_bf16 v[200:203], a[76:79], a[8:11], v[200:203]
    s_add_u32 s63, s67, 0x102000
    v_mfma_f32_16x16x32_bf16 v[200:203], a[72:75], a[152:155], v[200:203]
    ds_read_b64_tr_b16 a[68:69], v32 offset:24576
    v_mfma_f32_16x16x32_bf16 v[196:199], a[72:75], a[148:151], v[196:199]
    buffer_load_dwordx4 a[176:179], v1, s[4:7], s63 offen offset:0 sc1
    v_mfma_f32_16x16x32_bf16 v[196:199], a[76:79], a[4:7], v[196:199]
    ds_read_b64_tr_b16 a[70:71], v32 offset:28672
    v_mfma_f32_16x16x32_bf16 v[192:195], a[76:79], a[0:3], v[192:195]
    v_mfma_f32_16x16x32_bf16 v[192:195], a[72:75], a[144:147], v[192:195]
    s_waitcnt lgkmcnt(8)
    v_mfma_f32_16x16x32_bf16 v[224:227], a[80:83], a[144:147], v[224:227]
    ds_read_b64_tr_b16 a[72:73], v33 offset:16384
    v_mfma_f32_16x16x32_bf16 v[224:227], a[84:87], a[0:3], v[224:227]
    ds_read_b64_tr_b16 a[74:75], v33 offset:20480
    v_mfma_f32_16x16x32_bf16 v[228:231], a[84:87], a[4:7], v[228:231]
    buffer_load_dwordx4 a[180:183], v1, s[4:7], s63 offen offset:1024 sc1
    v_mfma_f32_16x16x32_bf16 v[228:231], a[80:83], a[148:151], v[228:231]
    ds_read_b64_tr_b16 a[76:77], v33 offset:24576
    v_mfma_f32_16x16x32_bf16 v[232:235], a[80:83], a[152:155], v[232:235]
    buffer_load_dwordx4 a[184:187], v1, s[4:7], s63 offen offset:2048 sc1
    v_mfma_f32_16x16x32_bf16 v[232:235], a[84:87], a[8:11], v[232:235]
    ds_read_b64_tr_b16 a[78:79], v33 offset:28672
    v_mfma_f32_16x16x32_bf16 v[236:239], a[84:87], a[12:15], v[236:239]
    v_mfma_f32_16x16x32_bf16 v[236:239], a[80:83], a[156:159], v[236:239]
    s_waitcnt lgkmcnt(8)
    v_mfma_f32_16x16x32_bf16 v[252:255], a[88:91], a[156:159], v[252:255]
    ds_read_b64_tr_b16 a[80:81], v34 offset:16384
    v_mfma_f32_16x16x32_bf16 v[252:255], a[92:95], a[12:15], v[252:255]
    ds_read_b64_tr_b16 a[82:83], v34 offset:20480
    v_mfma_f32_16x16x32_bf16 v[248:251], a[92:95], a[8:11], v[248:251]
    buffer_load_dwordx4 a[188:191], v1, s[4:7], s63 offen offset:3072 sc1
    v_mfma_f32_16x16x32_bf16 v[248:251], a[88:91], a[152:155], v[248:251]
    ds_read_b64_tr_b16 a[84:85], v34 offset:24576
    v_mfma_f32_16x16x32_bf16 v[244:247], a[88:91], a[148:151], v[244:247]
    s_add_u32 s62, s85, 0x1a0000
    v_mfma_f32_16x16x32_bf16 v[244:247], a[92:95], a[4:7], v[244:247]
    ds_read_b64_tr_b16 a[86:87], v34 offset:28672
    v_mfma_f32_16x16x32_bf16 v[240:243], a[92:95], a[0:3], v[240:243]
    s_add_u32 m0, s59, 0x10a000
    v_mfma_f32_16x16x32_bf16 v[240:243], a[88:91], a[144:147], v[240:243]
    s_waitcnt vmcnt(13)
    s_waitcnt lgkmcnt(8)
    v_mfma_f32_16x16x32_bf16 v[80:83], a[64:67], a[16:19], v[80:83]
    ds_read_b64_tr_b16 a[88:89], v35 offset:16384
    v_mfma_f32_16x16x32_bf16 v[80:83], a[68:71], a[160:163], v[80:83]
    ds_read_b64_tr_b16 a[90:91], v35 offset:20480
    v_mfma_f32_16x16x32_bf16 v[84:87], a[68:71], a[164:167], v[84:87]
    buffer_load_dwordx4 v26, s[32:35], s62 offen offset:0  lds
    v_mfma_f32_16x16x32_bf16 v[84:87], a[64:67], a[20:23], v[84:87]
    ds_read_b64_tr_b16 a[92:93], v35 offset:24576
    v_mfma_f32_16x16x32_bf16 v[88:91], a[64:67], a[24:27], v[88:91]
    buffer_load_dwordx4 v27, s[32:35], s62 offen offset:1024  lds
    v_mfma_f32_16x16x32_bf16 v[88:91], a[68:71], a[168:171], v[88:91]
    ds_read_b64_tr_b16 a[94:95], v35 offset:28672
    v_mfma_f32_16x16x32_bf16 v[92:95], a[68:71], a[172:175], v[92:95]
    s_add_u32 s62, s75, 0x100000
    v_mfma_f32_16x16x32_bf16 v[92:95], a[64:67], a[28:31], v[92:95]
    s_waitcnt lgkmcnt(8)
    v_mfma_f32_16x16x32_bf16 v[108:111], a[72:75], a[28:31], v[108:111]
    ds_read_b64_tr_b16 a[64:65], v36 offset:16384
    v_mfma_f32_16x16x32_bf16 v[108:111], a[76:79], a[172:175], v[108:111]
    ds_read_b64_tr_b16 a[66:67], v36 offset:20480
    v_mfma_f32_16x16x32_bf16 v[104:107], a[76:79], a[168:171], v[104:107]
    s_add_u32 m0, s59, 0x10c000
    v_mfma_f32_16x16x32_bf16 v[104:107], a[72:75], a[24:27], v[104:107]
    ds_read_b64_tr_b16 a[68:69], v36 offset:24576
    v_mfma_f32_16x16x32_bf16 v[100:103], a[72:75], a[20:23], v[100:103]
    buffer_load_dwordx4 v24, s[32:35], s62 offen offset:0  lds
    v_mfma_f32_16x16x32_bf16 v[100:103], a[76:79], a[164:167], v[100:103]
    ds_read_b64_tr_b16 a[70:71], v36 offset:28672
    v_mfma_f32_16x16x32_bf16 v[96:99], a[76:79], a[160:163], v[96:99]
    buffer_load_dwordx4 v25, s[32:35], s62 offen offset:1024  lds
    v_mfma_f32_16x16x32_bf16 v[96:99], a[72:75], a[16:19], v[96:99]
    s_waitcnt lgkmcnt(8)
    v_mfma_f32_16x16x32_bf16 v[112:115], a[80:83], a[16:19], v[112:115]
    ds_read_b64_tr_b16 a[72:73], v37 offset:16384
    v_mfma_f32_16x16x32_bf16 v[112:115], a[84:87], a[160:163], v[112:115]
    ds_read_b64_tr_b16 a[74:75], v37 offset:20480
    v_mfma_f32_16x16x32_bf16 v[116:119], a[84:87], a[164:167], v[116:119]
    s_add_u32 s63, s84, 0x10e000
    v_mfma_f32_16x16x32_bf16 v[116:119], a[80:83], a[20:23], v[116:119]
    ds_read_b64_tr_b16 a[76:77], v37 offset:24576
    v_mfma_f32_16x16x32_bf16 v[120:123], a[80:83], a[24:27], v[120:123]
    buffer_load_dwordx4 a[192:195], v1, s[4:7], s63 offen offset:0 sc1
    v_mfma_f32_16x16x32_bf16 v[120:123], a[84:87], a[168:171], v[120:123]
    ds_read_b64_tr_b16 a[78:79], v37 offset:28672
    v_mfma_f32_16x16x32_bf16 v[124:127], a[84:87], a[172:175], v[124:127]
    buffer_load_dwordx4 a[196:199], v1, s[4:7], s63 offen offset:1024 sc1
    v_mfma_f32_16x16x32_bf16 v[124:127], a[80:83], a[28:31], v[124:127]
    s_waitcnt lgkmcnt(8)
    v_mfma_f32_16x16x32_bf16 v[140:143], a[88:91], a[28:31], v[140:143]
    ds_read_b64_tr_b16 a[80:81], v38 offset:16384
    v_mfma_f32_16x16x32_bf16 v[140:143], a[92:95], a[172:175], v[140:143]
    ds_read_b64_tr_b16 a[82:83], v38 offset:20480
    v_mfma_f32_16x16x32_bf16 v[136:139], a[92:95], a[168:171], v[136:139]
    buffer_load_dwordx4 a[200:203], v1, s[4:7], s63 offen offset:2048 sc1
    v_mfma_f32_16x16x32_bf16 v[136:139], a[88:91], a[24:27], v[136:139]
    ds_read_b64_tr_b16 a[84:85], v38 offset:24576
    v_mfma_f32_16x16x32_bf16 v[132:135], a[88:91], a[20:23], v[132:135]
    v_mfma_f32_16x16x32_bf16 v[132:135], a[92:95], a[164:167], v[132:135]
    ds_read_b64_tr_b16 a[86:87], v38 offset:28672
    v_mfma_f32_16x16x32_bf16 v[128:131], a[92:95], a[160:163], v[128:131]
    buffer_load_dwordx4 a[204:207], v1, s[4:7], s63 offen offset:3072 sc1
    v_mfma_f32_16x16x32_bf16 v[128:131], a[88:91], a[16:19], v[128:131]
    s_waitcnt lgkmcnt(8)
    v_mfma_f32_16x16x32_bf16 v[160:163], a[64:67], a[16:19], v[160:163]
    ds_read_b64_tr_b16 a[88:89], v39 offset:16384
    v_mfma_f32_16x16x32_bf16 v[160:163], a[68:71], a[160:163], v[160:163]
    ds_read_b64_tr_b16 a[90:91], v39 offset:20480
    v_mfma_f32_16x16x32_bf16 v[164:167], a[68:71], a[164:167], v[164:167]
    s_add_u32 s63, s68, 0x100000
    v_mfma_f32_16x16x32_bf16 v[164:167], a[64:67], a[20:23], v[164:167]
    ds_read_b64_tr_b16 a[92:93], v39 offset:24576
    v_mfma_f32_16x16x32_bf16 v[168:171], a[64:67], a[24:27], v[168:171]
    v_mfma_f32_16x16x32_bf16 v[168:171], a[68:71], a[168:171], v[168:171]
    ds_read_b64_tr_b16 a[94:95], v39 offset:28672
    v_mfma_f32_16x16x32_bf16 v[172:175], a[68:71], a[172:175], v[172:175]
    buffer_load_dwordx4 a[208:211], v1, s[4:7], s63 offen offset:0 sc1
    v_mfma_f32_16x16x32_bf16 v[172:175], a[64:67], a[28:31], v[172:175]
    s_waitcnt vmcnt(17)
    s_barrier
    s_waitcnt lgkmcnt(8)
    v_mfma_f32_16x16x32_bf16 v[204:207], a[72:75], a[28:31], v[204:207]
    ds_read_b64_tr_b16 a[64:65], v32 offset:32768
    v_mfma_f32_16x16x32_bf16 v[204:207], a[76:79], a[172:175], v[204:207]
    ds_read_b64_tr_b16 a[66:67], v32 offset:36864
    v_mfma_f32_16x16x32_bf16 v[200:203], a[76:79], a[168:171], v[200:203]
    buffer_load_dwordx4 a[212:215], v1, s[4:7], s63 offen offset:1024 sc1
    v_mfma_f32_16x16x32_bf16 v[200:203], a[72:75], a[24:27], v[200:203]
    ds_read_b64_tr_b16 a[68:69], v32 offset:0
    v_mfma_f32_16x16x32_bf16 v[196:199], a[72:75], a[20:23], v[196:199]
    v_mfma_f32_16x16x32_bf16 v[196:199], a[76:79], a[164:167], v[196:199]
    ds_read_b64_tr_b16 a[70:71], v32 offset:4096
    v_mfma_f32_16x16x32_bf16 v[192:195], a[76:79], a[160:163], v[192:195]
    buffer_load_dwordx4 a[216:219], v1, s[4:7], s63 offen offset:2048 sc1
    v_mfma_f32_16x16x32_bf16 v[192:195], a[72:75], a[16:19], v[192:195]
    s_waitcnt lgkmcnt(8)
    v_mfma_f32_16x16x32_bf16 v[224:227], a[80:83], a[16:19], v[224:227]
    ds_read_b64_tr_b16 a[72:73], v33 offset:32768
    v_mfma_f32_16x16x32_bf16 v[224:227], a[84:87], a[160:163], v[224:227]
    ds_read_b64_tr_b16 a[74:75], v33 offset:36864
    v_mfma_f32_16x16x32_bf16 v[228:231], a[84:87], a[164:167], v[228:231]
    buffer_load_dwordx4 a[220:223], v1, s[4:7], s63 offen offset:3072 sc1
    v_mfma_f32_16x16x32_bf16 v[228:231], a[80:83], a[20:23], v[228:231]
    ds_read_b64_tr_b16 a[76:77], v33 offset:0
    v_mfma_f32_16x16x32_bf16 v[232:235], a[80:83], a[24:27], v[232:235]
    v_mfma_f32_16x16x32_bf16 v[232:235], a[84:87], a[168:171], v[232:235]
    ds_read_b64_tr_b16 a[78:79], v33 offset:4096
    v_mfma_f32_16x16x32_bf16 v[236:239], a[84:87], a[172:175], v[236:239]
    s_add_u32 s62, s75, 0x110000
    v_mfma_f32_16x16x32_bf16 v[236:239], a[80:83], a[28:31], v[236:239]
    s_waitcnt lgkmcnt(8)
    v_mfma_f32_16x16x32_bf16 v[252:255], a[88:91], a[28:31], v[252:255]
    ds_read_b64_tr_b16 a[80:81], v34 offset:32768
    v_mfma_f32_16x16x32_bf16 v[252:255], a[92:95], a[172:175], v[252:255]
    ds_read_b64_tr_b16 a[82:83], v34 offset:36864
    v_mfma_f32_16x16x32_bf16 v[248:251], a[92:95], a[168:171], v[248:251]
    s_add_u32 m0, s59, 0x10e000
    v_mfma_f32_16x16x32_bf16 v[248:251], a[88:91], a[24:27], v[248:251]
    ds_read_b64_tr_b16 a[84:85], v34 offset:0
    v_mfma_f32_16x16x32_bf16 v[244:247], a[88:91], a[20:23], v[244:247]
    buffer_load_dwordx4 v24, s[32:35], s62 offen offset:0  lds
    v_mfma_f32_16x16x32_bf16 v[244:247], a[92:95], a[164:167], v[244:247]
    ds_read_b64_tr_b16 a[86:87], v34 offset:4096
    v_mfma_f32_16x16x32_bf16 v[240:243], a[92:95], a[160:163], v[240:243]
    buffer_load_dwordx4 v25, s[32:35], s62 offen offset:1024  lds
    v_mfma_f32_16x16x32_bf16 v[240:243], a[88:91], a[16:19], v[240:243]
    buffer_load_dword v7, v5, s[4:7], s56 offen offset:32 sc1
    s_waitcnt vmcnt(15)
    s_waitcnt lgkmcnt(8)
    v_mfma_f32_16x16x32_bf16 v[80:83], a[64:67], a[96:99], v[80:83]
    ds_read_b64_tr_b16 a[88:89], v35 offset:32768
    v_mfma_f32_16x16x32_bf16 v[80:83], a[68:71], a[176:179], v[80:83]
    ds_read_b64_tr_b16 a[90:91], v35 offset:36864
    v_mfma_f32_16x16x32_bf16 v[84:87], a[68:71], a[180:183], v[84:87]
    s_add_u32 s62, s75, 0x120000
    v_mfma_f32_16x16x32_bf16 v[84:87], a[64:67], a[100:103], v[84:87]
    ds_read_b64_tr_b16 a[92:93], v35 offset:0
    v_mfma_f32_16x16x32_bf16 v[88:91], a[64:67], a[104:107], v[88:91]
    s_add_u32 m0, s59, 0x102000
    v_mfma_f32_16x16x32_bf16 v[88:91], a[68:71], a[184:187], v[88:91]
    ds_read_b64_tr_b16 a[94:95], v35 offset:4096
    v_mfma_f32_16x16x32_bf16 v[92:95], a[68:71], a[188:191], v[92:95]
    buffer_load_dwordx4 v24, s[32:35], s62 offen offset:0  lds
    v_mfma_f32_16x16x32_bf16 v[92:95], a[64:67], a[108:111], v[92:95]
    buffer_load_dwordx4 v25, s[32:35], s62 offen offset:1024  lds
    s_waitcnt lgkmcnt(8)
    v_mfma_f32_16x16x32_bf16 v[108:111], a[72:75], a[108:111], v[108:111]
    ds_read_b64_tr_b16 a[64:65], v36 offset:32768
    v_mfma_f32_16x16x32_bf16 v[108:111], a[76:79], a[188:191], v[108:111]
    ds_read_b64_tr_b16 a[66:67], v36 offset:36864
    v_mfma_f32_16x16x32_bf16 v[104:107], a[76:79], a[184:187], v[104:107]
    s_add_u32 s63, s68, 0x101000
    v_mfma_f32_16x16x32_bf16 v[104:107], a[72:75], a[104:107], v[104:107]
    ds_read_b64_tr_b16 a[68:69], v36 offset:0
    v_mfma_f32_16x16x32_bf16 v[100:103], a[72:75], a[100:103], v[100:103]
    buffer_load_dwordx4 a[32:35], v1, s[4:7], s63 offen offset:0 sc1
    v_mfma_f32_16x16x32_bf16 v[100:103], a[76:79], a[180:183], v[100:103]
    ds_read_b64_tr_b16 a[70:71], v36 offset:4096
    v_mfma_f32_16x16x32_bf16 v[96:99], a[76:79], a[176:179], v[96:99]
    v_mfma_f32_16x16x32_bf16 v[96:99], a[72:75], a[96:99], v[96:99]
    s_waitcnt lgkmcnt(8)
    v_mfma_f32_16x16x32_bf16 v[112:115], a[80:83], a[96:99], v[112:115]
    ds_read_b64_tr_b16 a[72:73], v37 offset:32768
    v_mfma_f32_16x16x32_bf16 v[112:115], a[84:87], a[176:179], v[112:115]
    ds_read_b64_tr_b16 a[74:75], v37 offset:36864
    v_mfma_f32_16x16x32_bf16 v[116:119], a[84:87], a[180:183], v[116:119]
    buffer_load_dwordx4 a[36:39], v1, s[4:7], s63 offen offset:1024 sc1
    v_mfma_f32_16x16x32_bf16 v[116:119], a[80:83], a[100:103], v[116:119]
    ds_read_b64_tr_b16 a[76:77], v37 offset:0
    v_mfma_f32_16x16x32_bf16 v[120:123], a[80:83], a[104:107], v[120:123]
    buffer_load_dwordx4 a[40:43], v1, s[4:7], s63 offen offset:2048 sc1
    v_mfma_f32_16x16x32_bf16 v[120:123], a[84:87], a[184:187], v[120:123]
    ds_read_b64_tr_b16 a[78:79], v37 offset:4096
    v_mfma_f32_16x16x32_bf16 v[124:127], a[84:87], a[188:191], v[124:127]
    v_mfma_f32_16x16x32_bf16 v[124:127], a[80:83], a[108:111], v[124:127]
    s_waitcnt lgkmcnt(8)
    v_mfma_f32_16x16x32_bf16 v[140:143], a[88:91], a[108:111], v[140:143]
    ds_read_b64_tr_b16 a[80:81], v38 offset:32768
    v_mfma_f32_16x16x32_bf16 v[140:143], a[92:95], a[188:191], v[140:143]
    ds_read_b64_tr_b16 a[82:83], v38 offset:36864
    v_mfma_f32_16x16x32_bf16 v[136:139], a[92:95], a[184:187], v[136:139]
    buffer_load_dwordx4 a[44:47], v1, s[4:7], s63 offen offset:3072 sc1
    v_mfma_f32_16x16x32_bf16 v[136:139], a[88:91], a[104:107], v[136:139]
    ds_read_b64_tr_b16 a[84:85], v38 offset:0
    v_mfma_f32_16x16x32_bf16 v[132:135], a[88:91], a[100:103], v[132:135]
    s_add_u32 s63, s68, 0x102000
    v_mfma_f32_16x16x32_bf16 v[132:135], a[92:95], a[180:183], v[132:135]
    ds_read_b64_tr_b16 a[86:87], v38 offset:4096
    v_mfma_f32_16x16x32_bf16 v[128:131], a[92:95], a[176:179], v[128:131]
    v_mfma_f32_16x16x32_bf16 v[128:131], a[88:91], a[96:99], v[128:131]
    s_waitcnt lgkmcnt(8)
    v_mfma_f32_16x16x32_bf16 v[160:163], a[64:67], a[96:99], v[160:163]
    ds_read_b64_tr_b16 a[88:89], v39 offset:32768
    v_mfma_f32_16x16x32_bf16 v[160:163], a[68:71], a[176:179], v[160:163]
    ds_read_b64_tr_b16 a[90:91], v39 offset:36864
    v_mfma_f32_16x16x32_bf16 v[164:167], a[68:71], a[180:183], v[164:167]
    buffer_load_dwordx4 a[112:115], v1, s[4:7], s63 offen offset:0 sc1
    v_mfma_f32_16x16x32_bf16 v[164:167], a[64:67], a[100:103], v[164:167]
    ds_read_b64_tr_b16 a[92:93], v39 offset:0
    v_mfma_f32_16x16x32_bf16 v[168:171], a[64:67], a[104:107], v[168:171]
    buffer_load_dwordx4 a[116:119], v1, s[4:7], s63 offen offset:1024 sc1
    v_mfma_f32_16x16x32_bf16 v[168:171], a[68:71], a[184:187], v[168:171]
    ds_read_b64_tr_b16 a[94:95], v39 offset:4096
    v_mfma_f32_16x16x32_bf16 v[172:175], a[68:71], a[188:191], v[172:175]
    v_mfma_f32_16x16x32_bf16 v[172:175], a[64:67], a[108:111], v[172:175]
    s_waitcnt vmcnt(19)
    s_barrier
    s_waitcnt lgkmcnt(8)
    v_mfma_f32_16x16x32_bf16 v[204:207], a[72:75], a[108:111], v[204:207]
    ds_read_b64_tr_b16 a[64:65], v32 offset:40960
    v_mfma_f32_16x16x32_bf16 v[204:207], a[76:79], a[188:191], v[204:207]
    ds_read_b64_tr_b16 a[66:67], v32 offset:45056
    v_mfma_f32_16x16x32_bf16 v[200:203], a[76:79], a[184:187], v[200:203]
    buffer_load_dwordx4 a[120:123], v1, s[4:7], s63 offen offset:2048 sc1
    v_mfma_f32_16x16x32_bf16 v[200:203], a[72:75], a[104:107], v[200:203]
    ds_read_b64_tr_b16 a[68:69], v32 offset:49152
    v_mfma_f32_16x16x32_bf16 v[196:199], a[72:75], a[100:103], v[196:199]
    buffer_load_dwordx4 a[124:127], v1, s[4:7], s63 offen offset:3072 sc1
    v_mfma_f32_16x16x32_bf16 v[196:199], a[76:79], a[180:183], v[196:199]
    ds_read_b64_tr_b16 a[70:71], v32 offset:53248
    v_mfma_f32_16x16x32_bf16 v[192:195], a[76:79], a[176:179], v[192:195]
    v_mfma_f32_16x16x32_bf16 v[192:195], a[72:75], a[96:99], v[192:195]
    s_waitcnt lgkmcnt(8)
    v_mfma_f32_16x16x32_bf16 v[224:227], a[80:83], a[96:99], v[224:227]
    ds_read_b64_tr_b16 a[72:73], v33 offset:40960
    v_mfma_f32_16x16x32_bf16 v[224:227], a[84:87], a[176:179], v[224:227]
    ds_read_b64_tr_b16 a[74:75], v33 offset:45056
    v_mfma_f32_16x16x32_bf16 v[228:231], a[84:87], a[180:183], v[228:231]
    s_add_u32 s62, s76, 0x100000
    v_mfma_f32_16x16x32_bf16 v[228:231], a[80:83], a[100:103], v[228:231]
    ds_read_b64_tr_b16 a[76:77], v33 offset:49152
    v_mfma_f32_16x16x32_bf16 v[232:235], a[80:83], a[104:107], v[232:235]
    s_add_u32 m0, s59, 0x104000
    v_mfma_f32_16x16x32_bf16 v[232:235], a[84:87], a[184:187], v[232:235]
    ds_read_b64_tr_b16 a[78:79], v33 offset:53248
    v_mfma_f32_16x16x32_bf16 v[236:239], a[84:87], a[188:191], v[236:239]
    buffer_load_dwordx4 v24, s[32:35], s62 offen offset:0  lds
    v_mfma_f32_16x16x32_bf16 v[236:239], a[80:83], a[108:111], v[236:239]
    buffer_load_dwordx4 v25, s[32:35], s62 offen offset:1024  lds
    s_waitcnt lgkmcnt(8)
    v_mfma_f32_16x16x32_bf16 v[252:255], a[88:91], a[108:111], v[252:255]
    ds_read_b64_tr_b16 a[80:81], v34 offset:40960
    v_mfma_f32_16x16x32_bf16 v[252:255], a[92:95], a[188:191], v[252:255]
    ds_read_b64_tr_b16 a[82:83], v34 offset:45056
    v_mfma_f32_16x16x32_bf16 v[248:251], a[92:95], a[184:187], v[248:251]
    s_add_u32 s62, s76, 0x110000
    v_mfma_f32_16x16x32_bf16 v[248:251], a[88:91], a[104:107], v[248:251]
    ds_read_b64_tr_b16 a[84:85], v34 offset:49152
    v_mfma_f32_16x16x32_bf16 v[244:247], a[88:91], a[100:103], v[244:247]
    s_add_u32 m0, s59, 0x106000
    v_mfma_f32_16x16x32_bf16 v[244:247], a[92:95], a[180:183], v[244:247]
    ds_read_b64_tr_b16 a[86:87], v34 offset:53248
    v_mfma_f32_16x16x32_bf16 v[240:243], a[92:95], a[176:179], v[240:243]
    buffer_load_dwordx4 v24, s[32:35], s62 offen offset:0  lds
    v_mfma_f32_16x16x32_bf16 v[240:243], a[88:91], a[96:99], v[240:243]
    s_waitcnt vmcnt(16)
    s_waitcnt lgkmcnt(8)
    v_mfma_f32_16x16x32_bf16 v[80:83], a[64:67], a[192:195], v[80:83]
    ds_read_b64_tr_b16 a[88:89], v35 offset:40960
    v_mfma_f32_16x16x32_bf16 v[80:83], a[68:71], a[208:211], v[80:83]
    ds_read_b64_tr_b16 a[90:91], v35 offset:45056
    v_mfma_f32_16x16x32_bf16 v[84:87], a[68:71], a[212:215], v[84:87]
    buffer_load_dwordx4 v25, s[32:35], s62 offen offset:1024  lds
    v_mfma_f32_16x16x32_bf16 v[84:87], a[64:67], a[196:199], v[84:87]
    ds_read_b64_tr_b16 a[92:93], v35 offset:49152
    v_mfma_f32_16x16x32_bf16 v[88:91], a[64:67], a[200:203], v[88:91]
    s_waitcnt vmcnt(14)
    v_cmp_ne_u32 vcc, 0, v7
    s_cmp_eq_u64 vcc, 0
    s_cbranch_scc0 L_slow_flS
L_back_flS:
    v_mfma_f32_16x16x32_bf16 v[88:91], a[68:71], a[216:219], v[88:91]
    ds_read_b64_tr_b16 a[94:95], v35 offset:53248
    v_mfma_f32_16x16x32_bf16 v[92:95], a[68:71], a[220:223], v[92:95]
    s_add_u32 s63, s78, 0x107000
    v_mfma_f32_16x16x32_bf16 v[92:95], a[64:67], a[204:207], v[92:95]
    s_waitcnt lgkmcnt(8)
    v_mfma_f32_16x16x32_bf16 v[108:111], a[72:75], a[204:207], v[108:111]
    ds_read_b64_tr_b16 a[64:65], v36 offset:40960
    v_mfma_f32_16x16x32_bf16 v[108:111], a[76:79], a[220:223], v[108:111]
    ds_read_b64_tr_b16 a[66:67], v36 offset:45056
    v_mfma_f32_16x16x32_bf16 v[104:107], a[76:79], a[216:219], v[104:107]
    buffer_load_dwordx4 a[128:131], v1, s[4:7], s63 offen offset:0 sc1
    v_mfma_f32_16x16x32_bf16 v[104:107], a[72:75], a[200:203], v[104:107]
    ds_read_b64_tr_b16 a[68:69], v36 offset:49152
    v_mfma_f32_16x16x32_bf16 v[100:103], a[72:75], a[196:199], v[100:103]
    buffer_load_dwordx4 a[132:135], v1, s[4:7], s63 offen offset:1024 sc1
    v_mfma_f32_16x16x32_bf16 v[100:103], a[76:79], a[212:215], v[100:103]
    ds_read_b64_tr_b16 a[70:71], v36 offset:53248
    v_mfma_f32_16x16x32_bf16 v[96:99], a[76:79], a[208:211], v[96:99]
    v_mfma_f32_16x16x32_bf16 v[96:99], a[72:75], a[192:195], v[96:99]
    s_waitcnt lgkmcnt(8)
    v_mfma_f32_16x16x32_bf16 v[112:115], a[80:83], a[192:195], v[112:115]
    ds_read_b64_tr_b16 a[72:73], v37 offset:40960
    v_mfma_f32_16x16x32_bf16 v[112:115], a[84:87], a[208:211], v[112:115]
    ds_read_b64_tr_b16 a[74:75], v37 offset:45056
    v_mfma_f32_16x16x32_bf16 v[116:119], a[84:87], a[212:215], v[116:119]
    buffer_load_dwordx4 a[136:139], v1, s[4:7], s63 offen offset:2048 sc1
    v_mfma_f32_16x16x32_bf16 v[116:119], a[80:83], a[196:199], v[116:119]
    ds_read_b64_tr_b16 a[76:77], v37 offset:49152
    v_mfma_f32_16x16x32_bf16 v[120:123], a[80:83], a[200:203], v[120:123]
    buffer_load_dwordx4 a[140:143], v1, s[4:7], s63 offen offset:3072 sc1
    v_mfma_f32_16x16x32_bf16 v[120:123], a[84:87], a[216:219], v[120:123]
    ds_read_b64_tr_b16 a[78:79], v37 offset:53248
    v_mfma_f32_16x16x32_bf16 v[124:127], a[84:87], a[220:223], v[124:127]
    v_mfma_f32_16x16x32_bf16 v[124:127], a[80:83], a[204:207], v[124:127]
    s_waitcnt lgkmcnt(8)
    v_mfma_f32_16x16x32_bf16 v[140:143], a[88:91], a[204:207], v[140:143]
    ds_read_b64_tr_b16 a[80:81], v38 offset:40960
    v_mfma_f32_16x16x32_bf16 v[140:143], a[92:95], a[220:223], v[140:143]
    ds_read_b64_tr_b16 a[82:83], v38 offset:45056
    v_mfma_f32_16x16x32_bf16 v[136:139], a[92:95], a[216:219], v[136:139]
    s_add_u32 s63, s78, 0x108000
    v_mfma_f32_16x16x32_bf16 v[136:139], a[88:91], a[200:203], v[136:139]
    ds_read_b64_tr_b16 a[84:85], v38 offset:49152
    v_mfma_f32_16x16x32_bf16 v[132:135], a[88:91], a[196:199], v[132:135]
    buffer_load_dwordx4 a[48:51], v1, s[4:7], s63 offen offset:0 sc1
    v_mfma_f32_16x16x32_bf16 v[132:135], a[92:95], a[212:215], v[132:135]
    ds_read_b64_tr_b16 a[86:87], v38 offset:53248
    v_mfma_f32_16x16x32_bf16 v[128:131], a[92:95], a[208:211], v[128:131]
    v_mfma_f32_16x16x32_bf16 v[128:131], a[88:91], a[192:195], v[128:131]
    s_waitcnt lgkmcnt(8)
    v_mfma_f32_16x16x32_bf16 v[160:163], a[64:67], a[192:195], v[160:163]
    ds_read_b64_tr_b16 a[88:89], v39 offset:40960
    v_mfma_f32_16x16x32_bf16 v[160:163], a[68:71], a[208:211], v[160:163]
    ds_read_b64_tr_b16 a[90:91], v39 offset:45056
    v_mfma_f32_16x16x32_bf16 v[164:167], a[68:71], a[212:215], v[164:167]
    buffer_load_dwordx4 a[52:55], v1, s[4:7], s63 offen offset:1024 sc1
    v_mfma_f32_16x16x32_bf16 v[164:167], a[64:67], a[196:199], v[164:167]
    ds_read_b64_tr_b16 a[92:93], v39 offset:49152
    v_mfma_f32_16x16x32_bf16 v[168:171], a[64:67], a[200:203], v[168:171]
    buffer_load_dwordx4 a[56:59], v1, s[4:7], s63 offen offset:2048 sc1
    v_mfma_f32_16x16x32_bf16 v[168:171], a[68:71], a[216:219], v[168:171]
    ds_read_b64_tr_b16 a[94:95], v39 offset:53248
    v_mfma_f32_16x16x32_bf16 v[172:175], a[68:71], a[220:223], v[172:175]
    v_mfma_f32_16x16x32_bf16 v[172:175], a[64:67], a[204:207], v[172:175]
    s_waitcnt vmcnt(19)
    s_barrier
    s_waitcnt lgkmcnt(8)
    v_mfma_f32_16x16x32_bf16 v[204:207], a[72:75], a[204:207], v[204:207]
    ds_read_b64_tr_b16 a[64:65], v32 offset:57344
    v_mfma_f32_16x16x32_bf16 v[204:207], a[76:79], a[220:223], v[204:207]
    ds_read_b64_tr_b16 a[66:67], v32 offset:61440
    v_mfma_f32_16x16x32_bf16 v[200:203], a[76:79], a[216:219], v[200:203]
    buffer_load_dwordx4 a[60:63], v1, s[4:7], s63 offen offset:3072 sc1
    v_mfma_f32_16x16x32_bf16 v[200:203], a[72:75], a[200:203], v[200:203]
    ds_read_b64_tr_b16 a[68:69], v32 offset:8192
    v_mfma_f32_16x16x32_bf16 v[196:199], a[72:75], a[196:199], v[196:199]
    s_add_u32 s63, s78, 0x109000
    v_mfma_f32_16x16x32_bf16 v[196:199], a[76:79], a[212:215], v[196:199]
    ds_read_b64_tr_b16 a[70:71], v32 offset:12288
    v_mfma_f32_16x16x32_bf16 v[192:195], a[76:79], a[208:211], v[192:195]
    buffer_load_dwordx4 a[144:147], v1, s[4:7], s63 offen offset:0 sc1
    v_mfma_f32_16x16x32_bf16 v[192:195], a[72:75], a[192:195], v[192:195]
    s_waitcnt lgkmcnt(8)
    v_mfma_f32_16x16x32_bf16 v[224:227], a[80:83], a[192:195], v[224:227]
    ds_read_b64_tr_b16 a[72:73], v33 offset:57344
    v_mfma_f32_16x16x32_bf16 v[224:227], a[84:87], a[208:211], v[224:227]
    ds_read_b64_tr_b16 a[74:75], v33 offset:61440
    v_mfma_f32_16x16x32_bf16 v[228:231], a[84:87], a[212:215], v[228:231]
    buffer_load_dwordx4 a[148:151], v1, s[4:7], s63 offen offset:1024 sc1
    v_mfma_f32_16x16x32_bf16 v[228:231], a[80:83], a[196:199], v[228:231]
    ds_read_b64_tr_b16 a[76:77], v33 offset:8192
    v_mfma_f32_16x16x32_bf16 v[232:235], a[80:83], a[200:203], v[232:235]
    v_mfma_f32_16x16x32_bf16 v[232:235], a[84:87], a[216:219], v[232:235]
    ds_read_b64_tr_b16 a[78:79], v33 offset:12288
    v_mfma_f32_16x16x32_bf16 v[236:239], a[84:87], a[220:223], v[236:239]
    buffer_load_dwordx4 a[152:155], v1, s[4:7], s63 offen offset:2048 sc1
    v_mfma_f32_16x16x32_bf16 v[236:239], a[80:83], a[204:207], v[236:239]
    s_waitcnt lgkmcnt(8)
    v_mfma_f32_16x16x32_bf16 v[252:255], a[88:91], a[204:207], v[252:255]
    ds_read_b64_tr_b16 a[80:81], v34 offset:57344
    v_mfma_f32_16x16x32_bf16 v[252:255], a[92:95], a[220:223], v[252:255]
    ds_read_b64_tr_b16 a[82:83], v34 offset:61440
    v_mfma_f32_16x16x32_bf16 v[248:251], a[92:95], a[216:219], v[248:251]
    buffer_load_dwordx4 a[156:159], v1, s[4:7], s63 offen offset:3072 sc1
    v_mfma_f32_16x16x32_bf16 v[248:251], a[88:91], a[200:203], v[248:251]
    ds_read_b64_tr_b16 a[84:85], v34 offset:8192
    v_mfma_f32_16x16x32_bf16 v[244:247], a[88:91], a[196:199], v[244:247]
    v_mfma_f32_16x16x32_bf16 v[244:247], a[92:95], a[212:215], v[244:247]
    ds_read_b64_tr_b16 a[86:87], v34 offset:12288
    v_mfma_f32_16x16x32_bf16 v[240:243], a[92:95], a[208:211], v[240:243]
    s_add_u32 s63, s78, 0x10a000
    v_mfma_f32_16x16x32_bf16 v[240:243], a[88:91], a[192:195], v[240:243]
    s_waitcnt vmcnt(16)
    s_waitcnt lgkmcnt(8)
    v_mfma_f32_16x16x32_bf16 v[80:83], a[64:67], a[32:35], v[80:83]
    ds_read_b64_tr_b16 a[88:89], v35 offset:57344
    v_mfma_f32_16x16x32_bf16 v[80:83], a[68:71], a[112:115], v[80:83]
    ds_read_b64_tr_b16 a[90:91], v35 offset:61440
    v_mfma_f32_16x16x32_bf16 v[84:87], a[68:71], a[116:119], v[84:87]
L_hop_9:
    s_cbranch_execz L_hop_done
    s_nop 0
    buffer_load_dwordx4 a[0:3], v1, s[4:7], s63 offen offset:0 sc1
    v_mfma_f32_16x16x32_bf16 v[84:87], a[64:67], a[36:39], v[84:87]
    ds_read_b64_tr_b16 a[92:93], v35 offset:8192
    v_mfma_f32_16x16x32_bf16 v[88:91], a[64:67], a[40:43], v[88:91]
    v_mfma_f32_16x16x32_bf16 v[88:91], a[68:71], a[120:123], v[88:91]
    ds_read_b64_tr_b16 a[94:95], v35 offset:12288
    v_mfma_f32_16x16x32_bf16 v[92:95], a[68:71], a[124:127], v[92:95]
    buffer_load_dwordx4 a[4:7], v1, s[4:7], s63 offen offset:1024 sc1
    v_mfma_f32_16x16x32_bf16 v[92:95], a[64:67], a[44:47], v[92:95]
    s_waitcnt lgkmcnt(8)
    v_mfma_f32_16x16x32_bf16 v[108:111], a[72:75], a[44:47], v[108:111]
    ds_read_b64_tr_b16 a[64:65], v36 offset:57344
    v_mfma_f32_16x16x32_bf16 v[108:111], a[76:79], a[124:127], v[108:111]
    ds_read_b64_tr_b16 a[66:67], v36 offset:61440
    v_mfma_f32_16x16x32_bf16 v[104:107], a[76:79], a[120:123], v[104:107]
    buffer_load_dwordx4 a[8:11], v1, s[4:7], s63 offen offset:2048 sc1
    v_mfma_f32_16x16x32_bf16 v[104:107], a[72:75], a[40:43], v[104:107]
    ds_read_b64_tr_b16 a[68:69], v36 offset:8192
    v_mfma_f32_16x16x32_bf16 v[100:103], a[72:75], a[36:39], v[100:103]
    v_mfma_f32_16x16x32_bf16 v[100:103], a[76:79], a[116:119], v[100:103]
    ds_read_b64_tr_b16 a[70:71], v36 offset:12288
    v_mfma_f32_16x16x32_bf16 v[96:99], a[76:79], a[112:115], v[96:99]
    buffer_load_dwordx4 a[12:15], v1, s[4:7], s63 offen offset:3072 sc1
    v_mfma_f32_16x16x32_bf16 v[96:99], a[72:75], a[32:35], v[96:99]
    s_waitcnt lgkmcnt(8)
    v_mfma_f32_16x16x32_bf16 v[112:115], a[80:83], a[32:35], v[112:115]
    ds_read_b64_tr_b16 a[72:73], v37 offset:57344
    v_mfma_f32_16x16x32_bf16 v[112:115], a[84:87], a[112:115], v[112:115]
    ds_read_b64_tr_b16 a[74:75], v37 offset:61440
    v_mfma_f32_16x16x32_bf16 v[116:119], a[84:87], a[116:119], v[116:119]
    s_add_u32 s63, s69, 0x100000
    v_mfma_f32_16x16x32_bf16 v[116:119], a[80:83], a[36:39], v[116:119]
    ds_read_b64_tr_b16 a[76:77], v37 offset:8192
    v_mfma_f32_16x16x32_bf16 v[120:123], a[80:83], a[40:43], v[120:123]
    buffer_load_dwordx4 a[160:163], v1, s[4:7], s63 offen offset:0 sc1
    v_mfma_f32_16x16x32_bf16 v[120:123], a[84:87], a[120:123], v[120:123]
    ds_read_b64_tr_b16 a[78:79], v37 offset:12288
    v_mfma_f32_16x16x32_bf16 v[124:127], a[84:87], a[124:127], v[124:127]
    v_mfma_f32_16x16x32_bf16 v[124:127], a[80:83], a[44:47], v[124:127]
    s_waitcnt lgkmcnt(8)
    v_mfma_f32_16x16x32_bf16 v[140:143], a[88:91], a[44:47], v[140:143]
    ds_read_b64_tr_b16 a[80:81], v38 offset:57344
    v_mfma_f32_16x16x32_bf16 v[140:143], a[92:95], a[124:127], v[140:143]
    ds_read_b64_tr_b16 a[82:83], v38 offset:61440
    v_mfma_f32_16x16x32_bf16 v[136:139], a[92:95], a[120:123], v[136:139]
    buffer_load_dwordx4 a[164:167], v1, s[4:7], s63 offen offset:1024 sc1
    v_mfma_f32_16x16x32_bf16 v[136:139], a[88:91], a[40:43], v[136:139]
    ds_read_b64_tr_b16 a[84:85], v38 offset:8192
    v_mfma_f32_16x16x32_bf16 v[132:135], a[88:91], a[36:39], v[132:135]
    buffer_load_dwordx4 a[168:171], v1, s[4:7], s63 offen offset:2048 sc1
    v_mfma_f32_16x16x32_bf16 v[132:135], a[92:95], a[116:119], v[132:135]
    ds_read_b64_tr_b16 a[86:87], v38 offset:12288
    v_mfma_f32_16x16x32_bf16 v[128:131], a[92:95], a[112:115], v[128:131]
    v_mfma_f32_16x16x32_bf16 v[128:131], a[88:91], a[32:35], v[128:131]
    s_waitcnt lgkmcnt(8)
    v_mfma_f32_16x16x32_bf16 v[160:163], a[64:67], a[32:35], v[160:163]
    ds_read_b64_tr_b16 a[88:89], v39 offset:57344
    v_mfma_f32_16x16x32_bf16 v[160:163], a[68:71], a[112:115], v[160:163]
    ds_read_b64_tr_b16 a[90:91], v39 offset:61440
    v_mfma_f32_16x16x32_bf16 v[164:167], a[68:71], a[116:119], v[164:167]
    buffer_load_dwordx4 a[172:175], v1, s[4:7], s63 offen offset:3072 sc1
    v_mfma_f32_16x16x32_bf16 v[164:167], a[64:67], a[36:39], v[164:167]
    ds_read_b64_tr_b16 a[92:93], v39 offset:8192
    v_mfma_f32_16x16x32_bf16 v[168:171], a[64:67], a[40:43], v[168:171]
    s_add_u32 s63, s69, 0x101000
    v_mfma_f32_16x16x32_bf16 v[168:171], a[68:71], a[120:123], v[168:171]
    ds_read_b64_tr_b16 a[94:95], v39 offset:12288
    v_mfma_f32_16x16x32_bf16 v[172:175], a[68:71], a[124:127], v[172:175]
    v_mfma_f32_16x16x32_bf16 v[172:175], a[64:67], a[44:47], v[172:175]
    s_barrier
    s_waitcnt lgkmcnt(8)
    v_mfma_f32_16x16x32_bf16 v[204:207], a[72:75], a[44:47], v[204:207]
    ds_read_b128 a[64:67], v40 offset:32768
    v_mfma_f32_16x16x32_bf16 v[204:207], a[76:79], a[124:127], v[204:207]
    buffer_load_dwordx4 a[16:19], v1, s[4:7], s63 offen offset:0 sc1
    v_mfma_f32_16x16x32_bf16 v[200:203], a[76:79], a[120:123], v[200:203]
    v_mfma_f32_16x16x32_bf16 v[200:203], a[72:75], a[40:43], v[200:203]
    ds_read_b128 a[68:71], v41 offset:32768
    v_mfma_f32_16x16x32_bf16 v[196:199], a[72:75], a[36:39], v[196:199]
    buffer_load_dwordx4 a[20:23], v1, s[4:7], s63 offen offset:1024 sc1
    v_mfma_f32_16x16x32_bf16 v[196:199], a[76:79], a[116:119], v[196:199]
    v_mfma_f32_16x16x32_bf16 v[192:195], a[76:79], a[112:115], v[192:195]
    v_mfma_f32_16x16x32_bf16 v[192:195], a[72:75], a[32:35], v[192:195]
    s_waitcnt lgkmcnt(6)
    v_mfma_f32_16x16x32_bf16 v[224:227], a[80:83], a[32:35], v[224:227]
    ds_read_b128 a[72:75], v40 offset:34816
    v_mfma_f32_16x16x32_bf16 v[224:227], a[84:87], a[112:115], v[224:227]
    buffer_load_dwordx4 a[24:27], v1, s[4:7], s63 offen offset:2048 sc1
    v_mfma_f32_16x16x32_bf16 v[228:231], a[84:87], a[116:119], v[228:231]
    v_mfma_f32_16x16x32_bf16 v[228:231], a[80:83], a[36:39], v[228:231]
    ds_read_b128 a[76:79], v41 offset:34816
    v_mfma_f32_16x16x32_bf16 v[232:235], a[80:83], a[40:43], v[232:235]
    buffer_load_dwordx4 a[28:31], v1, s[4:7], s63 offen offset:3072 sc1
    v_mfma_f32_16x16x32_bf16 v[232:235], a[84:87], a[120:123], v[232:235]
    v_mfma_f32_16x16x32_bf16 v[236:239], a[84:87], a[124:127], v[236:239]
    v_mfma_f32_16x16x32_bf16 v[236:239], a[80:83], a[44:47], v[236:239]
    s_waitcnt lgkmcnt(4)
    v_mfma_f32_16x16x32_bf16 v[252:255], a[88:91], a[44:47], v[252:255]
    ds_read_b128 a[80:83], v40 offset:36864
    v_mfma_f32_16x16x32_bf16 v[252:255], a[92:95], a[124:127], v[252:255]
    s_add_u32 s62, s76, 0x120000
    v_mfma_f32_16x16x32_bf16 v[248:251], a[92:95], a[120:123], v[248:251]
    s_add_u32 m0, s59, 0x108000
    v_mfma_f32_16x16x32_bf16 v[248:251], a[88:91], a[40:43], v[248:251]
    ds_read_b128 a[84:87], v41 offset:36864
    v_mfma_f32_16x16x32_bf16 v[244:247], a[88:91], a[36:39], v[244:247]
    buffer_load_dwordx4 v24, s[32:35], s62 offen offset:0  lds
    v_mfma_f32_16x16x32_bf16 v[244:247], a[92:95], a[116:119], v[244:247]
    v_mfma_f32_16x16x32_bf16 v[240:243], a[92:95], a[112:115], v[240:243]
    buffer_load_dwordx4 v25, s[32:35], s62 offen offset:1024  lds
    v_mfma_f32_16x16x32_bf16 v[240:243], a[88:91], a[32:35], v[240:243]
    s_waitcnt vmcnt(18)
    s_waitcnt lgkmcnt(4)
    v_mfma_f32_16x16x32_bf16 v[80:83], a[64:67], a[128:131], v[80:83]
    ds_read_b128 a[88:91], v40 offset:38912
    v_mfma_f32_16x16x32_bf16 v[80:83], a[68:71], a[48:51], v[80:83]
    s_add_u32 s62, s85, 0x210000
    v_mfma_f32_16x16x32_bf16 v[84:87], a[68:71], a[52:55], v[84:87]
    v_mfma_f32_16x16x32_bf16 v[84:87], a[64:67], a[132:135], v[84:87]
    ds_read_b128 a[92:95], v41 offset:38912
    v_mfma_f32_16x16x32_bf16 v[88:91], a[64:67], a[136:139], v[88:91]
    s_add_u32 m0, s59, 0x100000
    v_mfma_f32_16x16x32_bf16 v[88:91], a[68:71], a[56:59], v[88:91]
    buffer_load_dwordx4 v26, s[32:35], s62 offen offset:0  lds
    v_mfma_f32_16x16x32_bf16 v[92:95], a[68:71], a[60:63], v[92:95]
    v_mfma_f32_16x16x32_bf16 v[92:95], a[64:67], a[140:143], v[92:95]
    s_waitcnt lgkmcnt(4)
    v_mfma_f32_16x16x32_bf16 v[108:111], a[72:75], a[140:143], v[108:111]
    ds_read_b128 a[64:67], v40 offset:40960
    v_mfma_f32_16x16x32_bf16 v[108:111], a[76:79], a[60:63], v[108:111]
    buffer_load_dwordx4 v27, s[32:35], s62 offen offset:1024  lds
    v_mfma_f32_16x16x32_bf16 v[104:107], a[76:79], a[56:59], v[104:107]
    s_add_u32 s63, s69, 0x102000
    v_mfma_f32_16x16x32_bf16 v[104:107], a[72:75], a[136:139], v[104:107]
    ds_read_b128 a[68:71], v41 offset:40960
    v_mfma_f32_16x16x32_bf16 v[100:103], a[72:75], a[132:135], v[100:103]
    v_mfma_f32_16x16x32_bf16 v[100:103], a[76:79], a[52:55], v[100:103]
    buffer_load_dwordx4 a[176:179], v1, s[4:7], s63 offen offset:0 sc1
    v_mfma_f32_16x16x32_bf16 v[96:99], a[76:79], a[48:51], v[96:99]
    v_mfma_f32_16x16x32_bf16 v[96:99], a[72:75], a[128:131], v[96:99]
    s_waitcnt lgkmcnt(4)
    v_mfma_f32_16x16x32_bf16 v[112:115], a[80:83], a[128:131], v[112:115]
    ds_read_b128 a[72:75], v40 offset:43008
    v_mfma_f32_16x16x32_bf16 v[112:115], a[84:87], a[48:51], v[112:115]
    buffer_load_dwordx4 a[180:183], v1, s[4:7], s63 offen offset:1024 sc1
    v_mfma_f32_16x16x32_bf16 v[116:119], a[84:87], a[52:55], v[116:119]
    v_mfma_f32_16x16x32_bf16 v[116:119], a[80:83], a[132:135], v[116:119]
    ds_read_b128 a[76:79], v41 offset:43008
    v_mfma_f32_16x16x32_bf16 v[120:123], a[80:83], a[136:139], v[120:123]
    v_mfma_f32_16x16x32_bf16 v[120:123], a[84:87], a[56:59], v[120:123]
    buffer_load_dwordx4 a[184:187], v1, s[4:7], s63 offen offset:2048 sc1
    v_mfma_f32_16x16x32_bf16 v[124:127], a[84:87], a[60:63], v[124:127]
    v_mfma_f32_16x16x32_bf16 v[124:127], a[80:83], a[140:143], v[124:127]
    s_waitcnt lgkmcnt(4)
    v_mfma_f32_16x16x32_bf16 v[140:143], a[88:91], a[140:143], v[140:143]
    ds_read_b128 a[80:83], v40 offset:45056
    v_mfma_f32_16x16x32_bf16 v[140:143], a[92:95], a[60:63], v[140:143]
    buffer_load_dwordx4 a[188:191], v1, s[4:7], s63 offen offset:3072 sc1
    v_mfma_f32_16x16x32_bf16 v[136:139], a[92:95], a[56:59], v[136:139]
    v_mfma_f32_16x16x32_bf16 v[136:139], a[88:91], a[136:139], v[136:139]
    ds_read_b128 a[84:87], v41 offset:45056
    v_mfma_f32_16x16x32_bf16 v[132:135], a[88:91], a[132:135], v[132:135]
    v_mfma_f32_16x16x32_bf16 v[132:135], a[92:95], a[52:55], v[132:135]
    s_add_u32 s63, s84, 0x119000
    v_mfma_f32_16x16x32_bf16 v[128:131], a[92:95], a[48:51], v[128:131]
    v_mfma_f32_16x16x32_bf16 v[128:131], a[88:91], a[128:131], v[128:131]
    s_waitcnt lgkmcnt(4)
    v_mfma_f32_16x16x32_bf16 v[160:163], a[64:67], a[128:131], v[160:163]
    ds_read_b128 a[88:91], v40 offset:47104
    v_mfma_f32_16x16x32_bf16 v[160:163], a[68:71], a[48:51], v[160:163]
    buffer_load_dwordx4 a[96:99], v1, s[4:7], s63 offen offset:0 sc1
    v_mfma_f32_16x16x32_bf16 v[164:167], a[68:71], a[52:55], v[164:167]
    v_mfma_f32_16x16x32_bf16 v[164:167], a[64:67], a[132:135], v[164:167]
    ds_read_b128 a[92:95], v41 offset:47104
    v_mfma_f32_16x16x32_bf16 v[168:171], a[64:67], a[136:139], v[168:171]
    v_mfma_f32_16x16x32_bf16 v[168:171], a[68:71], a[56:59], v[168:171]
    buffer_load_dwordx4 a[100:103], v1, s[4:7], s63 offen offset:1024 sc1
    v_mfma_f32_16x16x32_bf16 v[172:175], a[68:71], a[60:63], v[172:175]
    v_mfma_f32_16x16x32_bf16 v[172:175], a[64:67], a[140:143], v[172:175]
    s_barrier
    s_waitcnt lgkmcnt(4)
    v_mfma_f32_16x16x32_bf16 v[204:207], a[72:75], a[140:143], v[204:207]
    ds_read_b128 a[64:67], v40 offset:49152
    v_mfma_f32_16x16x32_bf16 v[204:207], a[76:79], a[60:63], v[204:207]
    buffer_load_dwordx4 a[104:107], v1, s[4:7], s63 offen offset:2048 sc1
    v_mfma_f32_16x16x32_bf16 v[200:203], a[76:79], a[56:59], v[200:203]
    v_mfma_f32_16x16x32_bf16 v[200:203], a[72:75], a[136:139], v[200:203]
    ds_read_b128 a[68:71], v41 offset:49152
    v_mfma_f32_16x16x32_bf16 v[196:199], a[72:75], a[132:135], v[196:199]
    v_mfma_f32_16x16x32_bf16 v[196:199], a[76:79], a[52:55], v[196:199]
    buffer_load_dwordx4 a[108:111], v1, s[4:7], s63 offen offset:3072 sc1
    v_mfma_f32_16x16x32_bf16 v[192:195], a[76:79], a[48:51], v[192:195]
    v_mfma_f32_16x16x32_bf16 v[192:195], a[72:75], a[128:131], v[192:195]
    s_waitcnt lgkmcnt(4)
    v_mfma_f32_16x16x32_bf16 v[224:227], a[80:83], a[128:131], v[224:227]
    ds_read_b128 a[72:75], v40 offset:51200
    v_mfma_f32_16x16x32_bf16 v[224:227], a[84:87], a[48:51], v[224:227]
    s_add_u32 s62, s77, 0x100000
    v_mfma_f32_16x16x32_bf16 v[228:231], a[84:87], a[52:55], v[228:231]
    v_mfma_f32_16x16x32_bf16 v[228:231], a[80:83], a[132:135], v[228:231]
    ds_read_b128 a[76:79], v41 offset:51200
    v_mfma_f32_16x16x32_bf16 v[232:235], a[80:83], a[136:139], v[232:235]
    s_add_u32 m0, s59, 0x10a000
    v_mfma_f32_16x16x32_bf16 v[232:235], a[84:87], a[56:59], v[232:235]
    buffer_load_dwordx4 v24, s[32:35], s62 offen offset:0  lds
    v_mfma_f32_16x16x32_bf16 v[236:239], a[84:87], a[60:63], v[236:239]
    v_mfma_f32_16x16x32_bf16 v[236:239], a[80:83], a[140:143], v[236:239]
    s_waitcnt lgkmcnt(4)
    v_mfma_f32_16x16x32_bf16 v[252:255], a[88:91], a[140:143], v[252:255]
    ds_read_b128 a[80:83], v40 offset:53248
    v_mfma_f32_16x16x32_bf16 v[252:255], a[92:95], a[60:63], v[252:255]
    buffer_load_dwordx4 v25, s[32:35], s62 offen offset:1024  lds
    v_mfma_f32_16x16x32_bf16 v[248:251], a[92:95], a[56:59], v[248:251]
    s_add_u32 s62, s77, 0x110000
    v_mfma_f32_16x16x32_bf16 v[248:251], a[88:91], a[136:139], v[248:251]
    ds_read_b128 a[84:87], v41 offset:53248
    v_mfma_f32_16x16x32_bf16 v[244:247], a[88:91], a[132:135], v[244:247]
    s_add_u32 m0, s59, 0x10c000
    v_mfma_f32_16x16x32_bf16 v[244:247], a[92:95], a[52:55], v[244:247]
    v_mfma_f32_16x16x32_bf16 v[240:243], a[92:95], a[48:51], v[240:243]
    v_mfma_f32_16x16x32_bf16 v[240:243], a[88:91], a[128:131], v[240:243]
    s_waitcnt vmcnt(22)
    s_waitcnt lgkmcnt(4)
    v_mfma_f32_16x16x32_bf16 v[80:83], a[64:67], a[144:147], v[80:83]
    ds_read_b128 a[88:91], v40 offset:55296
    s_add_u32 s18, s15, 1
    s_and_b32 s18, s18, 3
    v_mfma_f32_16x16x32_bf16 v[80:83], a[68:71], a[0:3], v[80:83]
    buffer_load_dwordx4 v24, s[32:35], s62 offen offset:0  lds
    v_mfma_f32_16x16x32_bf16 v[84:87], a[68:71], a[4:7], v[84:87]
    buffer_load_dwordx4 v25, s[32:35], s62 offen offset:1024  lds
    v_mfma_f32_16x16x32_bf16 v[84:87], a[64:67], a[148:151], v[84:87]
    ds_read_b128 a[92:95], v41 offset:55296
    v_mfma_f32_16x16x32_bf16 v[88:91], a[64:67], a[152:155], v[88:91]
    s_add_u32 s63, s70, 0x100000
    v_mfma_f32_16x16x32_bf16 v[88:91], a[68:71], a[8:11], v[88:91]
    s_sub_u32 s19, s18, s15
    s_mul_i32 s19, s19, 393216
    v_mfma_f32_16x16x32_bf16 v[92:95], a[68:71], a[12:15], v[92:95]
    v_mfma_f32_16x16x32_bf16 v[92:95], a[64:67], a[156:159], v[92:95]
    s_waitcnt lgkmcnt(4)
    v_mfma_f32_16x16x32_bf16 v[108:111], a[72:75], a[156:159], v[108:111]
    ds_read_b128 a[64:67], v40 offset:57344
    v_mfma_f32_16x16x32_bf16 v[108:111], a[76:79], a[12:15], v[108:111]
    buffer_load_dwordx4 a[192:195], v1, s[4:7], s63 offen offset:0 sc1
    v_mfma_f32_16x16x32_bf16 v[104:107], a[76:79], a[8:11], v[104:107]
    s_add_u32 s19, s19, s0
    s_add_u32 s96, s19, 0
    v_mfma_f32_16x16x32_bf16 v[104:107], a[72:75], a[152:155], v[104:107]
    ds_read_b128 a[68:71], v41 offset:57344
    v_mfma_f32_16x16x32_bf16 v[100:103], a[72:75], a[148:151], v[100:103]
    buffer_load_dwordx4 a[196:199], v1, s[4:7], s63 offen offset:1024 sc1
    v_mfma_f32_16x16x32_bf16 v[100:103], a[76:79], a[4:7], v[100:103]
    s_add_u32 s18, s15, 2
    s_and_b32 s18, s18, 3
    v_mfma_f32_16x16x32_bf16 v[96:99], a[76:79], a[0:3], v[96:99]
    v_mfma_f32_16x16x32_bf16 v[96:99], a[72:75], a[144:147], v[96:99]
    s_waitcnt lgkmcnt(4)
    v_mfma_f32_16x16x32_bf16 v[112:115], a[80:83], a[144:147], v[112:115]
    ds_read_b128 a[72:75], v40 offset:59392
    v_mfma_f32_16x16x32_bf16 v[112:115], a[84:87], a[0:3], v[112:115]
    buffer_load_dwordx4 a[200:203], v1, s[4:7], s63 offen offset:2048 sc1
    v_mfma_f32_16x16x32_bf16 v[116:119], a[84:87], a[4:7], v[116:119]
    s_sub_u32 s19, s18, s15
    s_mul_i32 s19, s19, 393216
    v_mfma_f32_16x16x32_bf16 v[116:119], a[80:83], a[148:151], v[116:119]
    ds_read_b128 a[76:79], v41 offset:59392
    v_mfma_f32_16x16x32_bf16 v[120:123], a[80:83], a[152:155], v[120:123]
    buffer_load_dwordx4 a[204:207], v1, s[4:7], s63 offen offset:3072 sc1
    v_mfma_f32_16x16x32_bf16 v[120:123], a[84:87], a[8:11], v[120:123]
    s_add_u32 s19, s19, s0
    s_add_u32 s97, s19, 4096
    v_mfma_f32_16x16x32_bf16 v[124:127], a[84:87], a[12:15], v[124:127]
    s_add_u32 s18, s15, 3
    s_and_b32 s18, s18, 3
    v_mfma_f32_16x16x32_bf16 v[124:127], a[80:83], a[156:159], v[124:127]
    s_waitcnt lgkmcnt(4)
    v_mfma_f32_16x16x32_bf16 v[140:143], a[88:91], a[156:159], v[140:143]
    ds_read_b128 a[80:83], v40 offset:61440
    v_mfma_f32_16x16x32_bf16 v[140:143], a[92:95], a[12:15], v[140:143]
    s_add_u32 s63, s70, 0x101000
    v_mfma_f32_16x16x32_bf16 v[136:139], a[92:95], a[8:11], v[136:139]
    buffer_load_dwordx4 a[208:211], v1, s[4:7], s63 offen offset:0 sc1
    v_mfma_f32_16x16x32_bf16 v[136:139], a[88:91], a[152:155], v[136:139]
    ds_read_b128 a[84:87], v41 offset:61440
    v_mfma_f32_16x16x32_bf16 v[132:135], a[88:91], a[148:151], v[132:135]
    s_sub_u32 s19, s18, s15
    s_mul_i32 s19, s19, 393216
    v_mfma_f32_16x16x32_bf16 v[132:135], a[92:95], a[4:7], v[132:135]
    v_mfma_f32_16x16x32_bf16 v[128:131], a[92:95], a[0:3], v[128:131]
    buffer_load_dwordx4 a[212:215], v1, s[4:7], s63 offen offset:1024 sc1
    v_mfma_f32_16x16x32_bf16 v[128:131], a[88:91], a[144:147], v[128:131]
    s_waitcnt lgkmcnt(4)
    v_mfma_f32_16x16x32_bf16 v[160:163], a[64:67], a[144:147], v[160:163]
    ds_read_b128 a[88:91], v40 offset:63488
    v_mfma_f32_16x16x32_bf16 v[160:163], a[68:71], a[0:3], v[160:163]
    s_add_u32 s19, s19, s0
    s_add_u32 s98, s19, 8192
    v_mfma_f32_16x16x32_bf16 v[164:167], a[68:71], a[4:7], v[164:167]
    buffer_load_dwordx4 a[216:219], v1, s[4:7], s63 offen offset:2048 sc1
    v_mfma_f32_16x16x32_bf16 v[164:167], a[64:67], a[148:151], v[164:167]
    ds_read_b128 a[92:95], v41 offset:63488
    v_mfma_f32_16x16x32_bf16 v[168:171], a[64:67], a[152:155], v[168:171]
    v_cmp_eq_u32 vcc, 0, v0
    v_mfma_f32_16x16x32_bf16 v[168:171], a[68:71], a[8:11], v[168:171]
    v_mfma_f32_16x16x32_bf16 v[172:175], a[68:71], a[12:15], v[172:175]
    buffer_load_dwordx4 a[220:223], v1, s[4:7], s63 offen offset:3072 sc1
    s_add_u32 s18, s15, 1
    s_and_b32 s18, s18, 3
    v_mfma_f32_16x16x32_bf16 v[172:175], a[64:67], a[156:159], v[172:175]
    s_barrier
    s_waitcnt lgkmcnt(4)
    v_mfma_f32_16x16x32_bf16 v[204:207], a[72:75], a[156:159], v[204:207]
    ds_read_b64_tr_b16 a[64:65], v32 offset:16384
    v_mfma_f32_16x16x32_bf16 v[204:207], a[76:79], a[12:15], v[204:207]
    ds_read_b64_tr_b16 a[66:67], v32 offset:20480
    s_sub_u32 s19, s18, s15
    s_lshl_b32 s19, s19, 17
    v_mfma_f32_16x16x32_bf16 v[200:203], a[76:79], a[8:11], v[200:203]
    s_add_u32 s62, s77, 0x120000
    v_mfma_f32_16x16x32_bf16 v[200:203], a[72:75], a[152:155], v[200:203]
    ds_read_b64_tr_b16 a[68:69], v32 offset:24576
    v_mfma_f32_16x16x32_bf16 v[196:199], a[72:75], a[148:151], v[196:199]
    s_add_u32 m0, s59, 0x10e000
    v_mfma_f32_16x16x32_bf16 v[196:199], a[76:79], a[4:7], v[196:199]
    ds_read_b64_tr_b16 a[70:71], v32 offset:28672
    s_add_u32 s71, s92, s19
    v_mfma_f32_16x16x32_bf16 v[192:195], a[76:79], a[0:3], v[192:195]
    buffer_load_dwordx4 v24, s[32:35], s62 offen offset:0  lds
    v_mfma_f32_16x16x32_bf16 v[192:195], a[72:75], a[144:147], v[192:195]
    s_waitcnt lgkmcnt(6)
    v_mfma_f32_16x16x32_bf16 v[224:227], a[80:83], a[144:147], v[224:227]
    ds_read_b64_tr_b16 a[72:73], v33 offset:16384
    v_mfma_f32_16x16x32_bf16 v[224:227], a[84:87], a[0:3], v[224:227]
    ds_read_b64_tr_b16 a[74:75], v33 offset:20480
    s_add_u32 s18, s15, 2
    s_and_b32 s18, s18, 3
    v_mfma_f32_16x16x32_bf16 v[228:231], a[84:87], a[4:7], v[228:231]
    buffer_load_dwordx4 v25, s[32:35], s62 offen offset:1024  lds
    v_mfma_f32_16x16x32_bf16 v[228:231], a[80:83], a[148:151], v[228:231]
    ds_read_b64_tr_b16 a[76:77], v33 offset:24576
    v_mfma_f32_16x16x32_bf16 v[232:235], a[80:83], a[152:155], v[232:235]
    s_add_u32 s62, s85, 0x280000
    v_mfma_f32_16x16x32_bf16 v[232:235], a[84:87], a[8:11], v[232:235]
    ds_read_b64_tr_b16 a[78:79], v33 offset:28672
    s_sub_u32 s19, s18, s15
    s_lshl_b32 s19, s19, 17
    v_mfma_f32_16x16x32_bf16 v[236:239], a[84:87], a[12:15], v[236:239]
    s_add_u32 m0, s59, 0x102000
    v_mfma_f32_16x16x32_bf16 v[236:239], a[80:83], a[156:159], v[236:239]
    s_waitcnt lgkmcnt(8)
    v_mfma_f32_16x16x32_bf16 v[252:255], a[88:91], a[156:159], v[252:255]
    ds_read_b64_tr_b16 a[80:81], v34 offset:16384
    v_mfma_f32_16x16x32_bf16 v[252:255], a[92:95], a[12:15], v[252:255]
    ds_read_b64_tr_b16 a[82:83], v34 offset:20480
    s_add_u32 s72, s92, s19
    v_mfma_f32_16x16x32_bf16 v[248:251], a[92:95], a[8:11], v[248:251]
    buffer_load_dwordx4 v26, s[32:35], s62 offen offset:0  lds
    v_mfma_f32_16x16x32_bf16 v[248:251], a[88:91], a[152:155], v[248:251]
    ds_read_b64_tr_b16 a[84:85], v34 offset:24576
    v_mfma_f32_16x16x32_bf16 v[244:247], a[88:91], a[148:151], v[244:247]
    buffer_load_dwordx4 v27, s[32:35], s62 offen offset:1024  lds
    s_add_u32 s18, s15, 3
    s_and_b32 s18, s18, 3
    v_mfma_f32_16x16x32_bf16 v[244:247], a[92:95], a[4:7], v[244:247]
    ds_read_b64_tr_b16 a[86:87], v34 offset:28672
    v_mfma_f32_16x16x32_bf16 v[240:243], a[92:95], a[0:3], v[240:243]
    s_add_u32 s63, s70, 0x102000
    v_mfma_f32_16x16x32_bf16 v[240:243], a[88:91], a[144:147], v[240:243]
    s_waitcnt vmcnt(28)
    s_waitcnt lgkmcnt(8)
    v_mfma_f32_16x16x32_bf16 v[80:83], a[64:67], a[160:163], v[80:83]
    ds_read_b64_tr_b16 a[88:89], v35 offset:16384
    s_sub_u32 s19, s18, s15
    s_lshl_b32 s19, s19, 17
    v_mfma_f32_16x16x32_bf16 v[80:83], a[68:71], a[16:19], v[80:83]
    ds_read_b64_tr_b16 a[90:91], v35 offset:20480
    v_mfma_f32_16x16x32_bf16 v[84:87], a[68:71], a[20:23], v[84:87]
    buffer_load_dwordx4 a[32:35], v1, s[4:7], s63 offen offset:0 sc1
    v_mfma_f32_16x16x32_bf16 v[84:87], a[64:67], a[164:167], v[84:87]
    ds_read_b64_tr_b16 a[92:93], v35 offset:24576
    v_mfma_f32_16x16x32_bf16 v[88:91], a[64:67], a[168:171], v[88:91]
    buffer_load_dwordx4 a[36:39], v1, s[4:7], s63 offen offset:1024 sc1
    v_mfma_f32_16x16x32_bf16 v[88:91], a[68:71], a[24:27], v[88:91]
    ds_read_b64_tr_b16 a[94:95], v35 offset:28672
    v_mfma_f32_16x16x32_bf16 v[92:95], a[68:71], a[28:31], v[92:95]
    s_add_u32 s73, s92, s19
    v_mfma_f32_16x16x32_bf16 v[92:95], a[64:67], a[172:175], v[92:95]
    s_waitcnt lgkmcnt(8)
    v_mfma_f32_16x16x32_bf16 v[108:111], a[72:75], a[172:175], v[108:111]
    ds_read_b64_tr_b16 a[64:65], v36 offset:16384
    v_cndmask_b32 v4, v59, v0, vcc
    v_mfma_f32_16x16x32_bf16 v[108:111], a[76:79], a[28:31], v[108:111]
    ds_read_b64_tr_b16 a[66:67], v36 offset:20480
    v_mfma_f32_16x16x32_bf16 v[104:107], a[76:79], a[24:27], v[104:107]
    buffer_load_dwordx4 a[40:43], v1, s[4:7], s63 offen offset:2048 sc1
    v_mfma_f32_16x16x32_bf16 v[104:107], a[72:75], a[168:171], v[104:107]
    ds_read_b64_tr_b16 a[68:69], v36 offset:24576
    v_mfma_f32_16x16x32_bf16 v[100:103], a[72:75], a[164:167], v[100:103]
    buffer_load_dwordx4 a[44:47], v1, s[4:7], s63 offen offset:3072 sc1
    v_mfma_f32_16x16x32_bf16 v[100:103], a[76:79], a[20:23], v[100:103]
    ds_read_b64_tr_b16 a[70:71], v36 offset:28672
    v_mfma_f32_16x16x32_bf16 v[96:99], a[76:79], a[16:19], v[96:99]
    s_add_u32 s57, s0, 4096
    v_mfma_f32_16x16x32_bf16 v[96:99], a[72:75], a[160:163], v[96:99]
    s_waitcnt lgkmcnt(8)
    v_mfma_f32_16x16x32_bf16 v[112:115], a[80:83], a[160:163], v[112:115]
    ds_read_b64_tr_b16 a[72:73], v37 offset:16384
    s_add_u32 s58, s0, 8192
    v_mfma_f32_16x16x32_bf16 v[112:115], a[84:87], a[16:19], v[112:115]
    ds_read_b64_tr_b16 a[74:75], v37 offset:20480
    v_mfma_f32_16x16x32_bf16 v[116:119], a[84:87], a[20:23], v[116:119]
    s_add_u32 s63, s84, 0x124000
    v_mfma_f32_16x16x32_bf16 v[116:119], a[80:83], a[164:167], v[116:119]
    ds_read_b64_tr_b16 a[76:77], v37 offset:24576
    v_mfma_f32_16x16x32_bf16 v[120:123], a[80:83], a[168:171], v[120:123]
    buffer_load_dwordx4 a[112:115], v1, s[4:7], s63 offen offset:0 sc1
    v_mfma_f32_16x16x32_bf16 v[120:123], a[84:87], a[24:27], v[120:123]
    ds_read_b64_tr_b16 a[78:79], v37 offset:28672
    v_mfma_f32_16x16x32_bf16 v[124:127], a[84:87], a[28:31], v[124:127]
    s_mov_b32 s64, 0
    s_mov_b32 s74, 0
    v_mfma_f32_16x16x32_bf16 v[124:127], a[80:83], a[172:175], v[124:127]
    s_mov_b32 s65, 0x4000
    s_waitcnt lgkmcnt(8)
    v_mfma_f32_16x16x32_bf16 v[140:143], a[88:91], a[172:175], v[140:143]
    ds_read_b64_tr_b16 a[80:81], v38 offset:16384
    v_mfma_f32_16x16x32_bf16 v[140:143], a[92:95], a[28:31], v[140:143]
    ds_read_b64_tr_b16 a[82:83], v38 offset:20480
    v_mfma_f32_16x16x32_bf16 v[136:139], a[92:95], a[24:27], v[136:139]
    buffer_load_dwordx4 a[116:119], v1, s[4:7], s63 offen offset:1024 sc1
    v_mfma_f32_16x16x32_bf16 v[136:139], a[88:91], a[168:171], v[136:139]
    ds_read_b64_tr_b16 a[84:85], v38 offset:24576
    v_mfma_f32_16x16x32_bf16 v[132:135], a[88:91], a[164:167], v[132:135]
    buffer_load_dwordx4 a[120:123], v1, s[4:7], s63 offen offset:2048 sc1
    v_mfma_f32_16x16x32_bf16 v[132:135], a[92:95], a[20:23], v[132:135]
    ds_read_b64_tr_b16 a[86:87], v38 offset:28672
    v_mfma_f32_16x16x32_bf16 v[128:131], a[92:95], a[16:19], v[128:131]
    s_mov_b32 s66, 0x8000
    v_mfma_f32_16x16x32_bf16 v[128:131], a[88:91], a[160:163], v[128:131]
    s_mov_b32 s67, 0xc000
    s_waitcnt lgkmcnt(8)
    v_mfma_f32_16x16x32_bf16 v[160:163], a[64:67], a[160:163], v[160:163]
    ds_read_b64_tr_b16 a[88:89], v39 offset:16384
    v_mfma_f32_16x16x32_bf16 v[160:163], a[68:71], a[16:19], v[160:163]
    ds_read_b64_tr_b16 a[90:91], v39 offset:20480
    v_mfma_f32_16x16x32_bf16 v[164:167], a[68:71], a[20:23], v[164:167]
    buffer_load_dwordx4 a[124:127], v1, s[4:7], s63 offen offset:3072 sc1
    v_mfma_f32_16x16x32_bf16 v[164:167], a[64:67], a[164:167], v[164:167]
    ds_read_b64_tr_b16 a[92:93], v39 offset:24576
    v_bfe_u32 v68, v0, 2, 2
    v_mfma_f32_16x16x32_bf16 v[168:171], a[64:67], a[168:171], v[168:171]
    s_add_u32 m0, s60, 0x10c000
    v_mfma_f32_16x16x32_bf16 v[168:171], a[68:71], a[24:27], v[168:171]
    ds_read_b64_tr_b16 a[94:95], v39 offset:28672
    v_mfma_f32_16x16x32_bf16 v[172:175], a[68:71], a[28:31], v[172:175]
    buffer_load_dwordx4 v28, s[40:43], s82 offen offset:0  lds
    v_lshrrev_b32 v69, 4, v0
    v_mfma_f32_16x16x32_bf16 v[172:175], a[64:67], a[172:175], v[172:175]
    s_waitcnt vmcnt(33)
    s_barrier
    s_waitcnt lgkmcnt(8)
    v_mfma_f32_16x16x32_bf16 v[204:207], a[72:75], a[172:175], v[204:207]
    ds_read_b64_tr_b16 a[64:65], v32 offset:32768
    v_mfma_f32_16x16x32_bf16 v[204:207], a[76:79], a[28:31], v[204:207]
    ds_read_b64_tr_b16 a[66:67], v32 offset:36864
    v_mfma_f32_16x16x32_bf16 v[200:203], a[76:79], a[24:27], v[200:203]
    buffer_load_dwordx4 v29, s[40:43], s82 offen offset:1024  lds
    v_mfma_f32_16x16x32_bf16 v[200:203], a[72:75], a[168:171], v[200:203]
    ds_read_b64_tr_b16 a[68:69], v32 offset:0
    v_mfma_f32_16x16x32_bf16 v[196:199], a[72:75], a[164:167], v[196:199]
    v_cmp_eq_u32 vcc, v68, v69
    v_mfma_f32_16x16x32_bf16 v[196:199], a[76:79], a[20:23], v[196:199]
    ds_read_b64_tr_b16 a[70:71], v32 offset:4096
    v_mfma_f32_16x16x32_bf16 v[192:195], a[76:79], a[16:19], v[192:195]
    s_add_u32 m0, s60, 0x10c000
    v_and_b32 v68, 1, v0
    v_mfma_f32_16x16x32_bf16 v[192:195], a[72:75], a[160:163], v[192:195]
    s_waitcnt lgkmcnt(8)
    v_mfma_f32_16x16x32_bf16 v[224:227], a[80:83], a[160:163], v[224:227]
    ds_read_b64_tr_b16 a[72:73], v33 offset:32768
    v_mfma_f32_16x16x32_bf16 v[224:227], a[84:87], a[16:19], v[224:227]
    ds_read_b64_tr_b16 a[74:75], v33 offset:36864
    v_mfma_f32_16x16x32_bf16 v[228:231], a[84:87], a[20:23], v[228:231]
    buffer_load_dwordx4 v30, s[40:43], s82 offen offset:2048  lds
    v_lshlrev_b32 v68, 4, v68
    v_mfma_f32_16x16x32_bf16 v[228:231], a[80:83], a[164:167], v[228:231]
    ds_read_b64_tr_b16 a[76:77], v33 offset:0
    v_mfma_f32_16x16x32_bf16 v[232:235], a[80:83], a[168:171], v[232:235]
    buffer_load_dwordx4 v31, s[40:43], s82 offen offset:3072  lds
    v_mfma_f32_16x16x32_bf16 v[232:235], a[84:87], a[24:27], v[232:235]
    ds_read_b64_tr_b16 a[78:79], v33 offset:4096
    v_mfma_f32_16x16x32_bf16 v[236:239], a[84:87], a[28:31], v[236:239]
    s_add_u32 m0, s60, 0x110000
    v_mov_b32 v69, 0x3f80
    v_mfma_f32_16x16x32_bf16 v[236:239], a[80:83], a[172:175], v[236:239]
    s_waitcnt lgkmcnt(8)
    v_mfma_f32_16x16x32_bf16 v[252:255], a[88:91], a[172:175], v[252:255]
    ds_read_b64_tr_b16 a[80:81], v34 offset:32768
    v_mfma_f32_16x16x32_bf16 v[252:255], a[92:95], a[28:31], v[252:255]
    ds_read_b64_tr_b16 a[82:83], v34 offset:36864
    v_lshlrev_b32 v68, v68, v69
    v_mfma_f32_16x16x32_bf16 v[248:251], a[92:95], a[24:27], v[248:251]
    buffer_load_dwordx4 v28, s[36:39], s83 offen offset:0  lds
    v_mfma_f32_16x16x32_bf16 v[248:251], a[88:91], a[168:171], v[248:251]
    ds_read_b64_tr_b16 a[84:85], v34 offset:0
    v_mfma_f32_16x16x32_bf16 v[244:247], a[88:91], a[164:167], v[244:247]
    buffer_load_dwordx4 v29, s[36:39], s83 offen offset:1024  lds
    v_mfma_f32_16x16x32_bf16 v[244:247], a[92:95], a[20:23], v[244:247]
    ds_read_b64_tr_b16 a[86:87], v34 offset:4096
    v_mfma_f32_16x16x32_bf16 v[240:243], a[92:95], a[16:19], v[240:243]
    v_cndmask_b32 v68, 0, v68, vcc
    v_mfma_f32_16x16x32_bf16 v[240:243], a[88:91], a[160:163], v[240:243]
    s_waitcnt vmcnt(30)
    s_waitcnt lgkmcnt(8)
    v_mfma_f32_16x16x32_bf16 v[80:83], a[64:67], a[176:179], v[80:83]
    ds_read_b64_tr_b16 a[88:89], v35 offset:32768
    v_mfma_f32_16x16x32_bf16 v[80:83], a[68:71], a[96:99], v[80:83]
    ds_read_b64_tr_b16 a[90:91], v35 offset:36864
    v_and_b32 v69, 2, v0
    v_mfma_f32_16x16x32_bf16 v[84:87], a[68:71], a[100:103], v[84:87]
    s_add_u32 m0, s60, 0x110000
    v_mfma_f32_16x16x32_bf16 v[84:87], a[64:67], a[180:183], v[84:87]
    ds_read_b64_tr_b16 a[92:93], v35 offset:0
    v_mfma_f32_16x16x32_bf16 v[88:91], a[64:67], a[184:187], v[88:91]
    buffer_load_dwordx4 v30, s[36:39], s83 offen offset:2048  lds
    v_mfma_f32_16x16x32_bf16 v[88:91], a[68:71], a[104:107], v[88:91]
    ds_read_b64_tr_b16 a[94:95], v35 offset:4096
    v_cmp_eq_u32 vcc, 0, v69
    v_mfma_f32_16x16x32_bf16 v[92:95], a[68:71], a[108:111], v[92:95]
    buffer_load_dwordx4 v31, s[36:39], s83 offen offset:3072  lds
    v_mfma_f32_16x16x32_bf16 v[92:95], a[64:67], a[188:191], v[92:95]
    s_waitcnt lgkmcnt(8)
    v_mfma_f32_16x16x32_bf16 v[108:111], a[72:75], a[188:191], v[108:111]
    ds_read_b64_tr_b16 a[64:65], v36 offset:32768
    v_mfma_f32_16x16x32_bf16 v[108:111], a[76:79], a[108:111], v[108:111]
    ds_read_b64_tr_b16 a[66:67], v36 offset:36864
    v_mov_b32 v62, 0
    v_mfma_f32_16x16x32_bf16 v[104:107], a[76:79], a[104:107], v[104:107]
    s_add_u32 m0, s60, 0x114000
    v_mfma_f32_16x16x32_bf16 v[104:107], a[72:75], a[184:187], v[104:107]
    ds_read_b64_tr_b16 a[68:69], v36 offset:0
    v_mfma_f32_16x16x32_bf16 v[100:103], a[72:75], a[180:183], v[100:103]
    buffer_load_dwordx4 v28, s[40:43], s83 offen offset:0  lds
    v_mfma_f32_16x16x32_bf16 v[100:103], a[76:79], a[100:103], v[100:103]
    ds_read_b64_tr_b16 a[70:71], v36 offset:4096
    v_mfma_f32_16x16x32_bf16 v[96:99], a[76:79], a[96:99], v[96:99]
    v_mov_b32 v63, 0
    v_mfma_f32_16x16x32_bf16 v[96:99], a[72:75], a[176:179], v[96:99]
    s_waitcnt lgkmcnt(8)
    v_mfma_f32_16x16x32_bf16 v[112:115], a[80:83], a[176:179], v[112:115]
    ds_read_b64_tr_b16 a[72:73], v37 offset:32768
    v_mov_b32 v66, 0
    v_mfma_f32_16x16x32_bf16 v[112:115], a[84:87], a[96:99], v[112:115]
L_hop_10:
    s_cbranch_execz L_hop_done
    s_nop 0
    ds_read_b64_tr_b16 a[74:75], v37 offset:36864
    v_mfma_f32_16x16x32_bf16 v[116:119], a[84:87], a[100:103], v[116:119]
    buffer_load_dwordx4 v29, s[40:43], s83 offen offset:1024  lds
    v_mfma_f32_16x16x32_bf16 v[116:119], a[80:83], a[180:183], v[116:119]
    ds_read_b64_tr_b16 a[76:77], v37 offset:0
    v_mfma_f32_16x16x32_bf16 v[120:123], a[80:83], a[184:187], v[120:123]
    s_add_u32 m0, s60, 0x114000
    v_mov_b32 v67, 0
    v_mfma_f32_16x16x32_bf16 v[120:123], a[84:87], a[104:107], v[120:123]
    ds_read_b64_tr_b16 a[78:79], v37 offset:4096
    v_mfma_f32_16x16x32_bf16 v[124:127], a[84:87], a[108:111], v[124:127]
    buffer_load_dwordx4 v30, s[40:43], s83 offen offset:2048  lds
    v_mfma_f32_16x16x32_bf16 v[124:127], a[80:83], a[188:191], v[124:127]
    s_waitcnt lgkmcnt(8)
    v_mfma_f32_16x16x32_bf16 v[140:143], a[88:91], a[188:191], v[140:143]
    ds_read_b64_tr_b16 a[80:81], v38 offset:32768
    v_mfma_f32_16x16x32_bf16 v[140:143], a[92:95], a[108:111], v[140:143]
    ds_read_b64_tr_b16 a[82:83], v38 offset:36864
    v_mfma_f32_16x16x32_bf16 v[136:139], a[92:95], a[104:107], v[136:139]
    buffer_load_dwordx4 v31, s[40:43], s83 offen offset:3072  lds
    v_mfma_f32_16x16x32_bf16 v[136:139], a[88:91], a[184:187], v[136:139]
    ds_read_b64_tr_b16 a[84:85], v38 offset:0
    v_mfma_f32_16x16x32_bf16 v[132:135], a[88:91], a[180:183], v[132:135]
    v_cndmask_b32 v64, 0, v68, vcc
    v_mfma_f32_16x16x32_bf16 v[132:135], a[92:95], a[100:103], v[132:135]
    ds_read_b64_tr_b16 a[86:87], v38 offset:4096
    v_sub_u32 v65, v68, v64
    v_mfma_f32_16x16x32_bf16 v[128:131], a[92:95], a[96:99], v[128:131]
    s_add_u32 s63, s79, 0x107000
    v_mfma_f32_16x16x32_bf16 v[128:131], a[88:91], a[176:179], v[128:131]
    s_waitcnt lgkmcnt(8)
    v_mfma_f32_16x16x32_bf16 v[160:163], a[64:67], a[176:179], v[160:163]
    ds_read_b64_tr_b16 a[88:89], v39 offset:32768
    v_mfma_f32_16x16x32_bf16 v[160:163], a[68:71], a[96:99], v[160:163]
    ds_read_b64_tr_b16 a[90:91], v39 offset:36864
    v_mfma_f32_16x16x32_bf16 v[164:167], a[68:71], a[100:103], v[164:167]
    buffer_load_dwordx4 a[128:131], v1, s[4:7], s63 offen offset:0 sc1
    v_mfma_f32_16x16x32_bf16 v[164:167], a[64:67], a[180:183], v[164:167]
    ds_read_b64_tr_b16 a[92:93], v39 offset:0
    v_mfma_f32_16x16x32_bf16 v[168:171], a[64:67], a[184:187], v[168:171]
    buffer_load_dwordx4 a[132:135], v1, s[4:7], s63 offen offset:1024 sc1
    v_mfma_f32_16x16x32_bf16 v[168:171], a[68:71], a[104:107], v[168:171]
    ds_read_b64_tr_b16 a[94:95], v39 offset:4096
    v_mfma_f32_16x16x32_bf16 v[172:175], a[68:71], a[108:111], v[172:175]
    v_mfma_f32_16x16x32_bf16 v[172:175], a[64:67], a[188:191], v[172:175]
    s_waitcnt vmcnt(34)
    s_barrier
    s_waitcnt lgkmcnt(8)
    v_mfma_f32_16x16x32_bf16 v[204:207], a[72:75], a[188:191], v[204:207]
    ds_read_b64_tr_b16 a[64:65], v32 offset:40960
    v_mfma_f32_16x16x32_bf16 v[204:207], a[76:79], a[108:111], v[204:207]
    ds_read_b64_tr_b16 a[66:67], v32 offset:45056
    v_mfma_f32_16x16x32_bf16 v[200:203], a[76:79], a[104:107], v[200:203]
    buffer_load_dwordx4 a[136:139], v1, s[4:7], s63 offen offset:2048 sc1
    v_mfma_f32_16x16x32_bf16 v[200:203], a[72:75], a[184:187], v[200:203]
    ds_read_b64_tr_b16 a[68:69], v32 offset:49152
    v_mfma_f32_16x16x32_bf16 v[196:199], a[72:75], a[180:183], v[196:199]
    buffer_load_dwordx4 a[140:143], v1, s[4:7], s63 offen offset:3072 sc1
    v_mfma_f32_16x16x32_bf16 v[196:199], a[76:79], a[100:103], v[196:199]
    ds_read_b64_tr_b16 a[70:71], v32 offset:53248
    v_mfma_f32_16x16x32_bf16 v[192:195], a[76:79], a[96:99], v[192:195]
    v_mfma_f32_16x16x32_bf16 v[192:195], a[72:75], a[176:179], v[192:195]
    s_waitcnt lgkmcnt(8)
    v_mfma_f32_16x16x32_bf16 v[224:227], a[80:83], a[176:179], v[224:227]
    ds_read_b64_tr_b16 a[72:73], v33 offset:40960
    s_lshl_b32 s18, s16, 13
    s_add_u32 s18, s18, 114688
    v_mfma_f32_16x16x32_bf16 v[224:227], a[84:87], a[96:99], v[224:227]
    ds_read_b64_tr_b16 a[74:75], v33 offset:45056
    v_mfma_f32_16x16x32_bf16 v[228:231], a[84:87], a[100:103], v[228:231]
    s_add_u32 s63, s79, 0x108000
    v_mfma_f32_16x16x32_bf16 v[228:231], a[80:83], a[180:183], v[228:231]
    ds_read_b64_tr_b16 a[76:77], v33 offset:49152
    v_mfma_f32_16x16x32_bf16 v[232:235], a[80:83], a[184:187], v[232:235]
    buffer_load_dwordx4 a[48:51], v1, s[4:7], s63 offen offset:0 sc1
    v_mfma_f32_16x16x32_bf16 v[232:235], a[84:87], a[104:107], v[232:235]
    ds_read_b64_tr_b16 a[78:79], v33 offset:53248
    v_mfma_f32_16x16x32_bf16 v[236:239], a[84:87], a[108:111], v[236:239]
    v_add_u32 v77, s18, v1
    v_mfma_f32_16x16x32_bf16 v[236:239], a[80:83], a[188:191], v[236:239]
    s_waitcnt lgkmcnt(8)
    v_mfma_f32_16x16x32_bf16 v[252:255], a[88:91], a[188:191], v[252:255]
    ds_read_b64_tr_b16 a[80:81], v34 offset:40960
    v_and_b32 v72, 15, v0
    v_mfma_f32_16x16x32_bf16 v[252:255], a[92:95], a[108:111], v[252:255]
    ds_read_b64_tr_b16 a[82:83], v34 offset:45056
    v_mfma_f32_16x16x32_bf16 v[248:251], a[92:95], a[104:107], v[248:251]
    buffer_load_dwordx4 a[52:55], v1, s[4:7], s63 offen offset:1024 sc1
    v_mfma_f32_16x16x32_bf16 v[248:251], a[88:91], a[184:187], v[248:251]
    ds_read_b64_tr_b16 a[84:85], v34 offset:49152
    v_mfma_f32_16x16x32_bf16 v[244:247], a[88:91], a[180:183], v[244:247]
    buffer_load_dwordx4 a[56:59], v1, s[4:7], s63 offen offset:2048 sc1
    v_mfma_f32_16x16x32_bf16 v[244:247], a[92:95], a[100:103], v[244:247]
    ds_read_b64_tr_b16 a[86:87], v34 offset:53248
    v_mfma_f32_16x16x32_bf16 v[240:243], a[92:95], a[96:99], v[240:243]
    v_lshrrev_b32 v73, 4, v0
    v_mfma_f32_16x16x32_bf16 v[240:243], a[88:91], a[176:179], v[240:243]
    s_waitcnt vmcnt(31)
    s_waitcnt lgkmcnt(8)
    v_mfma_f32_16x16x32_bf16 v[80:83], a[64:67], a[192:195], v[80:83]
    ds_read_b64_tr_b16 a[88:89], v35 offset:40960
    v_and_b32 v74, 7, v0
    v_mfma_f32_16x16x32_bf16 v[80:83], a[68:71], a[208:211], v[80:83]
    ds_read_b64_tr_b16 a[90:91], v35 offset:45056
    v_mfma_f32_16x16x32_bf16 v[84:87], a[68:71], a[212:215], v[84:87]
    buffer_load_dwordx4 a[60:63], v1, s[4:7], s63 offen offset:3072 sc1
    v_mfma_f32_16x16x32_bf16 v[84:87], a[64:67], a[196:199], v[84:87]
    ds_read_b64_tr_b16 a[92:93], v35 offset:49152
    v_mfma_f32_16x16x32_bf16 v[88:91], a[64:67], a[200:203], v[88:91]
    s_add_u32 s63, s79, 0x109000
    v_mfma_f32_16x16x32_bf16 v[88:91], a[68:71], a[216:219], v[88:91]
    ds_read_b64_tr_b16 a[94:95], v35 offset:53248
    v_xor_b32 v73, v73, v74
    v_mfma_f32_16x16x32_bf16 v[92:95], a[68:71], a[220:223], v[92:95]
    buffer_load_dwordx4 a[144:147], v1, s[4:7], s63 offen offset:0 sc1
    v_mfma_f32_16x16x32_bf16 v[92:95], a[64:67], a[204:207], v[92:95]
    s_waitcnt lgkmcnt(8)
    v_mfma_f32_16x16x32_bf16 v[108:111], a[72:75], a[204:207], v[108:111]
    ds_read_b64_tr_b16 a[64:65], v36 offset:40960
    v_mfma_f32_16x16x32_bf16 v[108:111], a[76:79], a[220:223], v[108:111]
    ds_read_b64_tr_b16 a[66:67], v36 offset:45056
    v_mfma_f32_16x16x32_bf16 v[104:107], a[76:79], a[216:219], v[104:107]
    buffer_load_dwordx4 a[148:151], v1, s[4:7], s63 offen offset:1024 sc1
    v_mfma_f32_16x16x32_bf16 v[104:107], a[72:75], a[200:203], v[104:107]
    ds_read_b64_tr_b16 a[68:69], v36 offset:49152
    v_mfma_f32_16x16x32_bf16 v[100:103], a[72:75], a[196:199], v[100:103]
    v_lshl_add_u32 v72, v72, 7, s18
    v_mfma_f32_16x16x32_bf16 v[100:103], a[76:79], a[212:215], v[100:103]
    ds_read_b64_tr_b16 a[70:71], v36 offset:53248
    v_lshl_add_u32 v75, v73, 4, v72
    v_mfma_f32_16x16x32_bf16 v[96:99], a[76:79], a[208:211], v[96:99]
    buffer_load_dwordx4 a[152:155], v1, s[4:7], s63 offen offset:2048 sc1
    v_mfma_f32_16x16x32_bf16 v[96:99], a[72:75], a[192:195], v[96:99]
    s_waitcnt lgkmcnt(8)
    v_mfma_f32_16x16x32_bf16 v[112:115], a[80:83], a[192:195], v[112:115]
    ds_read_b64_tr_b16 a[72:73], v37 offset:40960
    v_mfma_f32_16x16x32_bf16 v[112:115], a[84:87], a[208:211], v[112:115]
    ds_read_b64_tr_b16 a[74:75], v37 offset:45056
    v_mfma_f32_16x16x32_bf16 v[116:119], a[84:87], a[212:215], v[116:119]
    buffer_load_dwordx4 a[156:159], v1, s[4:7], s63 offen offset:3072 sc1
    v_mfma_f32_16x16x32_bf16 v[116:119], a[80:83], a[196:199], v[116:119]
    ds_read_b64_tr_b16 a[76:77], v37 offset:49152
    v_mfma_f32_16x16x32_bf16 v[120:123], a[80:83], a[200:203], v[120:123]
    v_xor_b32 v76, 64, v75
    v_mfma_f32_16x16x32_bf16 v[120:123], a[84:87], a[216:219], v[120:123]
    ds_read_b64_tr_b16 a[78:79], v37 offset:53248
    v_lshrrev_b32 v72, 3, v0
    v_mfma_f32_16x16x32_bf16 v[124:127], a[84:87], a[220:223], v[124:127]
    s_add_u32 s63, s79, 0x10a000
    v_mfma_f32_16x16x32_bf16 v[124:127], a[80:83], a[204:207], v[124:127]
    s_waitcnt lgkmcnt(8)
    v_mfma_f32_16x16x32_bf16 v[140:143], a[88:91], a[204:207], v[140:143]
    ds_read_b64_tr_b16 a[80:81], v38 offset:40960
    v_mfma_f32_16x16x32_bf16 v[140:143], a[92:95], a[220:223], v[140:143]
    ds_read_b64_tr_b16 a[82:83], v38 offset:45056
    v_mfma_f32_16x16x32_bf16 v[136:139], a[92:95], a[216:219], v[136:139]
    buffer_load_dwordx4 a[0:3], v1, s[4:7], s63 offen offset:0 sc1
    v_mfma_f32_16x16x32_bf16 v[136:139], a[88:91], a[200:203], v[136:139]
    ds_read_b64_tr_b16 a[84:85], v38 offset:49152
    v_mfma_f32_16x16x32_bf16 v[132:135], a[88:91], a[196:199], v[132:135]
    v_xor_b32 v74, v74, v72
    v_mfma_f32_16x16x32_bf16 v[132:135], a[92:95], a[212:215], v[132:135]
    ds_read_b64_tr_b16 a[86:87], v38 offset:53248
    v_mfma_f32_16x16x32_bf16 v[128:131], a[92:95], a[208:211], v[128:131]
    buffer_load_dwordx4 a[4:7], v1, s[4:7], s63 offen offset:1024 sc1
    s_lshl2_add_u32 s18, s14, s15
    s_lshl_b32 s18, s18, 7
    v_mfma_f32_16x16x32_bf16 v[128:131], a[88:91], a[192:195], v[128:131]
    s_waitcnt lgkmcnt(8)
    v_mfma_f32_16x16x32_bf16 v[160:163], a[64:67], a[192:195], v[160:163]
    ds_read_b64_tr_b16 a[88:89], v39 offset:40960
    v_mfma_f32_16x16x32_bf16 v[160:163], a[68:71], a[208:211], v[160:163]
    ds_read_b64_tr_b16 a[90:91], v39 offset:45056
    v_mfma_f32_16x16x32_bf16 v[164:167], a[68:71], a[212:215], v[164:167]
    buffer_load_dwordx4 a[8:11], v1, s[4:7], s63 offen offset:2048 sc1
    v_mfma_f32_16x16x32_bf16 v[164:167], a[64:67], a[196:199], v[164:167]
    ds_read_b64_tr_b16 a[92:93], v39 offset:49152
    v_mfma_f32_16x16x32_bf16 v[168:171], a[64:67], a[200:203], v[168:171]
    s_lshl_b32 s19, s3, 18
    s_add_u32 s18, s18, s19
    v_mfma_f32_16x16x32_bf16 v[168:171], a[68:71], a[216:219], v[168:171]
    ds_read_b64_tr_b16 a[94:95], v39 offset:53248
    v_mfma_f32_16x16x32_bf16 v[172:175], a[68:71], a[220:223], v[172:175]
    buffer_load_dwordx4 a[12:15], v1, s[4:7], s63 offen offset:3072 sc1
    v_lshl_add_u32 v74, v74, 4, s18
    v_mfma_f32_16x16x32_bf16 v[172:175], a[64:67], a[204:207], v[172:175]
    s_waitcnt vmcnt(36)
    s_barrier
    s_waitcnt lgkmcnt(8)
    v_mfma_f32_16x16x32_bf16 v[204:207], a[72:75], a[204:207], v[204:207]
    ds_read_b64_tr_b16 a[64:65], v32 offset:57344
    v_mfma_f32_16x16x32_bf16 v[204:207], a[76:79], a[220:223], v[204:207]
    ds_read_b64_tr_b16 a[66:67], v32 offset:61440
    v_mfma_f32_16x16x32_bf16 v[200:203], a[76:79], a[216:219], v[200:203]
    s_add_u32 s63, s80, 0x107000
    v_mfma_f32_16x16x32_bf16 v[200:203], a[72:75], a[200:203], v[200:203]
    ds_read_b64_tr_b16 a[68:69], v32 offset:8192
    v_mfma_f32_16x16x32_bf16 v[196:199], a[72:75], a[196:199], v[196:199]
    buffer_load_dwordx4 a[160:163], v1, s[4:7], s63 offen offset:0 sc1
    v_mfma_f32_16x16x32_bf16 v[196:199], a[76:79], a[212:215], v[196:199]
    ds_read_b64_tr_b16 a[70:71], v32 offset:12288
    v_mfma_f32_16x16x32_bf16 v[192:195], a[76:79], a[208:211], v[192:195]
    v_lshrrev_b32 v73, 5, v0
    v_mfma_f32_16x16x32_bf16 v[192:195], a[72:75], a[192:195], v[192:195]
    v_and_b32 v72, 3, v72
    s_waitcnt lgkmcnt(8)
    v_mfma_f32_16x16x32_bf16 v[224:227], a[80:83], a[192:195], v[224:227]
    ds_read_b64_tr_b16 a[72:73], v33 offset:57344
    v_mfma_f32_16x16x32_bf16 v[224:227], a[84:87], a[208:211], v[224:227]
    ds_read_b64_tr_b16 a[74:75], v33 offset:61440
    v_mfma_f32_16x16x32_bf16 v[228:231], a[84:87], a[212:215], v[228:231]
    buffer_load_dwordx4 a[164:167], v1, s[4:7], s63 offen offset:1024 sc1
    v_mfma_f32_16x16x32_bf16 v[228:231], a[80:83], a[196:199], v[228:231]
    ds_read_b64_tr_b16 a[76:77], v33 offset:8192
    v_mfma_f32_16x16x32_bf16 v[232:235], a[80:83], a[200:203], v[232:235]
    buffer_load_dwordx4 a[168:171], v1, s[4:7], s63 offen offset:2048 sc1
    v_mfma_f32_16x16x32_bf16 v[232:235], a[84:87], a[216:219], v[232:235]
    ds_read_b64_tr_b16 a[78:79], v33 offset:12288
    v_mfma_f32_16x16x32_bf16 v[236:239], a[84:87], a[220:223], v[236:239]
    v_lshl_add_u32 v72, v73, 4, v72
    v_mfma_f32_16x16x32_bf16 v[236:239], a[80:83], a[204:207], v[236:239]
    v_lshl_add_u32 v61, v72, 12, v74
    s_waitcnt lgkmcnt(8)
    v_mfma_f32_16x16x32_bf16 v[252:255], a[88:91], a[204:207], v[252:255]
    ds_read_b64_tr_b16 a[80:81], v34 offset:57344
    v_mfma_f32_16x16x32_bf16 v[252:255], a[92:95], a[220:223], v[252:255]
    ds_read_b64_tr_b16 a[82:83], v34 offset:61440
    v_mfma_f32_16x16x32_bf16 v[248:251], a[92:95], a[216:219], v[248:251]
    buffer_load_dwordx4 a[172:175], v1, s[4:7], s63 offen offset:3072 sc1
    v_mfma_f32_16x16x32_bf16 v[248:251], a[88:91], a[200:203], v[248:251]
    ds_read_b64_tr_b16 a[84:85], v34 offset:8192
    v_mfma_f32_16x16x32_bf16 v[244:247], a[88:91], a[196:199], v[244:247]
    s_add_u32 s63, s80, 0x108000
    v_mfma_f32_16x16x32_bf16 v[244:247], a[92:95], a[212:215], v[244:247]
    ds_read_b64_tr_b16 a[86:87], v34 offset:12288
    v_mfma_f32_16x16x32_bf16 v[240:243], a[92:95], a[208:211], v[240:243]
    v_add_u32 v74, 0x20000, v61
    v_mfma_f32_16x16x32_bf16 v[240:243], a[88:91], a[192:195], v[240:243]
    s_waitcnt vmcnt(32)
    s_waitcnt lgkmcnt(8)
    v_mfma_f32_16x16x32_bf16 v[80:83], a[64:67], a[32:35], v[80:83]
    ds_read_b64_tr_b16 a[88:89], v35 offset:57344
    v_mfma_f32_16x16x32_bf16 v[80:83], a[68:71], a[112:115], v[80:83]
    ds_read_b64_tr_b16 a[90:91], v35 offset:61440
    v_mfma_f32_16x16x32_bf16 v[84:87], a[68:71], a[116:119], v[84:87]
    buffer_load_dwordx4 a[16:19], v1, s[4:7], s63 offen offset:0 sc1
    v_mfma_f32_16x16x32_bf16 v[84:87], a[64:67], a[36:39], v[84:87]
    ds_read_b64_tr_b16 a[92:93], v35 offset:8192
    v_mfma_f32_16x16x32_bf16 v[88:91], a[64:67], a[40:43], v[88:91]
    buffer_load_dwordx4 a[20:23], v1, s[4:7], s63 offen offset:1024 sc1
    v_mfma_f32_16x16x32_bf16 v[88:91], a[68:71], a[120:123], v[88:91]
    ds_read_b64_tr_b16 a[94:95], v35 offset:12288
    v_mfma_f32_16x16x32_bf16 v[92:95], a[68:71], a[124:127], v[92:95]
    v_mfma_f32_16x16x32_bf16 v[92:95], a[64:67], a[44:47], v[92:95]
    s_waitcnt lgkmcnt(8)
    v_mfma_f32_16x16x32_bf16 v[108:111], a[72:75], a[44:47], v[108:111]
    ds_read_b64_tr_b16 a[64:65], v36 offset:57344
    v_mfma_f32_16x16x32_bf16 v[108:111], a[76:79], a[124:127], v[108:111]
    ds_read_b64_tr_b16 a[66:67], v36 offset:61440
    v_mfma_f32_16x16x32_bf16 v[104:107], a[76:79], a[120:123], v[104:107]
    buffer_load_dwordx4 a[24:27], v1, s[4:7], s63 offen offset:2048 sc1
    v_mfma_f32_16x16x32_bf16 v[104:107], a[72:75], a[40:43], v[104:107]
    ds_read_b64_tr_b16 a[68:69], v36 offset:8192
    v_mfma_f32_16x16x32_bf16 v[100:103], a[72:75], a[36:39], v[100:103]
    buffer_load_dwordx4 a[28:31], v1, s[4:7], s63 offen offset:3072 sc1
    v_mfma_f32_16x16x32_bf16 v[100:103], a[76:79], a[116:119], v[100:103]
    ds_read_b64_tr_b16 a[70:71], v36 offset:12288
    v_mfma_f32_16x16x32_bf16 v[96:99], a[76:79], a[112:115], v[96:99]
    v_mfma_f32_16x16x32_bf16 v[96:99], a[72:75], a[32:35], v[96:99]
    s_waitcnt lgkmcnt(8)
    v_mfma_f32_16x16x32_bf16 v[112:115], a[80:83], a[32:35], v[112:115]
    ds_read_b64_tr_b16 a[72:73], v37 offset:57344
    v_mfma_f32_16x16x32_bf16 v[112:115], a[84:87], a[112:115], v[112:115]
    ds_read_b64_tr_b16 a[74:75], v37 offset:61440
    v_mfma_f32_16x16x32_bf16 v[116:119], a[84:87], a[116:119], v[116:119]
    s_add_u32 s63, s80, 0x109000
    v_mfma_f32_16x16x32_bf16 v[116:119], a[80:83], a[36:39], v[116:119]
    ds_read_b64_tr_b16 a[76:77], v37 offset:8192
    v_mfma_f32_16x16x32_bf16 v[120:123], a[80:83], a[40:43], v[120:123]
    buffer_load_dwordx4 a[176:179], v1, s[4:7], s63 offen offset:0 sc1
    v_mfma_f32_16x16x32_bf16 v[120:123], a[84:87], a[120:123], v[120:123]
    ds_read_b64_tr_b16 a[78:79], v37 offset:12288
    v_mfma_f32_16x16x32_bf16 v[124:127], a[84:87], a[124:127], v[124:127]
    buffer_load_dwordx4 a[180:183], v1, s[4:7], s63 offen offset:1024 sc1
    v_mfma_f32_16x16x32_bf16 v[124:127], a[80:83], a[44:47], v[124:127]
    s_waitcnt lgkmcnt(8)
    v_mfma_f32_16x16x32_bf16 v[140:143], a[88:91], a[44:47], v[140:143]
    ds_read_b64_tr_b16 a[80:81], v38 offset:57344
    v_mfma_f32_16x16x32_bf16 v[140:143], a[92:95], a[124:127], v[140:143]
    ds_read_b64_tr_b16 a[82:83], v38 offset:61440
    v_mfma_f32_16x16x32_bf16 v[136:139], a[92:95], a[120:123], v[136:139]
    buffer_load_dwordx4 a[184:187], v1, s[4:7], s63 offen offset:2048 sc1
    v_mfma_f32_16x16x32_bf16 v[136:139], a[88:91], a[40:43], v[136:139]
    ds_read_b64_tr_b16 a[84:85], v38 offset:8192
    v_mfma_f32_16x16x32_bf16 v[132:135], a[88:91], a[36:39], v[132:135]
    v_mfma_f32_16x16x32_bf16 v[132:135], a[92:95], a[116:119], v[132:135]
    ds_read_b64_tr_b16 a[86:87], v38 offset:12288
    v_mfma_f32_16x16x32_bf16 v[128:131], a[92:95], a[112:115], v[128:131]
    buffer_load_dwordx4 a[188:191], v1, s[4:7], s63 offen offset:3072 sc1
    v_mfma_f32_16x16x32_bf16 v[128:131], a[88:91], a[32:35], v[128:131]
    s_waitcnt lgkmcnt(8)
    v_mfma_f32_16x16x32_bf16 v[160:163], a[64:67], a[32:35], v[160:163]
    ds_read_b64_tr_b16 a[88:89], v39 offset:57344
    v_mfma_f32_16x16x32_bf16 v[160:163], a[68:71], a[112:115], v[160:163]
    ds_read_b64_tr_b16 a[90:91], v39 offset:61440
    v_mfma_f32_16x16x32_bf16 v[164:167], a[68:71], a[116:119], v[164:167]
    s_add_u32 s63, s80, 0x10a000
    v_mfma_f32_16x16x32_bf16 v[164:167], a[64:67], a[36:39], v[164:167]
    ds_read_b64_tr_b16 a[92:93], v39 offset:8192
    v_mfma_f32_16x16x32_bf16 v[168:171], a[64:67], a[40:43], v[168:171]
    v_mfma_f32_16x16x32_bf16 v[168:171], a[68:71], a[120:123], v[168:171]
    ds_read_b64_tr_b16 a[94:95], v39 offset:12288
    v_mfma_f32_16x16x32_bf16 v[172:175], a[68:71], a[124:127], v[172:175]
    buffer_load_dwordx4 a[96:99], v1, s[4:7], s63 offen offset:0 sc1
    v_mfma_f32_16x16x32_bf16 v[172:175], a[64:67], a[44:47], v[172:175]
    s_waitcnt vmcnt(29)
    s_barrier
    s_waitcnt lgkmcnt(8)
    v_mfma_f32_16x16x32_bf16 v[204:207], a[72:75], a[44:47], v[204:207]
    ds_read_b128 a[64:67], v40 offset:4096
    v_mfma_f32_16x16x32_bf16 v[204:207], a[76:79], a[124:127], v[204:207]
    buffer_load_dwordx4 a[100:103], v1, s[4:7], s63 offen offset:1024 sc1
    v_mfma_f32_16x16x32_bf16 v[200:203], a[76:79], a[120:123], v[200:203]
    v_mfma_f32_16x16x32_bf16 v[200:203], a[72:75], a[40:43], v[200:203]
    ds_read_b128 a[68:71], v41 offset:4096
    v_mfma_f32_16x16x32_bf16 v[196:199], a[72:75], a[36:39], v[196:199]
    v_mfma_f32_16x16x32_bf16 v[196:199], a[76:79], a[116:119], v[196:199]
    buffer_load_dwordx4 a[104:107], v1, s[4:7], s63 offen offset:2048 sc1
    v_mfma_f32_16x16x32_bf16 v[192:195], a[76:79], a[112:115], v[192:195]
    v_mfma_f32_16x16x32_bf16 v[192:195], a[72:75], a[32:35], v[192:195]
    s_waitcnt lgkmcnt(6)
    v_mfma_f32_16x16x32_bf16 v[224:227], a[80:83], a[32:35], v[224:227]
    ds_read_b128 a[72:75], v40 offset:6144
    v_mfma_f32_16x16x32_bf16 v[224:227], a[84:87], a[112:115], v[224:227]
    buffer_load_dwordx4 a[108:111], v1, s[4:7], s63 offen offset:3072 sc1
    v_mfma_f32_16x16x32_bf16 v[228:231], a[84:87], a[116:119], v[228:231]
    v_mfma_f32_16x16x32_bf16 v[228:231], a[80:83], a[36:39], v[228:231]
    ds_read_b128 a[76:79], v41 offset:6144
    v_mfma_f32_16x16x32_bf16 v[232:235], a[80:83], a[40:43], v[232:235]
    v_mfma_f32_16x16x32_bf16 v[232:235], a[84:87], a[120:123], v[232:235]
    s_add_u32 s63, s88, 0x100000
    v_mfma_f32_16x16x32_bf16 v[236:239], a[84:87], a[124:127], v[236:239]
    v_mfma_f32_16x16x32_bf16 v[236:239], a[80:83], a[44:47], v[236:239]
    s_waitcnt lgkmcnt(4)
    v_mfma_f32_16x16x32_bf16 v[252:255], a[88:91], a[44:47], v[252:255]
    ds_read_b128 a[80:83], v40 offset:20480
    v_mfma_f32_16x16x32_bf16 v[252:255], a[92:95], a[124:127], v[252:255]
    buffer_load_dwordx4 a[192:195], v1, s[4:7], s63 offen offset:0 sc1
    v_mfma_f32_16x16x32_bf16 v[248:251], a[92:95], a[120:123], v[248:251]
    v_mfma_f32_16x16x32_bf16 v[248:251], a[88:91], a[40:43], v[248:251]
    ds_read_b128 a[84:87], v41 offset:20480
    v_mfma_f32_16x16x32_bf16 v[244:247], a[88:91], a[36:39], v[244:247]
    buffer_load_dwordx4 a[196:199], v1, s[4:7], s63 offen offset:1024 sc1
    v_mfma_f32_16x16x32_bf16 v[244:247], a[92:95], a[116:119], v[244:247]
    v_mfma_f32_16x16x32_bf16 v[240:243], a[92:95], a[112:115], v[240:243]
    v_mfma_f32_16x16x32_bf16 v[240:243], a[88:91], a[32:35], v[240:243]
    s_waitcnt vmcnt(26)
    s_waitcnt lgkmcnt(4)
    v_mfma_f32_16x16x32_bf16 v[112:115], a[64:67], a[128:131], v[112:115]
    ds_read_b128 a[88:91], v40 offset:22528
    v_mfma_f32_16x16x32_bf16 v[112:115], a[68:71], a[48:51], v[112:115]
    buffer_load_dwordx4 a[200:203], v1, s[4:7], s63 offen offset:2048 sc1
    v_mfma_f32_16x16x32_bf16 v[116:119], a[68:71], a[52:55], v[116:119]
    v_mfma_f32_16x16x32_bf16 v[116:119], a[64:67], a[132:135], v[116:119]
    ds_read_b128 a[92:95], v41 offset:22528
    v_mfma_f32_16x16x32_bf16 v[120:123], a[64:67], a[136:139], v[120:123]
    buffer_load_dwordx4 a[204:207], v1, s[4:7], s63 offen offset:3072 sc1
    v_mfma_f32_16x16x32_bf16 v[120:123], a[68:71], a[56:59], v[120:123]
    v_mfma_f32_16x16x32_bf16 v[124:127], a[68:71], a[60:63], v[124:127]
    v_mfma_f32_16x16x32_bf16 v[124:127], a[64:67], a[140:143], v[124:127]
    s_waitcnt lgkmcnt(4)
    v_mfma_f32_16x16x32_bf16 v[140:143], a[72:75], a[140:143], v[140:143]
    ds_read_b128 a[64:67], v40 offset:36864
    v_mfma_f32_16x16x32_bf16 v[140:143], a[76:79], a[60:63], v[140:143]
    s_add_u32 s63, s88, 0x102000
    v_mfma_f32_16x16x32_bf16 v[136:139], a[76:79], a[56:59], v[136:139]
    v_mfma_f32_16x16x32_bf16 v[136:139], a[72:75], a[136:139], v[136:139]
    ds_read_b128 a[68:71], v41 offset:36864
    v_mfma_f32_16x16x32_bf16 v[132:135], a[72:75], a[132:135], v[132:135]
    buffer_load_dwordx4 a[208:211], v1, s[4:7], s63 offen offset:0 sc1
    v_mfma_f32_16x16x32_bf16 v[132:135], a[76:79], a[52:55], v[132:135]
    v_mfma_f32_16x16x32_bf16 v[128:131], a[76:79], a[48:51], v[128:131]
    v_mfma_f32_16x16x32_bf16 v[128:131], a[72:75], a[128:131], v[128:131]
    s_waitcnt vmcnt(21)
    s_waitcnt lgkmcnt(4)
    v_mfma_f32_16x16x32_bf16 v[112:115], a[80:83], a[144:147], v[112:115]
    ds_read_b128 a[72:75], v40 offset:38912
    v_mfma_f32_16x16x32_bf16 v[112:115], a[84:87], a[0:3], v[112:115]
    buffer_load_dwordx4 a[212:215], v1, s[4:7], s63 offen offset:1024 sc1
    v_mfma_f32_16x16x32_bf16 v[116:119], a[84:87], a[4:7], v[116:119]
    v_mfma_f32_16x16x32_bf16 v[116:119], a[80:83], a[148:151], v[116:119]
    ds_read_b128 a[76:79], v41 offset:38912
    v_mfma_f32_16x16x32_bf16 v[120:123], a[80:83], a[152:155], v[120:123]
    buffer_load_dwordx4 a[216:219], v1, s[4:7], s63 offen offset:2048 sc1
    v_mfma_f32_16x16x32_bf16 v[120:123], a[84:87], a[8:11], v[120:123]
    v_mfma_f32_16x16x32_bf16 v[124:127], a[84:87], a[12:15], v[124:127]
    v_mfma_f32_16x16x32_bf16 v[124:127], a[80:83], a[156:159], v[124:127]
    s_waitcnt lgkmcnt(4)
    v_mfma_f32_16x16x32_bf16 v[140:143], a[88:91], a[156:159], v[140:143]
    ds_read_b128 a[80:83], v40 offset:53248
    v_mfma_f32_16x16x32_bf16 v[140:143], a[92:95], a[12:15], v[140:143]
    buffer_load_dwordx4 a[220:223], v1, s[4:7], s63 offen offset:3072 sc1
    v_mfma_f32_16x16x32_bf16 v[136:139], a[92:95], a[8:11], v[136:139]
    v_mfma_f32_16x16x32_bf16 v[136:139], a[88:91], a[152:155], v[136:139]
    ds_read_b128 a[84:87], v41 offset:53248
    v_mfma_f32_16x16x32_bf16 v[132:135], a[88:91], a[148:151], v[132:135]
    v_mfma_f32_16x16x32_bf16 v[132:135], a[92:95], a[4:7], v[132:135]
    v_mfma_f32_16x16x32_bf16 v[128:131], a[92:95], a[0:3], v[128:131]
    v_mfma_f32_16x16x32_bf16 v[128:131], a[88:91], a[144:147], v[128:131]
    s_waitcnt vmcnt(16)
    s_waitcnt lgkmcnt(4)
    v_mfma_f32_16x16x32_bf16 v[112:115], a[64:67], a[160:163], v[112:115]
    ds_read_b128 a[88:91], v40 offset:55296
    v_mfma_f32_16x16x32_bf16 v[112:115], a[68:71], a[16:19], v[112:115]
    v_mfma_f32_16x16x32_bf16 v[116:119], a[68:71], a[20:23], v[116:119]
    v_mfma_f32_16x16x32_bf16 v[116:119], a[64:67], a[164:167], v[116:119]
    ds_read_b128 a[92:95], v41 offset:55296
    v_mfma_f32_16x16x32_bf16 v[120:123], a[64:67], a[168:171], v[120:123]
    v_mfma_f32_16x16x32_bf16 v[120:123], a[68:71], a[24:27], v[120:123]
    v_mfma_f32_16x16x32_bf16 v[124:127], a[68:71], a[28:31], v[124:127]
    v_mfma_f32_16x16x32_bf16 v[124:127], a[64:67], a[172:175], v[124:127]
    s_waitcnt lgkmcnt(4)
    v_mfma_f32_16x16x32_bf16 v[140:143], a[72:75], a[172:175], v[140:143]
    ds_read_b128 a[64:67], v3 offset:4096
    v_mfma_f32_16x16x32_bf16 v[140:143], a[76:79], a[28:31], v[140:143]
    v_mfma_f32_16x16x32_bf16 v[136:139], a[76:79], a[24:27], v[136:139]
    v_mfma_f32_16x16x32_bf16 v[136:139], a[72:75], a[168:171], v[136:139]
    ds_read_b128 a[68:71], v3 offset:20480
    v_mfma_f32_16x16x32_bf16 v[132:135], a[72:75], a[164:167], v[132:135]
    v_mfma_f32_16x16x32_bf16 v[132:135], a[76:79], a[20:23], v[132:135]
    v_mfma_f32_16x16x32_bf16 v[128:131], a[76:79], a[16:19], v[128:131]
    v_mfma_f32_16x16x32_bf16 v[128:131], a[72:75], a[160:163], v[128:131]
    s_waitcnt vmcnt(8)
    s_waitcnt lgkmcnt(4)
    v_mfma_f32_16x16x32_bf16 v[112:115], a[80:83], a[176:179], v[112:115]
    ds_read_b128 a[72:75], v3 offset:6144
    v_mfma_f32_16x16x32_bf16 v[112:115], a[84:87], a[96:99], v[112:115]
    v_mfma_f32_16x16x32_bf16 v[116:119], a[84:87], a[100:103], v[116:119]
    v_mfma_f32_16x16x32_bf16 v[116:119], a[80:83], a[180:183], v[116:119]
    ds_read_b128 a[76:79], v3 offset:22528
    v_mfma_f32_16x16x32_bf16 v[120:123], a[80:83], a[184:187], v[120:123]
    v_mfma_f32_16x16x32_bf16 v[120:123], a[84:87], a[104:107], v[120:123]
    v_mfma_f32_16x16x32_bf16 v[124:127], a[84:87], a[108:111], v[124:127]
    v_mfma_f32_16x16x32_bf16 v[124:127], a[80:83], a[188:191], v[124:127]
    s_waitcnt lgkmcnt(4)
    v_mfma_f32_16x16x32_bf16 v[140:143], a[88:91], a[188:191], v[140:143]
    ds_read_b128 a[80:83], v40 offset:8192
    v_mfma_f32_16x16x32_bf16 v[140:143], a[92:95], a[108:111], v[140:143]
    v_mfma_f32_16x16x32_bf16 v[136:139], a[92:95], a[104:107], v[136:139]
    v_mfma_f32_16x16x32_bf16 v[136:139], a[88:91], a[184:187], v[136:139]
    ds_read_b128 a[84:87], v41 offset:8192
    v_mfma_f32_16x16x32_bf16 v[132:135], a[88:91], a[180:183], v[132:135]
    v_mfma_f32_16x16x32_bf16 v[132:135], a[92:95], a[100:103], v[132:135]
    v_mfma_f32_16x16x32_bf16 v[128:131], a[92:95], a[96:99], v[128:131]
    v_mfma_f32_16x16x32_bf16 v[128:131], a[88:91], a[176:179], v[128:131]
    s_waitcnt vmcnt(0)
    s_waitcnt lgkmcnt(4)
    v_mfma_f32_16x16x32_bf16 v[112:115], a[64:67], a[192:195], v[112:115]
    ds_read_b128 a[88:91], v40 offset:10240
    v_mfma_f32_16x16x32_bf16 v[112:115], a[68:71], a[208:211], v[112:115]
    v_mfma_f32_16x16x32_bf16 v[116:119], a[68:71], a[212:215], v[116:119]
    v_mfma_f32_16x16x32_bf16 v[116:119], a[64:67], a[196:199], v[116:119]
    ds_read_b128 a[92:95], v41 offset:10240
    v_mfma_f32_16x16x32_bf16 v[120:123], a[64:67], a[200:203], v[120:123]
    v_mfma_f32_16x16x32_bf16 v[120:123], a[68:71], a[216:219], v[120:123]
    v_mfma_f32_16x16x32_bf16 v[124:127], a[68:71], a[220:223], v[124:127]
    v_mfma_f32_16x16x32_bf16 v[124:127], a[64:67], a[204:207], v[124:127]
    s_waitcnt lgkmcnt(4)
    v_mfma_f32_16x16x32_bf16 v[140:143], a[72:75], a[204:207], v[140:143]
    ds_read_b128 a[64:67], v40 offset:24576
    v_mfma_f32_16x16x32_bf16 v[140:143], a[76:79], a[220:223], v[140:143]
    v_mfma_f32_16x16x32_bf16 v[136:139], a[76:79], a[216:219], v[136:139]
    v_mfma_f32_16x16x32_bf16 v[136:139], a[72:75], a[200:203], v[136:139]
    ds_read_b128 a[68:71], v41 offset:24576
    v_mfma_f32_16x16x32_bf16 v[132:135], a[72:75], a[196:199], v[132:135]
    v_mfma_f32_16x16x32_bf16 v[132:135], a[76:79], a[212:215], v[132:135]
    v_mfma_f32_16x16x32_bf16 v[128:131], a[76:79], a[208:211], v[128:131]
    v_mfma_f32_16x16x32_bf16 v[128:131], a[72:75], a[192:195], v[128:131]
    s_waitcnt lgkmcnt(4)
    v_mfma_f32_16x16x32_bf16 v[160:163], a[80:83], a[128:131], v[160:163]
    ds_read_b128 a[72:75], v40 offset:26624
    v_mfma_f32_16x16x32_bf16 v[160:163], a[84:87], a[48:51], v[160:163]
    v_mfma_f32_16x16x32_bf16 v[164:167], a[84:87], a[52:55], v[164:167]
    v_mfma_f32_16x16x32_bf16 v[164:167], a[80:83], a[132:135], v[164:167]
    ds_read_b128 a[76:79], v41 offset:26624
    v_mfma_f32_16x16x32_bf16 v[168:171], a[80:83], a[136:139], v[168:171]
    v_cvt_pk_bf16_f32 v124, v124, v125
    v_mfma_f32_16x16x32_bf16 v[168:171], a[84:87], a[56:59], v[168:171]
    v_cvt_pk_bf16_f32 v125, v126, v127
    v_mfma_f32_16x16x32_bf16 v[172:175], a[84:87], a[60:63], v[172:175]
    v_cvt_pk_bf16_f32 v126, v140, v141
    v_mfma_f32_16x16x32_bf16 v[172:175], a[80:83], a[140:143], v[172:175]
    s_waitcnt lgkmcnt(4)
    v_mfma_f32_16x16x32_bf16 v[204:207], a[88:91], a[140:143], v[204:207]
    ds_read_b128 a[80:83], v40 offset:40960
    v_mfma_f32_16x16x32_bf16 v[204:207], a[92:95], a[60:63], v[204:207]
    v_cvt_pk_bf16_f32 v127, v142, v143
    v_mfma_f32_16x16x32_bf16 v[200:203], a[92:95], a[56:59], v[200:203]
    buffer_store_dwordx4 v[124:127], v1, s[4:7], s96 offen offset:3072 sc1
    v_mfma_f32_16x16x32_bf16 v[200:203], a[88:91], a[136:139], v[200:203]
    ds_read_b128 a[84:87], v41 offset:40960
    v_mfma_f32_16x16x32_bf16 v[196:199], a[88:91], a[132:135], v[196:199]
    v_cvt_pk_bf16_f32 v120, v120, v121
    v_mfma_f32_16x16x32_bf16 v[196:199], a[92:95], a[52:55], v[196:199]
    v_cvt_pk_bf16_f32 v121, v122, v123
    v_mfma_f32_16x16x32_bf16 v[192:195], a[92:95], a[48:51], v[192:195]
    v_cvt_pk_bf16_f32 v122, v136, v137
    v_mfma_f32_16x16x32_bf16 v[192:195], a[88:91], a[128:131], v[192:195]
    v_cvt_pk_bf16_f32 v123, v138, v139
    s_waitcnt lgkmcnt(4)
    v_mfma_f32_16x16x32_bf16 v[160:163], a[64:67], a[144:147], v[160:163]
    ds_read_b128 a[88:91], v40 offset:43008
    v_mfma_f32_16x16x32_bf16 v[160:163], a[68:71], a[0:3], v[160:163]
    buffer_store_dwordx4 v[120:123], v1, s[4:7], s96 offen offset:2048 sc1
    v_mfma_f32_16x16x32_bf16 v[164:167], a[68:71], a[4:7], v[164:167]
    v_cvt_pk_bf16_f32 v116, v116, v117
    v_mfma_f32_16x16x32_bf16 v[164:167], a[64:67], a[148:151], v[164:167]
    ds_read_b128 a[92:95], v41 offset:43008
    v_mfma_f32_16x16x32_bf16 v[168:171], a[64:67], a[152:155], v[168:171]
    v_cvt_pk_bf16_f32 v117, v118, v119
    v_mfma_f32_16x16x32_bf16 v[168:171], a[68:71], a[8:11], v[168:171]
    v_cvt_pk_bf16_f32 v118, v132, v133
    v_mfma_f32_16x16x32_bf16 v[172:175], a[68:71], a[12:15], v[172:175]
    v_cvt_pk_bf16_f32 v119, v134, v135
    v_mfma_f32_16x16x32_bf16 v[172:175], a[64:67], a[156:159], v[172:175]
    s_waitcnt lgkmcnt(4)
    v_mfma_f32_16x16x32_bf16 v[204:207], a[72:75], a[156:159], v[204:207]
    ds_read_b128 a[64:67], v40 offset:57344
    v_mfma_f32_16x16x32_bf16 v[204:207], a[76:79], a[12:15], v[204:207]
    buffer_store_dwordx4 v[116:119], v1, s[4:7], s96 offen offset:1024 sc1
    v_mfma_f32_16x16x32_bf16 v[200:203], a[76:79], a[8:11], v[200:203]
    v_cvt_pk_bf16_f32 v112, v112, v113
    v_mfma_f32_16x16x32_bf16 v[200:203], a[72:75], a[152:155], v[200:203]
    ds_read_b128 a[68:71], v41 offset:57344
    v_mfma_f32_16x16x32_bf16 v[196:199], a[72:75], a[148:151], v[196:199]
    v_cvt_pk_bf16_f32 v113, v114, v115
    v_mfma_f32_16x16x32_bf16 v[196:199], a[76:79], a[4:7], v[196:199]
    v_cvt_pk_bf16_f32 v114, v128, v129
    v_mfma_f32_16x16x32_bf16 v[192:195], a[76:79], a[0:3], v[192:195]
    v_cvt_pk_bf16_f32 v115, v130, v131
    v_mfma_f32_16x16x32_bf16 v[192:195], a[72:75], a[144:147], v[192:195]
    buffer_store_dwordx4 v[112:115], v1, s[4:7], s96 offen offset:0 sc1
    s_waitcnt lgkmcnt(4)
    v_mfma_f32_16x16x32_bf16 v[160:163], a[80:83], a[160:163], v[160:163]
    ds_read_b128 a[72:75], v40 offset:59392
L_hop_11:
    s_cbranch_execz L_hop_done
    s_nop 0
    v_mfma_f32_16x16x32_bf16 v[160:163], a[84:87], a[16:19], v[160:163]
    v_mfma_f32_16x16x32_bf16 v[164:167], a[84:87], a[20:23], v[164:167]
    v_mfma_f32_16x16x32_bf16 v[164:167], a[80:83], a[164:167], v[164:167]
    ds_read_b128 a[76:79], v41 offset:59392
    v_mfma_f32_16x16x32_bf16 v[168:171], a[80:83], a[168:171], v[168:171]
    v_mfma_f32_16x16x32_bf16 v[168:171], a[84:87], a[24:27], v[168:171]
    v_mfma_f32_16x16x32_bf16 v[172:175], a[84:87], a[28:31], v[172:175]
    v_mfma_f32_16x16x32_bf16 v[172:175], a[80:83], a[172:175], v[172:175]
    s_waitcnt lgkmcnt(4)
    v_mfma_f32_16x16x32_bf16 v[204:207], a[88:91], a[172:175], v[204:207]
    ds_read_b128 a[80:83], v3 offset:8192
    v_mfma_f32_16x16x32_bf16 v[204:207], a[92:95], a[28:31], v[204:207]
    v_mfma_f32_16x16x32_bf16 v[200:203], a[92:95], a[24:27], v[200:203]
    v_mfma_f32_16x16x32_bf16 v[200:203], a[88:91], a[168:171], v[200:203]
    ds_read_b128 a[84:87], v3 offset:24576
    v_mfma_f32_16x16x32_bf16 v[196:199], a[88:91], a[164:167], v[196:199]
    v_mfma_f32_16x16x32_bf16 v[196:199], a[92:95], a[20:23], v[196:199]
    v_mfma_f32_16x16x32_bf16 v[192:195], a[92:95], a[16:19], v[192:195]
    v_mfma_f32_16x16x32_bf16 v[192:195], a[88:91], a[160:163], v[192:195]
    s_waitcnt lgkmcnt(4)
    v_mfma_f32_16x16x32_bf16 v[160:163], a[64:67], a[176:179], v[160:163]
    ds_read_b128 a[88:91], v3 offset:10240
    v_mfma_f32_16x16x32_bf16 v[160:163], a[68:71], a[96:99], v[160:163]
    v_mfma_f32_16x16x32_bf16 v[164:167], a[68:71], a[100:103], v[164:167]
    v_mfma_f32_16x16x32_bf16 v[164:167], a[64:67], a[180:183], v[164:167]
    ds_read_b128 a[92:95], v3 offset:26624
    v_mfma_f32_16x16x32_bf16 v[168:171], a[64:67], a[184:187], v[168:171]
    v_mfma_f32_16x16x32_bf16 v[168:171], a[68:71], a[104:107], v[168:171]
    v_mfma_f32_16x16x32_bf16 v[172:175], a[68:71], a[108:111], v[172:175]
    v_mfma_f32_16x16x32_bf16 v[172:175], a[64:67], a[188:191], v[172:175]
    s_waitcnt lgkmcnt(4)
    v_mfma_f32_16x16x32_bf16 v[204:207], a[72:75], a[188:191], v[204:207]
    ds_read_b128 a[64:67], v40 offset:12288
    v_mfma_f32_16x16x32_bf16 v[204:207], a[76:79], a[108:111], v[204:207]
    v_mfma_f32_16x16x32_bf16 v[200:203], a[76:79], a[104:107], v[200:203]
    v_mfma_f32_16x16x32_bf16 v[200:203], a[72:75], a[184:187], v[200:203]
    ds_read_b128 a[68:71], v41 offset:12288
    v_mfma_f32_16x16x32_bf16 v[196:199], a[72:75], a[180:183], v[196:199]
    v_mfma_f32_16x16x32_bf16 v[196:199], a[76:79], a[100:103], v[196:199]
    v_mfma_f32_16x16x32_bf16 v[192:195], a[76:79], a[96:99], v[192:195]
    v_mfma_f32_16x16x32_bf16 v[192:195], a[72:75], a[176:179], v[192:195]
    s_waitcnt lgkmcnt(4)
    v_mfma_f32_16x16x32_bf16 v[160:163], a[80:83], a[192:195], v[160:163]
    ds_read_b128 a[72:75], v40 offset:14336
    v_mfma_f32_16x16x32_bf16 v[160:163], a[84:87], a[208:211], v[160:163]
    v_mfma_f32_16x16x32_bf16 v[164:167], a[84:87], a[212:215], v[164:167]
    v_mfma_f32_16x16x32_bf16 v[164:167], a[80:83], a[196:199], v[164:167]
    ds_read_b128 a[76:79], v41 offset:14336
    v_mfma_f32_16x16x32_bf16 v[168:171], a[80:83], a[200:203], v[168:171]
    v_mfma_f32_16x16x32_bf16 v[168:171], a[84:87], a[216:219], v[168:171]
    v_mfma_f32_16x16x32_bf16 v[172:175], a[84:87], a[220:223], v[172:175]
    v_mfma_f32_16x16x32_bf16 v[172:175], a[80:83], a[204:207], v[172:175]
    s_waitcnt lgkmcnt(4)
    v_mfma_f32_16x16x32_bf16 v[204:207], a[88:91], a[204:207], v[204:207]
    ds_read_b128 a[80:83], v40 offset:28672
    v_mfma_f32_16x16x32_bf16 v[204:207], a[92:95], a[220:223], v[204:207]
    v_mfma_f32_16x16x32_bf16 v[200:203], a[92:95], a[216:219], v[200:203]
    v_mfma_f32_16x16x32_bf16 v[200:203], a[88:91], a[200:203], v[200:203]
    ds_read_b128 a[84:87], v41 offset:28672
    v_mfma_f32_16x16x32_bf16 v[196:199], a[88:91], a[196:199], v[196:199]
    v_mfma_f32_16x16x32_bf16 v[196:199], a[92:95], a[212:215], v[196:199]
    v_mfma_f32_16x16x32_bf16 v[192:195], a[92:95], a[208:211], v[192:195]
    v_mfma_f32_16x16x32_bf16 v[192:195], a[88:91], a[192:195], v[192:195]
    s_waitcnt lgkmcnt(4)
    v_mfma_f32_16x16x32_bf16 v[224:227], a[64:67], a[128:131], v[224:227]
    ds_read_b128 a[88:91], v40 offset:30720
    v_mfma_f32_16x16x32_bf16 v[224:227], a[68:71], a[48:51], v[224:227]
    v_mfma_f32_16x16x32_bf16 v[228:231], a[68:71], a[52:55], v[228:231]
    v_mfma_f32_16x16x32_bf16 v[228:231], a[64:67], a[132:135], v[228:231]
    ds_read_b128 a[92:95], v41 offset:30720
    v_mfma_f32_16x16x32_bf16 v[232:235], a[64:67], a[136:139], v[232:235]
    v_cvt_pk_bf16_f32 v172, v172, v173
    v_mfma_f32_16x16x32_bf16 v[232:235], a[68:71], a[56:59], v[232:235]
    v_cvt_pk_bf16_f32 v173, v174, v175
    v_mfma_f32_16x16x32_bf16 v[236:239], a[68:71], a[60:63], v[236:239]
    v_cvt_pk_bf16_f32 v174, v204, v205
    v_mfma_f32_16x16x32_bf16 v[236:239], a[64:67], a[140:143], v[236:239]
    s_waitcnt lgkmcnt(4)
    v_mfma_f32_16x16x32_bf16 v[252:255], a[72:75], a[140:143], v[252:255]
    ds_read_b128 a[64:67], v40 offset:45056
    v_mfma_f32_16x16x32_bf16 v[252:255], a[76:79], a[60:63], v[252:255]
    v_cvt_pk_bf16_f32 v175, v206, v207
    v_mfma_f32_16x16x32_bf16 v[248:251], a[76:79], a[56:59], v[248:251]
    buffer_store_dwordx4 v[172:175], v1, s[4:7], s97 offen offset:3072 sc1
    v_mfma_f32_16x16x32_bf16 v[248:251], a[72:75], a[136:139], v[248:251]
    ds_read_b128 a[68:71], v41 offset:45056
    v_mfma_f32_16x16x32_bf16 v[244:247], a[72:75], a[132:135], v[244:247]
    v_cvt_pk_bf16_f32 v168, v168, v169
    v_mfma_f32_16x16x32_bf16 v[244:247], a[76:79], a[52:55], v[244:247]
    v_cvt_pk_bf16_f32 v169, v170, v171
    v_mfma_f32_16x16x32_bf16 v[240:243], a[76:79], a[48:51], v[240:243]
    v_cvt_pk_bf16_f32 v170, v200, v201
    v_mfma_f32_16x16x32_bf16 v[240:243], a[72:75], a[128:131], v[240:243]
    v_cvt_pk_bf16_f32 v171, v202, v203
    s_waitcnt lgkmcnt(4)
    v_mfma_f32_16x16x32_bf16 v[224:227], a[80:83], a[144:147], v[224:227]
    ds_read_b128 a[72:75], v40 offset:47104
    v_mfma_f32_16x16x32_bf16 v[224:227], a[84:87], a[0:3], v[224:227]
    buffer_store_dwordx4 v[168:171], v1, s[4:7], s97 offen offset:2048 sc1
    v_mfma_f32_16x16x32_bf16 v[228:231], a[84:87], a[4:7], v[228:231]
    v_cvt_pk_bf16_f32 v164, v164, v165
    v_mfma_f32_16x16x32_bf16 v[228:231], a[80:83], a[148:151], v[228:231]
    ds_read_b128 a[76:79], v41 offset:47104
    v_mfma_f32_16x16x32_bf16 v[232:235], a[80:83], a[152:155], v[232:235]
    v_cvt_pk_bf16_f32 v165, v166, v167
    v_mfma_f32_16x16x32_bf16 v[232:235], a[84:87], a[8:11], v[232:235]
    v_cvt_pk_bf16_f32 v166, v196, v197
    v_mfma_f32_16x16x32_bf16 v[236:239], a[84:87], a[12:15], v[236:239]
    v_cvt_pk_bf16_f32 v167, v198, v199
    v_mfma_f32_16x16x32_bf16 v[236:239], a[80:83], a[156:159], v[236:239]
    s_waitcnt lgkmcnt(4)
    v_mfma_f32_16x16x32_bf16 v[252:255], a[88:91], a[156:159], v[252:255]
    ds_read_b128 a[80:83], v40 offset:61440
    v_mfma_f32_16x16x32_bf16 v[252:255], a[92:95], a[12:15], v[252:255]
    buffer_store_dwordx4 v[164:167], v1, s[4:7], s97 offen offset:1024 sc1
    v_mfma_f32_16x16x32_bf16 v[248:251], a[92:95], a[8:11], v[248:251]
    v_cvt_pk_bf16_f32 v160, v160, v161
    v_mfma_f32_16x16x32_bf16 v[248:251], a[88:91], a[152:155], v[248:251]
    ds_read_b128 a[84:87], v41 offset:61440
    v_mfma_f32_16x16x32_bf16 v[244:247], a[88:91], a[148:151], v[244:247]
    v_cvt_pk_bf16_f32 v161, v162, v163
    v_mfma_f32_16x16x32_bf16 v[244:247], a[92:95], a[4:7], v[244:247]
    v_cvt_pk_bf16_f32 v162, v192, v193
    v_mfma_f32_16x16x32_bf16 v[240:243], a[92:95], a[0:3], v[240:243]
    v_cvt_pk_bf16_f32 v163, v194, v195
    v_mfma_f32_16x16x32_bf16 v[240:243], a[88:91], a[144:147], v[240:243]
    buffer_store_dwordx4 v[160:163], v1, s[4:7], s97 offen offset:0 sc1
    s_waitcnt lgkmcnt(4)
    v_mfma_f32_16x16x32_bf16 v[224:227], a[64:67], a[160:163], v[224:227]
    ds_read_b128 a[88:91], v40 offset:63488
    v_mfma_f32_16x16x32_bf16 v[224:227], a[68:71], a[16:19], v[224:227]
    v_mfma_f32_16x16x32_bf16 v[228:231], a[68:71], a[20:23], v[228:231]
    v_mfma_f32_16x16x32_bf16 v[228:231], a[64:67], a[164:167], v[228:231]
    ds_read_b128 a[92:95], v41 offset:63488
    v_mfma_f32_16x16x32_bf16 v[232:235], a[64:67], a[168:171], v[232:235]
    s_waitcnt vmcnt(4)
    v_mfma_f32_16x16x32_bf16 v[232:235], a[68:71], a[24:27], v[232:235]
    buffer_store_dword v58, v4, s[4:7], s71 offen offset:256 sc1
    v_mfma_f32_16x16x32_bf16 v[236:239], a[68:71], a[28:31], v[236:239]
    v_mfma_f32_16x16x32_bf16 v[236:239], a[64:67], a[172:175], v[236:239]
    s_waitcnt lgkmcnt(4)
    v_mfma_f32_16x16x32_bf16 v[252:255], a[72:75], a[172:175], v[252:255]
    ds_read_b128 a[64:67], v3 offset:12288
    v_mfma_f32_16x16x32_bf16 v[252:255], a[76:79], a[28:31], v[252:255]
    v_mfma_f32_16x16x32_bf16 v[248:251], a[76:79], a[24:27], v[248:251]
    v_mfma_f32_16x16x32_bf16 v[248:251], a[72:75], a[168:171], v[248:251]
    ds_read_b128 a[68:71], v3 offset:28672
    v_mfma_f32_16x16x32_bf16 v[244:247], a[72:75], a[164:167], v[244:247]
    v_mfma_f32_16x16x32_bf16 v[244:247], a[76:79], a[20:23], v[244:247]
    v_mfma_f32_16x16x32_bf16 v[240:243], a[76:79], a[16:19], v[240:243]
    v_mfma_f32_16x16x32_bf16 v[240:243], a[72:75], a[160:163], v[240:243]
    s_waitcnt lgkmcnt(4)
    v_mfma_f32_16x16x32_bf16 v[224:227], a[80:83], a[176:179], v[224:227]
    ds_read_b128 a[72:75], v3 offset:14336
    v_mfma_f32_16x16x32_bf16 v[224:227], a[84:87], a[96:99], v[224:227]
    v_mfma_f32_16x16x32_bf16 v[228:231], a[84:87], a[100:103], v[228:231]
    v_mfma_f32_16x16x32_bf16 v[228:231], a[80:83], a[180:183], v[228:231]
    ds_read_b128 a[76:79], v3 offset:30720
    v_mfma_f32_16x16x32_bf16 v[232:235], a[80:83], a[184:187], v[232:235]
    v_mfma_f32_16x16x32_bf16 v[232:235], a[84:87], a[104:107], v[232:235]
    v_mfma_f32_16x16x32_bf16 v[236:239], a[84:87], a[108:111], v[236:239]
    v_mfma_f32_16x16x32_bf16 v[236:239], a[80:83], a[188:191], v[236:239]
    s_waitcnt lgkmcnt(4)
    v_mfma_f32_16x16x32_bf16 v[252:255], a[88:91], a[188:191], v[252:255]
    ds_read_b128 a[80:83], v40 offset:0
    v_mfma_f32_16x16x32_bf16 v[252:255], a[92:95], a[108:111], v[252:255]
    v_mfma_f32_16x16x32_bf16 v[248:251], a[92:95], a[104:107], v[248:251]
    v_mfma_f32_16x16x32_bf16 v[248:251], a[88:91], a[184:187], v[248:251]
    ds_read_b128 a[84:87], v41 offset:0
    v_mfma_f32_16x16x32_bf16 v[244:247], a[88:91], a[180:183], v[244:247]
    v_mfma_f32_16x16x32_bf16 v[244:247], a[92:95], a[100:103], v[244:247]
    v_mfma_f32_16x16x32_bf16 v[240:243], a[92:95], a[96:99], v[240:243]
    v_mfma_f32_16x16x32_bf16 v[240:243], a[88:91], a[176:179], v[240:243]
    s_waitcnt lgkmcnt(4)
    v_mfma_f32_16x16x32_bf16 v[224:227], a[64:67], a[192:195], v[224:227]
    ds_read_b128 a[88:91], v40 offset:2048
    v_mfma_f32_16x16x32_bf16 v[224:227], a[68:71], a[208:211], v[224:227]
    v_mfma_f32_16x16x32_bf16 v[228:231], a[68:71], a[212:215], v[228:231]
    v_mfma_f32_16x16x32_bf16 v[228:231], a[64:67], a[196:199], v[228:231]
    ds_read_b128 a[92:95], v41 offset:2048
    v_mfma_f32_16x16x32_bf16 v[232:235], a[64:67], a[200:203], v[232:235]
    v_mfma_f32_16x16x32_bf16 v[232:235], a[68:71], a[216:219], v[232:235]
    v_mfma_f32_16x16x32_bf16 v[236:239], a[68:71], a[220:223], v[236:239]
    v_mfma_f32_16x16x32_bf16 v[236:239], a[64:67], a[204:207], v[236:239]
    s_waitcnt lgkmcnt(4)
    v_mfma_f32_16x16x32_bf16 v[252:255], a[72:75], a[204:207], v[252:255]
    ds_read_b128 a[64:67], v40 offset:16384
    v_mfma_f32_16x16x32_bf16 v[252:255], a[76:79], a[220:223], v[252:255]
    v_mfma_f32_16x16x32_bf16 v[248:251], a[76:79], a[216:219], v[248:251]
    v_mfma_f32_16x16x32_bf16 v[248:251], a[72:75], a[200:203], v[248:251]
    ds_read_b128 a[68:71], v41 offset:16384
    v_mfma_f32_16x16x32_bf16 v[244:247], a[72:75], a[196:199], v[244:247]
    v_mfma_f32_16x16x32_bf16 v[244:247], a[76:79], a[212:215], v[244:247]
    v_mfma_f32_16x16x32_bf16 v[240:243], a[76:79], a[208:211], v[240:243]
    v_mfma_f32_16x16x32_bf16 v[240:243], a[72:75], a[192:195], v[240:243]
    s_waitcnt lgkmcnt(4)
    v_mfma_f32_16x16x32_bf16 v[80:83], a[80:83], a[128:131], v[80:83]
    ds_read_b128 a[72:75], v40 offset:18432
    v_mfma_f32_16x16x32_bf16 v[80:83], a[84:87], a[48:51], v[80:83]
    buffer_load_dword v7, v5, s[4:7], s92 offen offset:256 sc1
    v_mfma_f32_16x16x32_bf16 v[84:87], a[84:87], a[52:55], v[84:87]
    v_mfma_f32_16x16x32_bf16 v[84:87], a[80:83], a[132:135], v[84:87]
    ds_read_b128 a[76:79], v41 offset:18432
    v_mfma_f32_16x16x32_bf16 v[88:91], a[80:83], a[136:139], v[88:91]
    v_cvt_pk_bf16_f32 v236, v236, v237
    v_mfma_f32_16x16x32_bf16 v[88:91], a[84:87], a[56:59], v[88:91]
    v_cvt_pk_bf16_f32 v237, v238, v239
    v_mfma_f32_16x16x32_bf16 v[92:95], a[84:87], a[60:63], v[92:95]
    v_cvt_pk_bf16_f32 v238, v252, v253
    v_mfma_f32_16x16x32_bf16 v[92:95], a[80:83], a[140:143], v[92:95]
    s_waitcnt lgkmcnt(4)
    v_mfma_f32_16x16x32_bf16 v[108:111], a[88:91], a[140:143], v[108:111]
    ds_read_b128 a[80:83], v40 offset:32768
    v_mfma_f32_16x16x32_bf16 v[108:111], a[92:95], a[60:63], v[108:111]
    v_cvt_pk_bf16_f32 v239, v254, v255
    v_mfma_f32_16x16x32_bf16 v[104:107], a[92:95], a[56:59], v[104:107]
    buffer_store_dwordx4 v[236:239], v1, s[4:7], s98 offen offset:3072 sc1
    v_mfma_f32_16x16x32_bf16 v[104:107], a[88:91], a[136:139], v[104:107]
    ds_read_b128 a[84:87], v41 offset:32768
    v_mfma_f32_16x16x32_bf16 v[100:103], a[88:91], a[132:135], v[100:103]
    v_cvt_pk_bf16_f32 v232, v232, v233
    v_mfma_f32_16x16x32_bf16 v[100:103], a[92:95], a[52:55], v[100:103]
    v_cvt_pk_bf16_f32 v233, v234, v235
    v_mfma_f32_16x16x32_bf16 v[96:99], a[92:95], a[48:51], v[96:99]
    v_cvt_pk_bf16_f32 v234, v248, v249
    v_mfma_f32_16x16x32_bf16 v[96:99], a[88:91], a[128:131], v[96:99]
    v_cvt_pk_bf16_f32 v235, v250, v251
    s_waitcnt lgkmcnt(4)
    v_mfma_f32_16x16x32_bf16 v[80:83], a[64:67], a[144:147], v[80:83]
    ds_read_b128 a[88:91], v40 offset:34816
    v_mfma_f32_16x16x32_bf16 v[80:83], a[68:71], a[0:3], v[80:83]
    buffer_store_dwordx4 v[232:235], v1, s[4:7], s98 offen offset:2048 sc1
    v_mfma_f32_16x16x32_bf16 v[84:87], a[68:71], a[4:7], v[84:87]
    v_cvt_pk_bf16_f32 v228, v228, v229
    v_mfma_f32_16x16x32_bf16 v[84:87], a[64:67], a[148:151], v[84:87]
    ds_read_b128 a[92:95], v41 offset:34816
    v_mfma_f32_16x16x32_bf16 v[88:91], a[64:67], a[152:155], v[88:91]
    v_cvt_pk_bf16_f32 v229, v230, v231
    v_mfma_f32_16x16x32_bf16 v[88:91], a[68:71], a[8:11], v[88:91]
    v_cvt_pk_bf16_f32 v230, v244, v245
    v_mfma_f32_16x16x32_bf16 v[92:95], a[68:71], a[12:15], v[92:95]
    v_cvt_pk_bf16_f32 v231, v246, v247
    v_mfma_f32_16x16x32_bf16 v[92:95], a[64:67], a[156:159], v[92:95]
    s_waitcnt lgkmcnt(4)
    v_mfma_f32_16x16x32_bf16 v[108:111], a[72:75], a[156:159], v[108:111]
    ds_read_b128 a[64:67], v40 offset:49152
    v_mfma_f32_16x16x32_bf16 v[108:111], a[76:79], a[12:15], v[108:111]
    buffer_store_dwordx4 v[228:231], v1, s[4:7], s98 offen offset:1024 sc1
    v_mfma_f32_16x16x32_bf16 v[104:107], a[76:79], a[8:11], v[104:107]
    v_cvt_pk_bf16_f32 v224, v224, v225
    v_mfma_f32_16x16x32_bf16 v[104:107], a[72:75], a[152:155], v[104:107]
    ds_read_b128 a[68:71], v41 offset:49152
    v_mfma_f32_16x16x32_bf16 v[100:103], a[72:75], a[148:151], v[100:103]
    v_cvt_pk_bf16_f32 v225, v226, v227
    v_mfma_f32_16x16x32_bf16 v[100:103], a[76:79], a[4:7], v[100:103]
    v_cvt_pk_bf16_f32 v226, v240, v241
    v_mfma_f32_16x16x32_bf16 v[96:99], a[76:79], a[0:3], v[96:99]
    v_cvt_pk_bf16_f32 v227, v242, v243
    v_mfma_f32_16x16x32_bf16 v[96:99], a[72:75], a[144:147], v[96:99]
    buffer_store_dwordx4 v[224:227], v1, s[4:7], s98 offen offset:0 sc1
    s_waitcnt lgkmcnt(4)
    v_mfma_f32_16x16x32_bf16 v[80:83], a[80:83], a[160:163], v[80:83]
    ds_read_b128 a[72:75], v40 offset:51200
    v_mfma_f32_16x16x32_bf16 v[80:83], a[84:87], a[16:19], v[80:83]
    v_mfma_f32_16x16x32_bf16 v[84:87], a[84:87], a[20:23], v[84:87]
    v_mfma_f32_16x16x32_bf16 v[84:87], a[80:83], a[164:167], v[84:87]
    ds_read_b128 a[76:79], v41 offset:51200
    v_mfma_f32_16x16x32_bf16 v[88:91], a[80:83], a[168:171], v[88:91]
    s_waitcnt vmcnt(6)
    v_mfma_f32_16x16x32_bf16 v[88:91], a[84:87], a[24:27], v[88:91]
    buffer_store_dword v58, v4, s[4:7], s72 offen offset:260 sc1
    v_mfma_f32_16x16x32_bf16 v[92:95], a[84:87], a[28:31], v[92:95]
    v_mfma_f32_16x16x32_bf16 v[92:95], a[80:83], a[172:175], v[92:95]
    s_waitcnt lgkmcnt(4)
    v_mfma_f32_16x16x32_bf16 v[108:111], a[88:91], a[172:175], v[108:111]
    ds_read_b128 a[80:83], v3 offset:0
    v_mfma_f32_16x16x32_bf16 v[108:111], a[92:95], a[28:31], v[108:111]
    s_waitcnt vmcnt(5)
    v_mfma_f32_16x16x32_bf16 v[104:107], a[92:95], a[24:27], v[104:107]
    v_cmp_eq_u32 vcc, 0, v7
    s_and_b32 s74, vcc_lo, 1
    s_cselect_b32 s63, s0, 0x40000000
    v_mfma_f32_16x16x32_bf16 v[104:107], a[88:91], a[168:171], v[104:107]
    ds_read_b128 a[84:87], v3 offset:16384
    v_mfma_f32_16x16x32_bf16 v[100:103], a[88:91], a[164:167], v[100:103]
    buffer_load_dwordx4 v[128:131], v1, s[4:7], s63 offen offset:0 sc1
    v_mfma_f32_16x16x32_bf16 v[100:103], a[92:95], a[20:23], v[100:103]
    buffer_load_dwordx4 v[132:135], v1, s[4:7], s63 offen offset:1024 sc1
    v_mfma_f32_16x16x32_bf16 v[96:99], a[92:95], a[16:19], v[96:99]
    v_mfma_f32_16x16x32_bf16 v[96:99], a[88:91], a[160:163], v[96:99]
    s_waitcnt lgkmcnt(4)
    v_mfma_f32_16x16x32_bf16 v[80:83], a[64:67], a[176:179], v[80:83]
    ds_read_b128 a[88:91], v3 offset:2048
    v_mfma_f32_16x16x32_bf16 v[80:83], a[68:71], a[96:99], v[80:83]
    buffer_load_dwordx4 v[136:139], v1, s[4:7], s63 offen offset:2048 sc1
    v_mfma_f32_16x16x32_bf16 v[84:87], a[68:71], a[100:103], v[84:87]
    buffer_load_dwordx4 v[140:143], v1, s[4:7], s63 offen offset:3072 sc1
    buffer_load_dword v7, v5, s[4:7], s92 offen offset:256 sc1
    v_mfma_f32_16x16x32_bf16 v[84:87], a[64:67], a[180:183], v[84:87]
    ds_read_b128 a[92:95], v3 offset:18432
    v_mfma_f32_16x16x32_bf16 v[88:91], a[64:67], a[184:187], v[88:91]
    v_mfma_f32_16x16x32_bf16 v[88:91], a[68:71], a[104:107], v[88:91]
    v_mfma_f32_16x16x32_bf16 v[92:95], a[68:71], a[108:111], v[92:95]
    v_mfma_f32_16x16x32_bf16 v[92:95], a[64:67], a[188:191], v[92:95]
    s_waitcnt lgkmcnt(4)
    v_mfma_f32_16x16x32_bf16 v[108:111], a[72:75], a[188:191], v[108:111]
    v_mfma_f32_16x16x32_bf16 v[108:111], a[76:79], a[108:111], v[108:111]
    v_mfma_f32_16x16x32_bf16 v[104:107], a[76:79], a[104:107], v[104:107]
    v_mfma_f32_16x16x32_bf16 v[104:107], a[72:75], a[184:187], v[104:107]
    v_mfma_f32_16x16x32_bf16 v[100:103], a[72:75], a[180:183], v[100:103]
    v_mfma_f32_16x16x32_bf16 v[100:103], a[76:79], a[100:103], v[100:103]
    v_mfma_f32_16x16x32_bf16 v[96:99], a[76:79], a[96:99], v[96:99]
    v_mfma_f32_16x16x32_bf16 v[96:99], a[72:75], a[176:179], v[96:99]
    s_waitcnt lgkmcnt(2)
    v_mfma_f32_16x16x32_bf16 v[80:83], a[80:83], a[192:195], v[80:83]
    v_mfma_f32_16x16x32_bf16 v[80:83], a[84:87], a[208:211], v[80:83]
    v_mfma_f32_16x16x32_bf16 v[84:87], a[84:87], a[212:215], v[84:87]
    v_mfma_f32_16x16x32_bf16 v[84:87], a[80:83], a[196:199], v[84:87]
    v_mfma_f32_16x16x32_bf16 v[88:91], a[80:83], a[200:203], v[88:91]
    v_mfma_f32_16x16x32_bf16 v[88:91], a[84:87], a[216:219], v[88:91]
    v_mfma_f32_16x16x32_bf16 v[92:95], a[84:87], a[220:223], v[92:95]
    v_mfma_f32_16x16x32_bf16 v[92:95], a[80:83], a[204:207], v[92:95]
    s_waitcnt lgkmcnt(0)
    v_mfma_f32_16x16x32_bf16 v[108:111], a[88:91], a[204:207], v[108:111]
    v_mfma_f32_16x16x32_bf16 v[108:111], a[92:95], a[220:223], v[108:111]
    v_mfma_f32_16x16x32_bf16 v[104:107], a[92:95], a[216:219], v[104:107]
    v_mfma_f32_16x16x32_bf16 v[104:107], a[88:91], a[200:203], v[104:107]
    v_mfma_f32_16x16x32_bf16 v[100:103], a[88:91], a[196:199], v[100:103]
    v_mfma_f32_16x16x32_bf16 v[100:103], a[92:95], a[212:215], v[100:103]
    v_mfma_f32_16x16x32_bf16 v[96:99], a[92:95], a[208:211], v[96:99]
    v_mfma_f32_16x16x32_bf16 v[96:99], a[88:91], a[192:195], v[96:99]
    s_waitcnt vmcnt(6)
    buffer_store_dword v58, v4, s[4:7], s73 offen offset:264 sc1
    s_mov_b32 s19, 0xffff0000
    v_lshlrev_b32 v208, 16, v50
    v_and_b32 v209, s19, v50
    v_lshlrev_b32 v210, 16, v51
    v_and_b32 v211, s19, v51
    v_lshlrev_b32 v212, 16, v52
    v_and_b32 v213, s19, v52
    v_lshlrev_b32 v214, 16, v53
    v_and_b32 v215, s19, v53
    v_lshlrev_b32 v216, 16, v54
    v_and_b32 v217, s19, v54
    v_lshlrev_b32 v218, 16, v55
    v_and_b32 v219, s19, v55
    v_lshlrev_b32 v220, 16, v56
    v_and_b32 v221, s19, v56
    v_lshlrev_b32 v222, 16, v57
    v_and_b32 v223, s19, v57
    s_waitcnt vmcnt(1)
    v_cmp_eq_u32 vcc, 0, v7
    s_and_b32 s75, vcc_lo, 7
    s_cmp_eq_u32 s93, 0
    s_cselect_b32 s75, 7, s75
    s_cselect_b32 s93, 1, s93
    s_sub_u32 s93, s93, 1
    s_andn2_b32 s75, s75, s74
    s_or_b32 s74, s74, s75
    s_bitcmp1_b32 s75, 0
    s_cbranch_scc0 L_nf_A_0
    buffer_load_dwordx4 v[128:131], v1, s[4:7], s0 offen offset:0 sc1
    buffer_load_dwordx4 v[132:135], v1, s[4:7], s0 offen offset:1024 sc1
    buffer_load_dwordx4 v[136:139], v1, s[4:7], s0 offen offset:2048 sc1
    buffer_load_dwordx4 v[140:143], v1, s[4:7], s0 offen offset:3072 sc1
L_nf_A_0:
    s_bitcmp1_b32 s75, 1
    s_cbranch_scc0 L_nf_A_1
    buffer_load_dwordx4 v[192:195], v1, s[4:7], s57 offen offset:0 sc1
    buffer_load_dwordx4 v[196:199], v1, s[4:7], s57 offen offset:1024 sc1
    buffer_load_dwordx4 v[200:203], v1, s[4:7], s57 offen offset:2048 sc1
    buffer_load_dwordx4 v[204:207], v1, s[4:7], s57 offen offset:3072 sc1
L_nf_A_1:
    s_bitcmp1_b32 s75, 2
    s_cbranch_scc0 L_nf_A_2
    buffer_load_dwordx4 v[240:243], v1, s[4:7], s58 offen offset:0 sc1
    buffer_load_dwordx4 v[244:247], v1, s[4:7], s58 offen offset:1024 sc1
    buffer_load_dwordx4 v[248:251], v1, s[4:7], s58 offen offset:2048 sc1
    buffer_load_dwordx4 v[252:255], v1, s[4:7], s58 offen offset:3072 sc1
L_nf_A_2:
    buffer_load_dword v7, v5, s[4:7], s92 offen offset:256 sc1
L_own:
    v_lshlrev_b32 v184, 16, v8
    v_and_b32 v185, s19, v8
    v_lshlrev_b32 v186, 16, v9
    v_and_b32 v187, s19, v9
    v_pk_mul_f32 v[184:185], v[184:185], v[208:209]
    v_pk_mul_f32 v[186:187], v[186:187], v[210:211]
    v_cvt_pk_bf16_f32 v188, v184, v185
    v_cvt_pk_bf16_f32 v189, v186, v187
    v_lshlrev_b32 v184, 16, v188
    v_and_b32 v185, s19, v188
    v_lshlrev_b32 v186, 16, v189
    v_and_b32 v187, s19, v189
    v_pk_fma_f32 v[80:81], v[184:185], v[46:47], v[80:81] op_sel:[0,0,0] op_sel_hi:[1,0,1]
    v_pk_fma_f32 v[80:81], v[216:217], v[42:43], v[80:81] op_sel:[0,0,0] op_sel_hi:[1,0,1]
    v_pk_fma_f32 v[82:83], v[186:187], v[46:47], v[82:83] op_sel:[0,0,0] op_sel_hi:[1,0,1]
    v_pk_fma_f32 v[82:83], v[218:219], v[42:43], v[82:83] op_sel:[0,0,0] op_sel_hi:[1,0,1]
    v_lshlrev_b32 v184, 16, v10
    v_and_b32 v185, s19, v10
    v_lshlrev_b32 v186, 16, v11
    v_and_b32 v187, s19, v11
    v_pk_mul_f32 v[184:185], v[184:185], v[212:213]
    v_pk_mul_f32 v[186:187], v[186:187], v[214:215]
    v_cvt_pk_bf16_f32 v188, v184, v185
    v_cvt_pk_bf16_f32 v189, v186, v187
    v_lshlrev_b32 v184, 16, v188
    v_and_b32 v185, s19, v188
    v_lshlrev_b32 v186, 16, v189
    v_and_b32 v187, s19, v189
    v_pk_fma_f32 v[96:97], v[184:185], v[46:47], v[96:97] op_sel:[0,0,0] op_sel_hi:[1,0,1]
    v_pk_fma_f32 v[96:97], v[220:221], v[42:43], v[96:97] op_sel:[0,0,0] op_sel_hi:[1,0,1]
    v_pk_fma_f32 v[98:99], v[186:187], v[46:47], v[98:99] op_sel:[0,0,0] op_sel_hi:[1,0,1]
    v_pk_fma_f32 v[98:99], v[222:223], v[42:43], v[98:99] op_sel:[0,0,0] op_sel_hi:[1,0,1]
    v_lshlrev_b32 v184, 16, v12
    v_and_b32 v185, s19, v12
    v_lshlrev_b32 v186, 16, v13
    v_and_b32 v187, s19, v13
    v_pk_mul_f32 v[184:185], v[184:185], v[208:209]
    v_pk_mul_f32 v[186:187], v[186:187], v[210:211]
    v_cvt_pk_bf16_f32 v188, v184, v185
    v_cvt_pk_bf16_f32 v189, v186, v187
    v_lshlrev_b32 v184, 16, v188
    v_and_b32 v185, s19, v188
    v_lshlrev_b32 v186, 16, v189
    v_and_b32 v187, s19, v189
    v_pk_fma_f32 v[84:85], v[184:185], v[46:47], v[84:85] op_sel:[0,1,0] op_sel_hi:[1,1,1]
    v_pk_fma_f32 v[84:85], v[216:217], v[42:43], v[84:85] op_sel:[0,1,0] op_sel_hi:[1,1,1]
    v_pk_fma_f32 v[86:87], v[186:187], v[46:47], v[86:87] op_sel:[0,1,0] op_sel_hi:[1,1,1]
    v_pk_fma_f32 v[86:87], v[218:219], v[42:43], v[86:87] op_sel:[0,1,0] op_sel_hi:[1,1,1]
    v_lshlrev_b32 v184, 16, v14
    v_and_b32 v185, s19, v14
    v_lshlrev_b32 v186, 16, v15
    v_and_b32 v187, s19, v15
    v_pk_mul_f32 v[184:185], v[184:185], v[212:213]
    v_pk_mul_f32 v[186:187], v[186:187], v[214:215]
    v_cvt_pk_bf16_f32 v188, v184, v185
    v_cvt_pk_bf16_f32 v189, v186, v187
    v_lshlrev_b32 v184, 16, v188
    v_and_b32 v185, s19, v188
    v_lshlrev_b32 v186, 16, v189
    v_and_b32 v187, s19, v189
    v_pk_fma_f32 v[100:101], v[184:185], v[46:47], v[100:101] op_sel:[0,1,0] op_sel_hi:[1,1,1]
    v_pk_fma_f32 v[100:101], v[220:221], v[42:43], v[100:101] op_sel:[0,1,0] op_sel_hi:[1,1,1]
    v_pk_fma_f32 v[102:103], v[186:187], v[46:47], v[102:103] op_sel:[0,1,0] op_sel_hi:[1,1,1]
    v_pk_fma_f32 v[102:103], v[222:223], v[42:43], v[102:103] op_sel:[0,1,0] op_sel_hi:[1,1,1]
    v_lshlrev_b32 v184, 16, v16
    v_and_b32 v185, s19, v16
    v_lshlrev_b32 v186, 16, v17
    v_and_b32 v187, s19, v17
    v_pk_mul_f32 v[184:185], v[184:185], v[208:209]
    v_pk_mul_f32 v[186:187], v[186:187], v[210:211]
    v_cvt_pk_bf16_f32 v188, v184, v185
    v_cvt_pk_bf16_f32 v189, v186, v187
    v_lshlrev_b32 v184, 16, v188
    v_and_b32 v185, s19, v188
    v_lshlrev_b32 v186, 16, v189
    v_and_b32 v187, s19, v189
    v_pk_fma_f32 v[88:89], v[184:185], v[48:49], v[88:89] op_sel:[0,0,0] op_sel_hi:[1,0,1]
    v_pk_fma_f32 v[88:89], v[216:217], v[44:45], v[88:89] op_sel:[0,0,0] op_sel_hi:[1,0,1]
    v_pk_fma_f32 v[90:91], v[186:187], v[48:49], v[90:91] op_sel:[0,0,0] op_sel_hi:[1,0,1]
    v_pk_fma_f32 v[90:91], v[218:219], v[44:45], v[90:91] op_sel:[0,0,0] op_sel_hi:[1,0,1]
    v_lshlrev_b32 v184, 16, v18
    v_and_b32 v185, s19, v18
    v_lshlrev_b32 v186, 16, v19
    v_and_b32 v187, s19, v19
    v_pk_mul_f32 v[184:185], v[184:185], v[212:213]
    v_pk_mul_f32 v[186:187], v[186:187], v[214:215]
    v_cvt_pk_bf16_f32 v188, v184, v185
    v_cvt_pk_bf16_f32 v189, v186, v187
    v_lshlrev_b32 v184, 16, v188
    v_and_b32 v185, s19, v188
    v_lshlrev_b32 v186, 16, v189
    v_and_b32 v187, s19, v189
    v_pk_fma_f32 v[104:105], v[184:185], v[48:49], v[104:105] op_sel:[0,0,0] op_sel_hi:[1,0,1]
    v_pk_fma_f32 v[104:105], v[220:221], v[44:45], v[104:105] op_sel:[0,0,0] op_sel_hi:[1,0,1]
    v_pk_fma_f32 v[106:107], v[186:187], v[48:49], v[106:107] op_sel:[0,0,0] op_sel_hi:[1,0,1]
    v_pk_fma_f32 v[106:107], v[222:223], v[44:45], v[106:107] op_sel:[0,0,0] op_sel_hi:[1,0,1]
    v_lshlrev_b32 v184, 16, v20
    v_and_b32 v185, s19, v20
    v_lshlrev_b32 v186, 16, v21
    v_and_b32 v187, s19, v21
    v_pk_mul_f32 v[184:185], v[184:185], v[208:209]
    v_pk_mul_f32 v[186:187], v[186:187], v[210:211]
    v_cvt_pk_bf16_f32 v188, v184, v185
    v_cvt_pk_bf16_f32 v189, v186, v187
    v_lshlrev_b32 v184, 16, v188
    v_and_b32 v185, s19, v188
    v_lshlrev_b32 v186, 16, v189
    v_and_b32 v187, s19, v189
    v_pk_fma_f32 v[92:93], v[184:185], v[48:49], v[92:93] op_sel:[0,1,0] op_sel_hi:[1,1,1]
    v_pk_fma_f32 v[92:93], v[216:217], v[44:45], v[92:93] op_sel:[0,1,0] op_sel_hi:[1,1,1]
    v_pk_fma_f32 v[94:95], v[186:187], v[48:49], v[94:95] op_sel:[0,1,0] op_sel_hi:[1,1,1]
    v_pk_fma_f32 v[94:95], v[218:219], v[44:45], v[94:95] op_sel:[0,1,0] op_sel_hi:[1,1,1]
    v_lshlrev_b32 v184, 16, v22
    v_and_b32 v185, s19, v22
    v_lshlrev_b32 v186, 16, v23
    v_and_b32 v187, s19, v23
    v_pk_mul_f32 v[184:185], v[184:185], v[212:213]
    v_pk_mul_f32 v[186:187], v[186:187], v[214:215]
    v_cvt_pk_bf16_f32 v188, v184, v185
    v_cvt_pk_bf16_f32 v189, v186, v187
    v_lshlrev_b32 v184, 16, v188
    v_and_b32 v185, s19, v188
    v_lshlrev_b32 v186, 16, v189
    v_and_b32 v187, s19, v189
    v_pk_fma_f32 v[108:109], v[184:185], v[48:49], v[108:109] op_sel:[0,1,0] op_sel_hi:[1,1,1]
    v_pk_fma_f32 v[108:109], v[220:221], v[44:45], v[108:109] op_sel:[0,1,0] op_sel_hi:[1,1,1]
    v_pk_fma_f32 v[110:111], v[186:187], v[48:49], v[110:111] op_sel:[0,1,0] op_sel_hi:[1,1,1]
    v_pk_fma_f32 v[110:111], v[222:223], v[44:45], v[110:111] op_sel:[0,1,0] op_sel_hi:[1,1,1]
L_tB:
    s_waitcnt vmcnt(0)
    s_cmp_eq_u32 s74, 7
    s_cbranch_scc1 L_doB
    v_cmp_eq_u32 vcc, 0, v7
    s_and_b32 s75, vcc_lo, 7
    s_cmp_eq_u32 s93, 0
    s_cselect_b32 s75, 7, s75
    s_cselect_b32 s93, 1, s93
    s_sub_u32 s93, s93, 1
    s_andn2_b32 s75, s75, s74
    s_or_b32 s74, s74, s75
    s_bitcmp1_b32 s75, 0
    s_cbranch_scc0 L_nf_B_0
    buffer_load_dwordx4 v[128:131], v1, s[4:7], s0 offen offset:0 sc1
    buffer_load_dwordx4 v[132:135], v1, s[4:7], s0 offen offset:1024 sc1
    buffer_load_dwordx4 v[136:139], v1, s[4:7], s0 offen offset:2048 sc1
    buffer_load_dwordx4 v[140:143], v1, s[4:7], s0 offen offset:3072 sc1
L_nf_B_0:
    s_bitcmp1_b32 s75, 1
    s_cbranch_scc0 L_nf_B_1
    buffer_load_dwordx4 v[192:195], v1, s[4:7], s57 offen offset:0 sc1
    buffer_load_dwordx4 v[196:199], v1, s[4:7], s57 offen offset:1024 sc1
    buffer_load_dwordx4 v[200:203], v1, s[4:7], s57 offen offset:2048 sc1
    buffer_load_dwordx4 v[204:207], v1, s[4:7], s57 offen offset:3072 sc1
L_nf_B_1:
    s_bitcmp1_b32 s75, 2
    s_cbranch_scc0 L_nf_B_2
    buffer_load_dwordx4 v[240:243], v1, s[4:7], s58 offen offset:0 sc1
    buffer_load_dwordx4 v[244:247], v1, s[4:7], s58 offen offset:1024 sc1
    buffer_load_dwordx4 v[248:251], v1, s[4:7], s58 offen offset:2048 sc1
    buffer_load_dwordx4 v[252:255], v1, s[4:7], s58 offen offset:3072 sc1
L_nf_B_2:
    buffer_load_dword v7, v5, s[4:7], s92 offen offset:256 sc1
    s_branch L_tB
L_doB:
    v_mfma_f32_16x16x32_bf16 v[80:83], v[64:67], v[128:131], v[80:83]
    v_mfma_f32_16x16x32_bf16 v[96:99], v[62:65], v[128:131], v[96:99]
    v_mfma_f32_16x16x32_bf16 v[80:83], v[64:67], v[192:195], v[80:83]
    v_mfma_f32_16x16x32_bf16 v[96:99], v[62:65], v[192:195], v[96:99]
    v_mfma_f32_16x16x32_bf16 v[80:83], v[64:67], v[240:243], v[80:83]
    v_mfma_f32_16x16x32_bf16 v[96:99], v[62:65], v[240:243], v[96:99]
    v_mfma_f32_16x16x32_bf16 v[84:87], v[64:67], v[132:135], v[84:87]
    v_mfma_f32_16x16x32_bf16 v[100:103], v[62:65], v[132:135], v[100:103]
    v_mfma_f32_16x16x32_bf16 v[84:87], v[64:67], v[196:199], v[84:87]
    v_mfma_f32_16x16x32_bf16 v[100:103], v[62:65], v[196:199], v[100:103]
    v_mfma_f32_16x16x32_bf16 v[84:87], v[64:67], v[244:247], v[84:87]
    v_mfma_f32_16x16x32_bf16 v[100:103], v[62:65], v[244:247], v[100:103]
    s_nop 1
    ds_write_b128 v75, v[80:83] offset:0
    ds_write_b128 v76, v[96:99] offset:0
    ds_read_b128 a[0:3], v77 offset:0
    ds_read_b128 a[4:7], v77 offset:1024
    v_mfma_f32_16x16x32_bf16 v[88:91], v[64:67], v[136:139], v[88:91]
    v_mfma_f32_16x16x32_bf16 v[104:107], v[62:65], v[136:139], v[104:107]
    v_mfma_f32_16x16x32_bf16 v[88:91], v[64:67], v[200:203], v[88:91]
    v_mfma_f32_16x16x32_bf16 v[104:107], v[62:65], v[200:203], v[104:107]
    v_mfma_f32_16x16x32_bf16 v[88:91], v[64:67], v[248:251], v[88:91]
    v_mfma_f32_16x16x32_bf16 v[104:107], v[62:65], v[248:251], v[104:107]
    ds_write_b128 v75, v[84:87] offset:2048
    ds_write_b128 v76, v[100:103] offset:2048
    ds_read_b128 a[8:11], v77 offset:2048
    ds_read_b128 a[12:15], v77 offset:3072
    v_mfma_f32_16x16x32_bf16 v[92:95], v[64:67], v[140:143], v[92:95]
    v_mfma_f32_16x16x32_bf16 v[108:111], v[62:65], v[140:143], v[108:111]
    v_mfma_f32_16x16x32_bf16 v[92:95], v[64:67], v[204:207], v[92:95]
    v_mfma_f32_16x16x32_bf16 v[108:111], v[62:65], v[204:207], v[108:111]
    v_mfma_f32_16x16x32_bf16 v[92:95], v[64:67], v[252:255], v[92:95]
    v_mfma_f32_16x16x32_bf16 v[108:111], v[62:65], v[252:255], v[108:111]
    s_waitcnt lgkmcnt(4)
    buffer_store_dwordx4 a[0:3], v61, s[44:47], s64 offen sc1 nt
    buffer_store_dwordx4 a[4:7], v74, s[44:47], s64 offen sc1 nt
    ds_write_b128 v75, v[88:91] offset:4096
    ds_write_b128 v76, v[104:107] offset:4096
    ds_read_b128 a[16:19], v77 offset:4096
    ds_read_b128 a[20:23], v77 offset:5120
    s_waitcnt lgkmcnt(4)
    buffer_store_dwordx4 a[8:11], v61, s[44:47], s65 offen sc1 nt
    buffer_store_dwordx4 a[12:15], v74, s[44:47], s65 offen sc1 nt
    ds_write_b128 v75, v[92:95] offset:6144
    ds_write_b128 v76, v[108:111] offset:6144
    ds_read_b128 a[24:27], v77 offset:6144
    ds_read_b128 a[28:31], v77 offset:7168
    s_waitcnt lgkmcnt(4)
L_hop_12:
    s_cbranch_execz L_hop_done
    s_nop 0
    buffer_store_dwordx4 a[16:19], v61, s[44:47], s66 offen sc1 nt
    buffer_store_dwordx4 a[20:23], v74, s[44:47], s66 offen sc1 nt
    s_waitcnt lgkmcnt(0)
    buffer_store_dwordx4 a[24:27], v61, s[44:47], s67 offen sc1 nt
    buffer_store_dwordx4 a[28:31], v74, s[44:47], s67 offen sc1 nt
L_end:
    s_endpgm
L_slow_arr:
    s_cmp_eq_u32 s93, 0
    s_cbranch_scc1 L_back_arr
    s_sub_u32 s93, s93, 1
    buffer_load_dword v23, off, s[48:51], 0 sc1
    s_waitcnt vmcnt(0)
    v_readfirstlane_b32 s18, v23
    s_nop 0
    s_cmp_ge_u32 s18, 256
    s_cbranch_scc0 L_slow_arr
    s_branch L_back_arr
L_slow_car:
    s_cmp_eq_u32 s93, 0
    s_cbranch_scc1 L_back_car
    s_sub_u32 s93, s93, 1
    buffer_load_dwordx4 v[160:163], v7, s[52:55], 0 offen offset:0 sc1
    buffer_load_dwordx4 v[164:167], v7, s[52:55], 0 offen offset:512 sc1
    buffer_load_dwordx4 v[168:171], v7, s[52:55], 0 offen offset:1024 sc1
    buffer_load_dwordx4 v[172:175], v7, s[52:55], 0 offen offset:1536 sc1
    buffer_load_dwordx4 v[192:195], v7, s[52:55], 0 offen offset:2048 sc1
    buffer_load_dwordx4 v[196:199], v7, s[52:55], 0 offen offset:2560 sc1
    buffer_load_dwordx4 v[200:203], v7, s[52:55], 0 offen offset:3072 sc1
    buffer_load_dwordx4 v[204:207], v7, s[52:55], 0 offen offset:3584 sc1
    s_waitcnt vmcnt(0)
    v_max3_u32 v32, v160, v161, v162
    v_max3_u32 v33, v163, v164, v165
    v_max3_u32 v32, v32, v166, v167
    v_max3_u32 v33, v33, v168, v169
    v_max3_u32 v32, v32, v170, v171
    v_max3_u32 v33, v33, v172, v173
    v_max3_u32 v32, v32, v174, v175
    v_max3_u32 v33, v33, v192, v193
    v_max3_u32 v32, v32, v194, v195
    v_max3_u32 v33, v33, v196, v197
    v_max3_u32 v32, v32, v198, v199
    v_max3_u32 v33, v33, v200, v201
    v_max3_u32 v32, v32, v202, v203
    v_max3_u32 v33, v33, v204, v205
    v_max3_u32 v32, v32, v206, v207
    v_max_u32 v32, v32, v33
    v_cmp_eq_u32 vcc, -1, v32
    s_cmp_eq_u64 vcc, 0
    s_cbranch_scc0 L_slow_car
    s_branch L_back_car
L_slow_flF:
    s_cmp_eq_u32 s93, 0
    s_cbranch_scc1 L_back_flF
    s_sub_u32 s93, s93, 1
    buffer_load_dword v7, v5, s[4:7], s56 offen offset:0 sc1
    s_waitcnt vmcnt(0)
    v_cmp_ne_u32 vcc, 0, v7
    s_cmp_eq_u64 vcc, 0
    s_cbranch_scc0 L_slow_flF
    s_branch L_back_flF
L_slow_flS:
    s_cmp_eq_u32 s93, 0
    s_cbranch_scc1 L_back_flS
    s_sub_u32 s93, s93, 1
    buffer_load_dword v7, v5, s[4:7], s56 offen offset:32 sc1
    s_waitcnt vmcnt(0)
    v_cmp_ne_u32 vcc, 0, v7
    s_cmp_eq_u64 vcc, 0
    s_cbranch_scc0 L_slow_flS
    s_branch L_back_flS
L_pad:
    .fill (66048 - (L_pad - L_body)) / 4, 4, 0xbf810000
.section .rodata,"a"
.p2align 6
.amdhsa_kernel gated_mix__ssm_conv_s5__dense_activation_gelu__prompt_kernel
  .amdhsa_next_free_vgpr 512
  .amdhsa_next_free_sgpr 102
  .amdhsa_accum_offset 256
  .amdhsa_group_segment_fixed_size 0
  .amdhsa_kernarg_size 144
  .amdhsa_user_sgpr_count 2
  .amdhsa_user_sgpr_kernarg_segment_ptr 1
  .amdhsa_system_sgpr_workgroup_id_x 1
  .amdhsa_float_denorm_mode_32 3
  .amdhsa_float_denorm_mode_16_64 3
.end_amdhsa_kernel
```
